```python
import torch

def _softmax(x, axis=-1):
    return torch.softmax(x, dim=axis)

def _gelu(x):
    return torch.nn.functional.gelu(x, approximate='tanh')

def _silu(x):
    return torch.nn.functional.silu(x)

def _sigmoid(x):
    return torch.sigmoid(x)

def _layernorm(x, axis=-1, eps=1e-05):
    m = x.mean(dim=axis, keepdim=True)
    v = x.var(dim=axis, keepdim=True, unbiased=False)
    return (x - m) / torch.sqrt(v + eps)

def _scatter_add(tgt, idx, src, axis=0):
    return tgt.clone().index_add_(axis, idx, src)

def _segment_sum(src, seg, n):
    out = torch.zeros((n,) + src.shape[1:], dtype=src.dtype)
    return out.index_add_(0, seg, src)

def _pad(x, pw):
    flat = tuple((v for pair in reversed(pw) for v in pair))
    return torch.nn.functional.pad(x, flat)
kernel_name = 'gated_mix__memory_aug_recurrent_mem_tr__grouped_kv_mqa__prompt'

def setup_inputs():

    _w = lambda a: (lambda t: t.to(torch.bfloat16) if t.is_floating_point() else t)(torch.as_tensor(a))

    def _A_setup():
        B, S, Dm = (1, 2048, 512)
        H, Dh = (32, 128)
        M, seg = (8, 32)
        seg = min(seg, S)
        S = S // seg * seg
        return {'x': _w((lambda *s: torch.randn(*s, dtype=torch.bfloat16) * 0.05)(B, S, Dm)), 'mem0': _w((lambda *s: torch.randn(*s, dtype=torch.bfloat16) * 0.8)(B, M, Dm)), 'Wq': _w((lambda *s: torch.randn(*s, dtype=torch.bfloat16) * 1.6)(Dm, H, Dh) * Dm ** (-0.5)), 'Wk': _w((lambda *s: torch.randn(*s, dtype=torch.bfloat16) * 1.6)(Dm, H, Dh) * Dm ** (-0.5)), 'Wv': _w((lambda *s: torch.randn(*s, dtype=torch.bfloat16) * 0.8)(Dm, H, Dh) * Dm ** (-0.5)), 'Wo': _w((lambda *s: torch.randn(*s, dtype=torch.bfloat16) * 0.8)(H, Dh, Dm) * (H * Dh) ** (-0.5)), 'seg_len': seg}
    _A_in = _A_setup()

    def _B_setup():
        B, S, D, H = (1, 2048, 512, 32)
        Dh = D // H
        return {'x': _w((lambda *s: torch.randn(*s, dtype=torch.bfloat16) * 0.05)(B, S, D)), 'wq': _w((lambda *s: torch.randn(*s, dtype=torch.bfloat16) * 1.6)(D, H * Dh)), 'wk': _w((lambda *s: torch.randn(*s, dtype=torch.bfloat16) * 1.6)(D, Dh)), 'wv': _w((lambda *s: torch.randn(*s, dtype=torch.bfloat16) * 0.05)(D, Dh)), 'wo': _w((lambda *s: torch.randn(*s, dtype=torch.bfloat16) * 0.05)(H * Dh, D))}
    _B_in = _B_setup()
    return {'A_x': _A_in['x'], 'A_mem0': _A_in['mem0'], 'A_Wq': _A_in['Wq'], 'A_Wk': _A_in['Wk'], 'A_Wv': _A_in['Wv'], 'A_Wo': _A_in['Wo'], 'A_seg_len': _A_in['seg_len'], 'B_x': _B_in['x'], 'B_wq': _B_in['wq'], 'B_wk': _B_in['wk'], 'B_wv': _B_in['wv'], 'B_wo': _B_in['wo'], 'gate_w': _w((lambda *s: torch.randn(*s, dtype=torch.bfloat16) * 0.05)(512) * 16.0)}

def reference(A_x, A_mem0, A_Wq, A_Wk, A_Wv, A_Wo, A_seg_len, B_x, B_wq, B_wk, B_wv, B_wo, gate_w):

    def _A_ref(x, mem0, Wq, Wk, Wv, Wo, seg_len):
        B, S, Dm = x.shape
        H, Dh = (Wq.shape[1], Wq.shape[2])
        M = mem0.shape[1]
        scale = Dh ** (-0.5)
        n_seg = S // seg_len
        L = M + seg_len
        idx = torch.arange(L)
        mask = (idx[:, None] < M) | (idx[:, None] >= idx[None, :])
        mem = mem0
        outs = []
        for s in range(n_seg):
            xs = x[:, s * seg_len:(s + 1) * seg_len, :].clone()
            h = torch.concatenate([mem, xs], axis=1)
            q = torch.einsum('btd,dhe->bhte', h, Wq)
            k = torch.einsum('btd,dhe->bhte', h, Wk)
            v = torch.einsum('btd,dhe->bhte', h, Wv)
            scores = torch.einsum('bhqe,bhke->bhqk', q, k) * scale
            scores = torch.where(mask[None, None], scores, -1000000000.0)
            p = _softmax(scores, axis=-1)
            o = torch.einsum('bhqk,bhke->bhqe', p, v)
            o = torch.einsum('bhte,hed->btd', o, Wo)
            mem = o[:, :M, :].clone()
            outs.append(o[:, M:, :])
        return torch.concatenate(outs, axis=1)

    def _B_ref(x, wq, wk, wv, wo):
        B, S, D = x.shape
        H = 32
        Dh = D // H
        q = (lambda x, *d: x.permute(*d))((x @ wq).reshape(B, S, H, Dh), 0, 2, 1, 3)
        k = x @ wk
        v = x @ wv
        scores = torch.einsum('bhqd,bkd->bhqk', q, k) * Dh ** (-0.5)
        p = _softmax(scores, axis=-1)
        o = torch.einsum('bhqk,bkd->bhqd', p, v)
        return (lambda x, *d: x.permute(*d))(o, 0, 2, 1, 3).reshape(B, S, H * Dh) @ wo
    x = A_x
    g = _sigmoid((x * gate_w).sum(-1, keepdims=True))
    a = _A_ref(x, A_mem0, A_Wq, A_Wk, A_Wv, A_Wo, A_seg_len)
    b = _B_ref(x, B_wq, B_wk, B_wv, B_wo)
    return g * a + (1 - g) * b
```

```asm
; @launch grid=(256,1,1) block=(256,1,1) lds=163840
.amdgcn_target "amdgcn-amd-amdhsa--gfx950"
.text
.globl gated_mix__memory_aug_recurrent_mem_tr__grouped_kv_mqa__prompt_kernel
.p2align 8
.type gated_mix__memory_aug_recurrent_mem_tr__grouped_kv_mqa__prompt_kernel,@function
gated_mix__memory_aug_recurrent_mem_tr__grouped_kv_mqa__prompt_kernel:
  s_load_dwordx4 s[20:23], s[0:1], 112
  s_getreg_b32 s18, hwreg(HW_REG_XCC_ID, 0, 4)
  v_lshrrev_b32 v1, 6, v0
  v_and_b32 v0, 63, v0
  s_nop 0
  v_readfirstlane_b32 s16, v1
  s_waitcnt lgkmcnt(0)
  s_mov_b32 s12, s20
  s_mov_b32 s13, s21
  s_mov_b32 s14, 256
  s_mov_b32 s15, 0x20000
  s_mov_b32 s8, s22
  s_mov_b32 s9, s23
  s_mov_b32 s10, 268435456
  s_mov_b32 s11, 0x20000
  s_mov_b32 s19, 0
  s_cmp_eq_u32 s16, 0
  s_cbranch_scc0 L_tick_done
  s_lshl_b32 s20, s18, 2
  s_cmp_eq_u32 s18, 0
  s_cselect_b32 s20, 128, s20
  s_mov_b64 exec, 1
  v_mov_b32 v1, s20
  v_mov_b32 v2, 1
  buffer_atomic_add v2, v1, s[12:15], 0 offen sc0
  s_waitcnt vmcnt(0)
  v_mov_b32 v3, 0x7ff0
  ds_write_b32 v3, v2
  s_waitcnt lgkmcnt(0)
  s_mov_b64 exec, -1
L_tick_done:
  s_barrier
  v_mov_b32 v3, 0x7ff0
  ds_read_b32 v2, v3
  s_waitcnt lgkmcnt(0)
  v_readfirstlane_b32 s17, v2
  s_nop 3
  s_barrier
  s_cmp_ge_u32 s17, 32
  s_cbranch_scc1 L_exit
  s_cmp_ge_u32 s18, 8
  s_cbranch_scc1 L_exit
  s_cmp_eq_u32 s18, 0
  s_cbranch_scc1 L_chain
  s_sub_u32 s20, s18, 1
  s_lshl_b32 s20, s20, 5
  s_add_u32 s17, s20, s17
  s_cmp_eq_u32 s17, 223
  s_cbranch_scc0 L_noclear
  v_mov_b32 v4, 0
  v_mov_b32 v5, 0
  v_mov_b32 v6, 0
  v_mov_b32 v7, 0
  v_lshlrev_b32 v2, 4, v0
  s_lshl_b32 s20, s16, 10
  buffer_store_dwordx4 v[4:7], v2, s[8:11], s20 offen sc1
  s_add_u32 s20, s20, 4096
  buffer_store_dwordx4 v[4:7], v2, s[8:11], s20 offen sc1
  s_add_u32 s20, s20, 4096
  buffer_store_dwordx4 v[4:7], v2, s[8:11], s20 offen sc1
  s_add_u32 s20, s20, 4096
  buffer_store_dwordx4 v[4:7], v2, s[8:11], s20 offen sc1
  s_add_u32 s20, s20, 4096
  buffer_store_dwordx4 v[4:7], v2, s[8:11], s20 offen sc1
  s_add_u32 s20, s20, 4096
  s_waitcnt vmcnt(0)
  s_barrier
  s_cmp_eq_u32 s16, 0
  s_cbranch_scc0 L_noclear
  s_mov_b64 exec, 1
  v_mov_b32 v2, 64
  v_mov_b32 v3, 1
  buffer_store_dword v3, v2, s[12:15], 0 offen sc1
  s_waitcnt vmcnt(0)
  s_mov_b64 exec, -1
L_noclear:
  s_mul_i32 s20, s17, 9363
  s_lshr_b32 s37, s20, 16
  s_mul_i32 s20, s37, 7
  s_sub_u32 s20, s17, s20
  s_cmp_eq_u32 s20, 6
  s_cbranch_scc0 L_b1_done
  s_cmp_lt_u32 s37, 16
  s_cbranch_scc0 L_b1_done
  s_load_dwordx2 s[4:5], s[0:1], 72
  s_load_dwordx2 s[48:49], s[0:1], 80
  s_load_dwordx2 s[52:53], s[0:1], 96
  s_load_dwordx2 s[56:57], s[0:1], 0
  s_waitcnt lgkmcnt(0)
  s_mov_b32 s6, 16384
  s_mov_b32 s7, 0x20000
  s_mov_b32 s50, 16384
  s_mov_b32 s51, 0x20000
  s_mov_b32 s54, 1024
  s_mov_b32 s55, 0x20000
  s_mov_b32 s58, 2097152
  s_mov_b32 s59, 0x20000
  v_lshlrev_b32 v9, 4, v0
  s_lshl_b32 s20, s16, 12
  s_add_u32 s21, s20, 0
  s_mov_b32 m0, s21
  s_nop 0
  buffer_load_dwordx4 v9, s[4:7], s21 offen lds
  s_add_u32 m0, s21, 16384
  s_nop 0
  buffer_load_dwordx4 v9, s[48:51], s21 offen lds
  s_add_u32 s21, s20, 1024
  s_mov_b32 m0, s21
  s_nop 0
  buffer_load_dwordx4 v9, s[4:7], s21 offen lds
  s_add_u32 m0, s21, 16384
  s_nop 0
  buffer_load_dwordx4 v9, s[48:51], s21 offen lds
  s_add_u32 s21, s20, 2048
  s_mov_b32 m0, s21
  s_nop 0
  buffer_load_dwordx4 v9, s[4:7], s21 offen lds
  s_add_u32 m0, s21, 16384
  s_nop 0
  buffer_load_dwordx4 v9, s[48:51], s21 offen lds
  s_add_u32 s21, s20, 3072
  s_mov_b32 m0, s21
  s_nop 0
  buffer_load_dwordx4 v9, s[4:7], s21 offen lds
  s_add_u32 m0, s21, 16384
  s_nop 0
  buffer_load_dwordx4 v9, s[48:51], s21 offen lds
  s_lshl_b32 s31, s37, 2
  s_add_u32 s31, s31, s16
  v_and_b32 v2, 31, v0
  v_lshlrev_b32 v2, 10, v2
  v_lshrrev_b32 v3, 5, v0
  v_lshl_add_u32 v8, v3, 4, v2
  s_lshl_b32 s22, s31, 15
  buffer_load_dwordx4 v[128:131], v8, s[56:59], s22 offen offset:0
  buffer_load_dwordx4 v[132:135], v8, s[56:59], s22 offen offset:32
  buffer_load_dwordx4 v[136:139], v8, s[56:59], s22 offen offset:64
  buffer_load_dwordx4 v[140:143], v8, s[56:59], s22 offen offset:96
  buffer_load_dwordx4 v[144:147], v8, s[56:59], s22 offen offset:128
  buffer_load_dwordx4 v[148:151], v8, s[56:59], s22 offen offset:160
  buffer_load_dwordx4 v[152:155], v8, s[56:59], s22 offen offset:192
  buffer_load_dwordx4 v[156:159], v8, s[56:59], s22 offen offset:224
  buffer_load_dwordx4 v[160:163], v8, s[56:59], s22 offen offset:256
  buffer_load_dwordx4 v[164:167], v8, s[56:59], s22 offen offset:288
  buffer_load_dwordx4 v[168:171], v8, s[56:59], s22 offen offset:320
  buffer_load_dwordx4 v[172:175], v8, s[56:59], s22 offen offset:352
  buffer_load_dwordx4 v[176:179], v8, s[56:59], s22 offen offset:384
  buffer_load_dwordx4 v[180:183], v8, s[56:59], s22 offen offset:416
  buffer_load_dwordx4 v[184:187], v8, s[56:59], s22 offen offset:448
  buffer_load_dwordx4 v[188:191], v8, s[56:59], s22 offen offset:480
  buffer_load_dwordx4 v[192:195], v8, s[56:59], s22 offen offset:512
  buffer_load_dwordx4 v[196:199], v8, s[56:59], s22 offen offset:544
  buffer_load_dwordx4 v[200:203], v8, s[56:59], s22 offen offset:576
  buffer_load_dwordx4 v[204:207], v8, s[56:59], s22 offen offset:608
  buffer_load_dwordx4 v[208:211], v8, s[56:59], s22 offen offset:640
  buffer_load_dwordx4 v[212:215], v8, s[56:59], s22 offen offset:672
  buffer_load_dwordx4 v[216:219], v8, s[56:59], s22 offen offset:704
  buffer_load_dwordx4 v[220:223], v8, s[56:59], s22 offen offset:736
  buffer_load_dwordx4 v[224:227], v8, s[56:59], s22 offen offset:768
  buffer_load_dwordx4 v[228:231], v8, s[56:59], s22 offen offset:800
  buffer_load_dwordx4 v[232:235], v8, s[56:59], s22 offen offset:832
  buffer_load_dwordx4 v[236:239], v8, s[56:59], s22 offen offset:864
  buffer_load_dwordx4 v[240:243], v8, s[56:59], s22 offen offset:896
  buffer_load_dwordx4 v[244:247], v8, s[56:59], s22 offen offset:928
  buffer_load_dwordx4 v[248:251], v8, s[56:59], s22 offen offset:960
  buffer_load_dwordx4 v[252:255], v8, s[56:59], s22 offen offset:992
  v_lshrrev_b32 v2, 5, v0
  v_lshlrev_b32 v2, 3, v2
  v_bfe_u32 v3, v0, 2, 2
  v_add_u32 v2, v2, v3
  v_lshlrev_b32 v2, 5, v2
  v_and_b32 v3, 3, v0
  v_lshl_add_u32 v10, v3, 3, v2
  s_waitcnt vmcnt(32)
  s_barrier
  ds_read_b64_tr_b16 a[0:1], v10 offset:0
  ds_read_b64_tr_b16 a[2:3], v10 offset:128
  ds_read_b64_tr_b16 a[128:129], v10 offset:16384
  ds_read_b64_tr_b16 a[130:131], v10 offset:16512
  ds_read_b64_tr_b16 a[4:5], v10 offset:512
  ds_read_b64_tr_b16 a[6:7], v10 offset:640
  ds_read_b64_tr_b16 a[132:133], v10 offset:16896
  ds_read_b64_tr_b16 a[134:135], v10 offset:17024
  ds_read_b64_tr_b16 a[8:9], v10 offset:1024
  ds_read_b64_tr_b16 a[10:11], v10 offset:1152
  ds_read_b64_tr_b16 a[136:137], v10 offset:17408
  ds_read_b64_tr_b16 a[138:139], v10 offset:17536
  s_waitcnt lgkmcnt(0)
  ds_read_b64_tr_b16 a[12:13], v10 offset:1536
  ds_read_b64_tr_b16 a[14:15], v10 offset:1664
  ds_read_b64_tr_b16 a[140:141], v10 offset:17920
  ds_read_b64_tr_b16 a[142:143], v10 offset:18048
  ds_read_b64_tr_b16 a[16:17], v10 offset:2048
  ds_read_b64_tr_b16 a[18:19], v10 offset:2176
  ds_read_b64_tr_b16 a[144:145], v10 offset:18432
  ds_read_b64_tr_b16 a[146:147], v10 offset:18560
  ds_read_b64_tr_b16 a[20:21], v10 offset:2560
  ds_read_b64_tr_b16 a[22:23], v10 offset:2688
  ds_read_b64_tr_b16 a[148:149], v10 offset:18944
  ds_read_b64_tr_b16 a[150:151], v10 offset:19072
  s_waitcnt lgkmcnt(0)
  ds_read_b64_tr_b16 a[24:25], v10 offset:3072
  ds_read_b64_tr_b16 a[26:27], v10 offset:3200
  ds_read_b64_tr_b16 a[152:153], v10 offset:19456
  ds_read_b64_tr_b16 a[154:155], v10 offset:19584
  ds_read_b64_tr_b16 a[28:29], v10 offset:3584
  ds_read_b64_tr_b16 a[30:31], v10 offset:3712
  ds_read_b64_tr_b16 a[156:157], v10 offset:19968
  ds_read_b64_tr_b16 a[158:159], v10 offset:20096
  ds_read_b64_tr_b16 a[32:33], v10 offset:4096
  ds_read_b64_tr_b16 a[34:35], v10 offset:4224
  ds_read_b64_tr_b16 a[160:161], v10 offset:20480
  ds_read_b64_tr_b16 a[162:163], v10 offset:20608
  s_waitcnt lgkmcnt(0)
  ds_read_b64_tr_b16 a[36:37], v10 offset:4608
  ds_read_b64_tr_b16 a[38:39], v10 offset:4736
  ds_read_b64_tr_b16 a[164:165], v10 offset:20992
  ds_read_b64_tr_b16 a[166:167], v10 offset:21120
  ds_read_b64_tr_b16 a[40:41], v10 offset:5120
  ds_read_b64_tr_b16 a[42:43], v10 offset:5248
  ds_read_b64_tr_b16 a[168:169], v10 offset:21504
  ds_read_b64_tr_b16 a[170:171], v10 offset:21632
  ds_read_b64_tr_b16 a[44:45], v10 offset:5632
  ds_read_b64_tr_b16 a[46:47], v10 offset:5760
  ds_read_b64_tr_b16 a[172:173], v10 offset:22016
  ds_read_b64_tr_b16 a[174:175], v10 offset:22144
  s_waitcnt lgkmcnt(0)
  ds_read_b64_tr_b16 a[48:49], v10 offset:6144
  ds_read_b64_tr_b16 a[50:51], v10 offset:6272
  ds_read_b64_tr_b16 a[176:177], v10 offset:22528
  ds_read_b64_tr_b16 a[178:179], v10 offset:22656
  ds_read_b64_tr_b16 a[52:53], v10 offset:6656
  ds_read_b64_tr_b16 a[54:55], v10 offset:6784
  ds_read_b64_tr_b16 a[180:181], v10 offset:23040
  ds_read_b64_tr_b16 a[182:183], v10 offset:23168
  ds_read_b64_tr_b16 a[56:57], v10 offset:7168
  ds_read_b64_tr_b16 a[58:59], v10 offset:7296
  ds_read_b64_tr_b16 a[184:185], v10 offset:23552
  ds_read_b64_tr_b16 a[186:187], v10 offset:23680
  s_waitcnt lgkmcnt(0)
  ds_read_b64_tr_b16 a[60:61], v10 offset:7680
  ds_read_b64_tr_b16 a[62:63], v10 offset:7808
  ds_read_b64_tr_b16 a[188:189], v10 offset:24064
  ds_read_b64_tr_b16 a[190:191], v10 offset:24192
  ds_read_b64_tr_b16 a[64:65], v10 offset:8192
  ds_read_b64_tr_b16 a[66:67], v10 offset:8320
  ds_read_b64_tr_b16 a[192:193], v10 offset:24576
  ds_read_b64_tr_b16 a[194:195], v10 offset:24704
  ds_read_b64_tr_b16 a[68:69], v10 offset:8704
  ds_read_b64_tr_b16 a[70:71], v10 offset:8832
  ds_read_b64_tr_b16 a[196:197], v10 offset:25088
  ds_read_b64_tr_b16 a[198:199], v10 offset:25216
  s_waitcnt lgkmcnt(0)
  ds_read_b64_tr_b16 a[72:73], v10 offset:9216
  ds_read_b64_tr_b16 a[74:75], v10 offset:9344
  ds_read_b64_tr_b16 a[200:201], v10 offset:25600
  ds_read_b64_tr_b16 a[202:203], v10 offset:25728
  ds_read_b64_tr_b16 a[76:77], v10 offset:9728
  ds_read_b64_tr_b16 a[78:79], v10 offset:9856
  ds_read_b64_tr_b16 a[204:205], v10 offset:26112
  ds_read_b64_tr_b16 a[206:207], v10 offset:26240
  ds_read_b64_tr_b16 a[80:81], v10 offset:10240
  ds_read_b64_tr_b16 a[82:83], v10 offset:10368
  ds_read_b64_tr_b16 a[208:209], v10 offset:26624
  ds_read_b64_tr_b16 a[210:211], v10 offset:26752
  s_waitcnt lgkmcnt(0)
  ds_read_b64_tr_b16 a[84:85], v10 offset:10752
  ds_read_b64_tr_b16 a[86:87], v10 offset:10880
  ds_read_b64_tr_b16 a[212:213], v10 offset:27136
  ds_read_b64_tr_b16 a[214:215], v10 offset:27264
  ds_read_b64_tr_b16 a[88:89], v10 offset:11264
  ds_read_b64_tr_b16 a[90:91], v10 offset:11392
  ds_read_b64_tr_b16 a[216:217], v10 offset:27648
  ds_read_b64_tr_b16 a[218:219], v10 offset:27776
  ds_read_b64_tr_b16 a[92:93], v10 offset:11776
  ds_read_b64_tr_b16 a[94:95], v10 offset:11904
  ds_read_b64_tr_b16 a[220:221], v10 offset:28160
  ds_read_b64_tr_b16 a[222:223], v10 offset:28288
  s_waitcnt lgkmcnt(0)
  ds_read_b64_tr_b16 a[96:97], v10 offset:12288
  ds_read_b64_tr_b16 a[98:99], v10 offset:12416
  ds_read_b64_tr_b16 a[224:225], v10 offset:28672
  ds_read_b64_tr_b16 a[226:227], v10 offset:28800
  ds_read_b64_tr_b16 a[100:101], v10 offset:12800
  ds_read_b64_tr_b16 a[102:103], v10 offset:12928
  ds_read_b64_tr_b16 a[228:229], v10 offset:29184
  ds_read_b64_tr_b16 a[230:231], v10 offset:29312
  ds_read_b64_tr_b16 a[104:105], v10 offset:13312
  ds_read_b64_tr_b16 a[106:107], v10 offset:13440
  ds_read_b64_tr_b16 a[232:233], v10 offset:29696
  ds_read_b64_tr_b16 a[234:235], v10 offset:29824
  s_waitcnt lgkmcnt(0)
  ds_read_b64_tr_b16 a[108:109], v10 offset:13824
  ds_read_b64_tr_b16 a[110:111], v10 offset:13952
  ds_read_b64_tr_b16 a[236:237], v10 offset:30208
  ds_read_b64_tr_b16 a[238:239], v10 offset:30336
  ds_read_b64_tr_b16 a[112:113], v10 offset:14336
  ds_read_b64_tr_b16 a[114:115], v10 offset:14464
  ds_read_b64_tr_b16 a[240:241], v10 offset:30720
  ds_read_b64_tr_b16 a[242:243], v10 offset:30848
  ds_read_b64_tr_b16 a[116:117], v10 offset:14848
  ds_read_b64_tr_b16 a[118:119], v10 offset:14976
  ds_read_b64_tr_b16 a[244:245], v10 offset:31232
  ds_read_b64_tr_b16 a[246:247], v10 offset:31360
  s_waitcnt lgkmcnt(0)
  ds_read_b64_tr_b16 a[120:121], v10 offset:15360
  ds_read_b64_tr_b16 a[122:123], v10 offset:15488
  ds_read_b64_tr_b16 a[248:249], v10 offset:31744
  ds_read_b64_tr_b16 a[250:251], v10 offset:31872
  ds_read_b64_tr_b16 a[124:125], v10 offset:15872
  ds_read_b64_tr_b16 a[126:127], v10 offset:16000
  ds_read_b64_tr_b16 a[252:253], v10 offset:32256
  ds_read_b64_tr_b16 a[254:255], v10 offset:32384
  s_waitcnt lgkmcnt(0)
  v_lshrrev_b32 v2, 5, v0
  v_lshlrev_b32 v11, 4, v2
  s_mov_b32 s20, 0x00010000
  s_mov_b32 s21, 0x00010000
  s_mov_b64 exec, s[20:21]
  buffer_load_dwordx4 a[128:131], v11, s[52:55], 0 offen offset:0
  buffer_load_dwordx4 a[132:135], v11, s[52:55], 0 offen offset:32
  buffer_load_dwordx4 a[136:139], v11, s[52:55], 0 offen offset:64
  buffer_load_dwordx4 a[140:143], v11, s[52:55], 0 offen offset:96
  buffer_load_dwordx4 a[144:147], v11, s[52:55], 0 offen offset:128
  buffer_load_dwordx4 a[148:151], v11, s[52:55], 0 offen offset:160
  buffer_load_dwordx4 a[152:155], v11, s[52:55], 0 offen offset:192
  buffer_load_dwordx4 a[156:159], v11, s[52:55], 0 offen offset:224
  buffer_load_dwordx4 a[160:163], v11, s[52:55], 0 offen offset:256
  buffer_load_dwordx4 a[164:167], v11, s[52:55], 0 offen offset:288
  buffer_load_dwordx4 a[168:171], v11, s[52:55], 0 offen offset:320
  buffer_load_dwordx4 a[172:175], v11, s[52:55], 0 offen offset:352
  buffer_load_dwordx4 a[176:179], v11, s[52:55], 0 offen offset:384
  buffer_load_dwordx4 a[180:183], v11, s[52:55], 0 offen offset:416
  buffer_load_dwordx4 a[184:187], v11, s[52:55], 0 offen offset:448
  buffer_load_dwordx4 a[188:191], v11, s[52:55], 0 offen offset:480
  buffer_load_dwordx4 a[192:195], v11, s[52:55], 0 offen offset:512
  buffer_load_dwordx4 a[196:199], v11, s[52:55], 0 offen offset:544
  buffer_load_dwordx4 a[200:203], v11, s[52:55], 0 offen offset:576
  buffer_load_dwordx4 a[204:207], v11, s[52:55], 0 offen offset:608
  buffer_load_dwordx4 a[208:211], v11, s[52:55], 0 offen offset:640
  buffer_load_dwordx4 a[212:215], v11, s[52:55], 0 offen offset:672
  buffer_load_dwordx4 a[216:219], v11, s[52:55], 0 offen offset:704
  buffer_load_dwordx4 a[220:223], v11, s[52:55], 0 offen offset:736
  buffer_load_dwordx4 a[224:227], v11, s[52:55], 0 offen offset:768
  buffer_load_dwordx4 a[228:231], v11, s[52:55], 0 offen offset:800
  buffer_load_dwordx4 a[232:235], v11, s[52:55], 0 offen offset:832
  buffer_load_dwordx4 a[236:239], v11, s[52:55], 0 offen offset:864
  buffer_load_dwordx4 a[240:243], v11, s[52:55], 0 offen offset:896
  buffer_load_dwordx4 a[244:247], v11, s[52:55], 0 offen offset:928
  buffer_load_dwordx4 a[248:251], v11, s[52:55], 0 offen offset:960
  buffer_load_dwordx4 a[252:255], v11, s[52:55], 0 offen offset:992
  s_mov_b64 exec, -1
  s_waitcnt vmcnt(0)
  v_mfma_f32_32x32x16_bf16 v[16:31], v[128:131], a[128:131], 0
  v_mfma_f32_32x32x16_bf16 v[32:47], a[0:3], v[128:131], 0
  v_mfma_f32_32x32x16_bf16 v[16:31], v[132:135], a[132:135], v[16:31]
  v_mfma_f32_32x32x16_bf16 v[32:47], a[4:7], v[132:135], v[32:47]
  v_mfma_f32_32x32x16_bf16 v[16:31], v[136:139], a[136:139], v[16:31]
  v_mfma_f32_32x32x16_bf16 v[32:47], a[8:11], v[136:139], v[32:47]
  v_mfma_f32_32x32x16_bf16 v[16:31], v[140:143], a[140:143], v[16:31]
  v_mfma_f32_32x32x16_bf16 v[32:47], a[12:15], v[140:143], v[32:47]
  v_mfma_f32_32x32x16_bf16 v[16:31], v[144:147], a[144:147], v[16:31]
  v_mfma_f32_32x32x16_bf16 v[32:47], a[16:19], v[144:147], v[32:47]
  v_mfma_f32_32x32x16_bf16 v[16:31], v[148:151], a[148:151], v[16:31]
  v_mfma_f32_32x32x16_bf16 v[32:47], a[20:23], v[148:151], v[32:47]
  v_mfma_f32_32x32x16_bf16 v[16:31], v[152:155], a[152:155], v[16:31]
  v_mfma_f32_32x32x16_bf16 v[32:47], a[24:27], v[152:155], v[32:47]
  v_mfma_f32_32x32x16_bf16 v[16:31], v[156:159], a[156:159], v[16:31]
  v_mfma_f32_32x32x16_bf16 v[32:47], a[28:31], v[156:159], v[32:47]
  v_mfma_f32_32x32x16_bf16 v[16:31], v[160:163], a[160:163], v[16:31]
  v_mfma_f32_32x32x16_bf16 v[32:47], a[32:35], v[160:163], v[32:47]
  v_mfma_f32_32x32x16_bf16 v[16:31], v[164:167], a[164:167], v[16:31]
  v_mfma_f32_32x32x16_bf16 v[32:47], a[36:39], v[164:167], v[32:47]
  v_mfma_f32_32x32x16_bf16 v[16:31], v[168:171], a[168:171], v[16:31]
  v_mfma_f32_32x32x16_bf16 v[32:47], a[40:43], v[168:171], v[32:47]
  v_mfma_f32_32x32x16_bf16 v[16:31], v[172:175], a[172:175], v[16:31]
  v_mfma_f32_32x32x16_bf16 v[32:47], a[44:47], v[172:175], v[32:47]
  v_mfma_f32_32x32x16_bf16 v[16:31], v[176:179], a[176:179], v[16:31]
  v_mfma_f32_32x32x16_bf16 v[32:47], a[48:51], v[176:179], v[32:47]
  v_mfma_f32_32x32x16_bf16 v[16:31], v[180:183], a[180:183], v[16:31]
  v_mfma_f32_32x32x16_bf16 v[32:47], a[52:55], v[180:183], v[32:47]
  v_mfma_f32_32x32x16_bf16 v[16:31], v[184:187], a[184:187], v[16:31]
  v_mfma_f32_32x32x16_bf16 v[32:47], a[56:59], v[184:187], v[32:47]
  v_mfma_f32_32x32x16_bf16 v[16:31], v[188:191], a[188:191], v[16:31]
  v_mfma_f32_32x32x16_bf16 v[32:47], a[60:63], v[188:191], v[32:47]
  v_mfma_f32_32x32x16_bf16 v[16:31], v[192:195], a[192:195], v[16:31]
  v_mfma_f32_32x32x16_bf16 v[32:47], a[64:67], v[192:195], v[32:47]
  v_mfma_f32_32x32x16_bf16 v[16:31], v[196:199], a[196:199], v[16:31]
  v_mfma_f32_32x32x16_bf16 v[32:47], a[68:71], v[196:199], v[32:47]
  v_mfma_f32_32x32x16_bf16 v[16:31], v[200:203], a[200:203], v[16:31]
  v_mfma_f32_32x32x16_bf16 v[32:47], a[72:75], v[200:203], v[32:47]
  v_mfma_f32_32x32x16_bf16 v[16:31], v[204:207], a[204:207], v[16:31]
  v_mfma_f32_32x32x16_bf16 v[32:47], a[76:79], v[204:207], v[32:47]
  v_mfma_f32_32x32x16_bf16 v[16:31], v[208:211], a[208:211], v[16:31]
  v_mfma_f32_32x32x16_bf16 v[32:47], a[80:83], v[208:211], v[32:47]
  v_mfma_f32_32x32x16_bf16 v[16:31], v[212:215], a[212:215], v[16:31]
  v_mfma_f32_32x32x16_bf16 v[32:47], a[84:87], v[212:215], v[32:47]
  v_mfma_f32_32x32x16_bf16 v[16:31], v[216:219], a[216:219], v[16:31]
  v_mfma_f32_32x32x16_bf16 v[32:47], a[88:91], v[216:219], v[32:47]
  v_mfma_f32_32x32x16_bf16 v[16:31], v[220:223], a[220:223], v[16:31]
  v_mfma_f32_32x32x16_bf16 v[32:47], a[92:95], v[220:223], v[32:47]
  v_mfma_f32_32x32x16_bf16 v[16:31], v[224:227], a[224:227], v[16:31]
  v_mfma_f32_32x32x16_bf16 v[32:47], a[96:99], v[224:227], v[32:47]
  v_mfma_f32_32x32x16_bf16 v[16:31], v[228:231], a[228:231], v[16:31]
  v_mfma_f32_32x32x16_bf16 v[32:47], a[100:103], v[228:231], v[32:47]
  v_mfma_f32_32x32x16_bf16 v[16:31], v[232:235], a[232:235], v[16:31]
  v_mfma_f32_32x32x16_bf16 v[32:47], a[104:107], v[232:235], v[32:47]
  v_mfma_f32_32x32x16_bf16 v[16:31], v[236:239], a[236:239], v[16:31]
  v_mfma_f32_32x32x16_bf16 v[32:47], a[108:111], v[236:239], v[32:47]
  v_mfma_f32_32x32x16_bf16 v[16:31], v[240:243], a[240:243], v[16:31]
  v_mfma_f32_32x32x16_bf16 v[32:47], a[112:115], v[240:243], v[32:47]
  v_mfma_f32_32x32x16_bf16 v[16:31], v[244:247], a[244:247], v[16:31]
  v_mfma_f32_32x32x16_bf16 v[32:47], a[116:119], v[244:247], v[32:47]
  v_mfma_f32_32x32x16_bf16 v[16:31], v[248:251], a[248:251], v[16:31]
  v_mfma_f32_32x32x16_bf16 v[32:47], a[120:123], v[248:251], v[32:47]
  v_mfma_f32_32x32x16_bf16 v[16:31], v[252:255], a[252:255], v[16:31]
  v_mfma_f32_32x32x16_bf16 v[32:47], a[124:127], v[252:255], v[32:47]
  s_nop 11
  v_cvt_pk_bf16_f32 v48, v32, v33
  s_nop 10
  v_cvt_pk_bf16_f32 v49, v34, v35
  s_nop 9
  v_cvt_pk_bf16_f32 v50, v36, v37
  s_nop 8
  v_cvt_pk_bf16_f32 v51, v38, v39
  s_lshl_b32 s20, s31, 10
  s_add_u32 s21, s20, 1966080
  buffer_store_dwordx4 v[48:51], v9, s[8:11], s21 offen sc1
  v_cvt_pk_bf16_f32 v52, v16, v17
  v_cvt_pk_bf16_f32 v53, v18, v19
  v_cvt_pk_bf16_f32 v54, v20, v21
  v_cvt_pk_bf16_f32 v55, v22, v23
  v_cvt_pk_bf16_f32 v56, v24, v25
  v_cvt_pk_bf16_f32 v57, v26, v27
  v_cvt_pk_bf16_f32 v58, v28, v29
  v_cvt_pk_bf16_f32 v59, v30, v31
  v_lshrrev_b32 v2, 5, v0
  v_lshlrev_b32 v2, 8, v2
  v_and_b32 v3, 15, v0
  v_lshl_add_u32 v12, v3, 4, v2
  s_add_u32 s21, s20, 2031616
  s_mov_b32 s22, 0x0000ffff
  s_mov_b32 s23, 0x0000ffff
  s_mov_b64 exec, s[22:23]
  buffer_store_dwordx4 v[52:55], v12, s[8:11], s21 offen sc1
  buffer_store_dwordx4 v[56:59], v12, s[8:11], s21 offen offset:512 sc1
  s_mov_b64 exec, -1
  s_mov_b32 s24, 0xbfb8aa3b
  v_mul_f32 v64, s24, v16
  v_mul_f32 v65, s24, v17
  v_mul_f32 v66, s24, v18
  v_mul_f32 v67, s24, v19
  v_mul_f32 v68, s24, v20
  v_mul_f32 v69, s24, v21
  v_mul_f32 v70, s24, v22
  v_mul_f32 v71, s24, v23
  v_mul_f32 v72, s24, v24
  v_mul_f32 v73, s24, v25
  v_mul_f32 v74, s24, v26
  v_mul_f32 v75, s24, v27
  v_mul_f32 v76, s24, v28
  v_mul_f32 v77, s24, v29
  v_mul_f32 v78, s24, v30
  v_mul_f32 v79, s24, v31
  v_exp_f32 v64, v64
  v_exp_f32 v65, v65
  v_exp_f32 v66, v66
  v_exp_f32 v67, v67
  v_exp_f32 v68, v68
  v_exp_f32 v69, v69
  v_exp_f32 v70, v70
  v_exp_f32 v71, v71
  v_exp_f32 v72, v72
  v_exp_f32 v73, v73
  v_exp_f32 v74, v74
  v_exp_f32 v75, v75
  v_exp_f32 v76, v76
  v_exp_f32 v77, v77
  v_exp_f32 v78, v78
  v_exp_f32 v79, v79
  v_add_f32 v64, 1.0, v64
  v_add_f32 v65, 1.0, v65
  v_add_f32 v66, 1.0, v66
  v_add_f32 v67, 1.0, v67
  v_add_f32 v68, 1.0, v68
  v_add_f32 v69, 1.0, v69
  v_add_f32 v70, 1.0, v70
  v_add_f32 v71, 1.0, v71
  v_add_f32 v72, 1.0, v72
  v_add_f32 v73, 1.0, v73
  v_add_f32 v74, 1.0, v74
  v_add_f32 v75, 1.0, v75
  v_add_f32 v76, 1.0, v76
  v_add_f32 v77, 1.0, v77
  v_add_f32 v78, 1.0, v78
  v_add_f32 v79, 1.0, v79
  v_rcp_f32 v64, v64
  v_rcp_f32 v65, v65
  v_rcp_f32 v66, v66
  v_rcp_f32 v67, v67
  v_rcp_f32 v68, v68
  v_rcp_f32 v69, v69
  v_rcp_f32 v70, v70
  v_rcp_f32 v71, v71
  v_rcp_f32 v72, v72
  v_rcp_f32 v73, v73
  v_rcp_f32 v74, v74
  v_rcp_f32 v75, v75
  v_rcp_f32 v76, v76
  v_rcp_f32 v77, v77
  v_rcp_f32 v78, v78
  v_rcp_f32 v79, v79
  v_lshrrev_b32 v2, 5, v0
  v_lshlrev_b32 v13, 4, v2
  s_lshl_b32 s21, s31, 7
  s_add_u32 s21, s21, 1900544
  s_mov_b32 s22, 0x00010000
  s_mov_b32 s23, 0x00010000
  s_mov_b64 exec, s[22:23]
  buffer_store_dwordx4 v[64:67], v13, s[8:11], s21 offen offset:0 sc1
  buffer_store_dwordx4 v[68:71], v13, s[8:11], s21 offen offset:32 sc1
  buffer_store_dwordx4 v[72:75], v13, s[8:11], s21 offen offset:64 sc1
  buffer_store_dwordx4 v[76:79], v13, s[8:11], s21 offen offset:96 sc1
  s_mov_b64 exec, -1
L_clr_b1:
  v_mov_b32 v2, 64
  buffer_load_dword v2, v2, s[12:15], 0 offen sc1
  s_waitcnt vmcnt(0)
  v_cmp_eq_u32 vcc, 0, v2
  s_add_u32 s19, s19, 1
  s_cmp_lt_u32 s19, 2097152
  s_cselect_b64 s[20:21], -1, 0
  s_and_b64 vcc, vcc, s[20:21]
  s_cbranch_vccnz L_clr_b1
  s_barrier
  s_lshl_b32 s20, s37, 2
  s_add_u32 s20, s20, 14336
  v_mov_b32 v2, 0
  v_mov_b32 v3, 1
  s_cmp_eq_u32 s16, 0
  s_cselect_b64 exec, 1, 0
  buffer_store_dword v3, v2, s[8:11], s20 offen sc1
  s_mov_b64 exec, -1
  s_waitcnt vmcnt(0)
  s_barrier
L_b1_done:
  s_mov_b32 s30, s17
  s_mul_i32 s20, s30, 9363
  s_lshr_b32 s17, s20, 16
  s_mul_i32 s20, s17, 7
  s_sub_u32 s31, s30, s20
  v_lshrrev_b32 v2, 2, v0
  v_and_b32 v3, 3, v0
  v_lshrrev_b32 v4, 5, v0
  v_lshlrev_b32 v4, 1, v4
  v_xor_b32 v3, v3, v4
  v_lshlrev_b32 v2, 13, v2
  v_lshl_add_u32 v2, v3, 4, v2
  v_lshrrev_b32 v3, 4, v0
  v_bfe_u32 v4, v0, 2, 2
  v_lshl_add_u32 v4, v3, 3, v4
  v_lshlrev_b32 v4, 6, v4
  v_and_b32 v5, 1, v0
  v_lshl_add_u32 v4, v5, 3, v4
  v_bfe_u32 v5, v0, 1, 1
  v_and_b32 v3, 1, v3
  v_lshlrev_b32 v3, 1, v3
  v_xor_b32 v5, v5, v3
  v_lshl_add_u32 v6, v5, 4, v4
  v_xor_b32 v5, 2, v5
  v_lshl_add_u32 v7, v5, 4, v4
  s_lshl_b32 s22, s16, 15
  s_add_u32 s22, s22, 0
  v_add_u32 v6, s22, v6
  v_add_u32 v7, s22, v7
  s_lshl_b32 s23, s17, 8
  s_lshl_b32 s24, s16, 6
  s_add_u32 s23, s23, s24
  s_mov_b32 s24, 0
  s_load_dwordx2 s[4:5], s[0:1], 16
  s_load_dwordx2 s[48:49], s[0:1], 24
  s_load_dwordx2 s[52:53], s[0:1], 32
  s_waitcnt lgkmcnt(0)
  s_mov_b32 s6, 4194304
  s_mov_b32 s7, 0x20000
  s_mov_b32 s50, 4194304
  s_mov_b32 s51, 0x20000
  s_mov_b32 s54, 4194304
  s_mov_b32 s55, 0x20000
  s_add_u32 s25, s24, 0
  s_and_b32 s25, s25, 511
  s_lshl_b32 s25, s25, 13
  s_add_u32 s25, s25, s23
  s_add_u32 m0, s22, 0
  s_nop 0
  buffer_load_dwordx4 v2, s[4:7], s25 offen lds
  s_add_u32 s25, s24, 16
  s_and_b32 s25, s25, 511
  s_lshl_b32 s25, s25, 13
  s_add_u32 s25, s25, s23
  s_add_u32 m0, s22, 1024
  s_nop 0
  buffer_load_dwordx4 v2, s[4:7], s25 offen lds
  s_add_u32 s25, s24, 32
  s_and_b32 s25, s25, 511
  s_lshl_b32 s25, s25, 13
  s_add_u32 s25, s25, s23
  s_add_u32 m0, s22, 2048
  s_nop 0
  buffer_load_dwordx4 v2, s[4:7], s25 offen lds
  s_add_u32 s25, s24, 48
  s_and_b32 s25, s25, 511
  s_lshl_b32 s25, s25, 13
  s_add_u32 s25, s25, s23
  s_add_u32 m0, s22, 3072
  s_nop 0
  buffer_load_dwordx4 v2, s[4:7], s25 offen lds
  s_add_u32 s25, s24, 64
  s_and_b32 s25, s25, 511
  s_lshl_b32 s25, s25, 13
  s_add_u32 s25, s25, s23
  s_add_u32 m0, s22, 4096
  s_nop 0
  buffer_load_dwordx4 v2, s[4:7], s25 offen lds
  s_add_u32 s25, s24, 80
  s_and_b32 s25, s25, 511
  s_lshl_b32 s25, s25, 13
  s_add_u32 s25, s25, s23
  s_add_u32 m0, s22, 5120
  s_nop 0
  buffer_load_dwordx4 v2, s[4:7], s25 offen lds
  s_add_u32 s25, s24, 96
  s_and_b32 s25, s25, 511
  s_lshl_b32 s25, s25, 13
  s_add_u32 s25, s25, s23
  s_add_u32 m0, s22, 6144
  s_nop 0
  buffer_load_dwordx4 v2, s[4:7], s25 offen lds
  s_add_u32 s25, s24, 112
  s_and_b32 s25, s25, 511
  s_lshl_b32 s25, s25, 13
  s_add_u32 s25, s25, s23
  s_add_u32 m0, s22, 7168
  s_nop 0
  buffer_load_dwordx4 v2, s[4:7], s25 offen lds
  s_add_u32 s25, s24, 128
  s_and_b32 s25, s25, 511
  s_lshl_b32 s25, s25, 13
  s_add_u32 s25, s25, s23
  s_add_u32 m0, s22, 8192
  s_nop 0
  buffer_load_dwordx4 v2, s[4:7], s25 offen lds
  s_add_u32 s25, s24, 144
  s_and_b32 s25, s25, 511
  s_lshl_b32 s25, s25, 13
  s_add_u32 s25, s25, s23
  s_add_u32 m0, s22, 9216
  s_nop 0
  buffer_load_dwordx4 v2, s[4:7], s25 offen lds
  s_add_u32 s25, s24, 160
  s_and_b32 s25, s25, 511
  s_lshl_b32 s25, s25, 13
  s_add_u32 s25, s25, s23
  s_add_u32 m0, s22, 10240
  s_nop 0
  buffer_load_dwordx4 v2, s[4:7], s25 offen lds
  s_add_u32 s25, s24, 176
  s_and_b32 s25, s25, 511
  s_lshl_b32 s25, s25, 13
  s_add_u32 s25, s25, s23
  s_add_u32 m0, s22, 11264
  s_nop 0
  buffer_load_dwordx4 v2, s[4:7], s25 offen lds
  s_add_u32 s25, s24, 192
  s_and_b32 s25, s25, 511
  s_lshl_b32 s25, s25, 13
  s_add_u32 s25, s25, s23
  s_add_u32 m0, s22, 12288
  s_nop 0
  buffer_load_dwordx4 v2, s[4:7], s25 offen lds
  s_add_u32 s25, s24, 208
  s_and_b32 s25, s25, 511
  s_lshl_b32 s25, s25, 13
  s_add_u32 s25, s25, s23
  s_add_u32 m0, s22, 13312
  s_nop 0
  buffer_load_dwordx4 v2, s[4:7], s25 offen lds
  s_add_u32 s25, s24, 224
  s_and_b32 s25, s25, 511
  s_lshl_b32 s25, s25, 13
  s_add_u32 s25, s25, s23
  s_add_u32 m0, s22, 14336
  s_nop 0
  buffer_load_dwordx4 v2, s[4:7], s25 offen lds
  s_add_u32 s25, s24, 240
  s_and_b32 s25, s25, 511
  s_lshl_b32 s25, s25, 13
  s_add_u32 s25, s25, s23
  s_add_u32 m0, s22, 15360
  s_nop 0
  buffer_load_dwordx4 v2, s[4:7], s25 offen lds
  s_add_u32 s25, s24, 256
  s_and_b32 s25, s25, 511
  s_lshl_b32 s25, s25, 13
  s_add_u32 s25, s25, s23
  s_add_u32 m0, s22, 16384
  s_nop 0
  buffer_load_dwordx4 v2, s[4:7], s25 offen lds
  s_add_u32 s25, s24, 272
  s_and_b32 s25, s25, 511
  s_lshl_b32 s25, s25, 13
  s_add_u32 s25, s25, s23
  s_add_u32 m0, s22, 17408
  s_nop 0
  buffer_load_dwordx4 v2, s[4:7], s25 offen lds
  s_add_u32 s25, s24, 288
  s_and_b32 s25, s25, 511
  s_lshl_b32 s25, s25, 13
  s_add_u32 s25, s25, s23
  s_add_u32 m0, s22, 18432
  s_nop 0
  buffer_load_dwordx4 v2, s[4:7], s25 offen lds
  s_add_u32 s25, s24, 304
  s_and_b32 s25, s25, 511
  s_lshl_b32 s25, s25, 13
  s_add_u32 s25, s25, s23
  s_add_u32 m0, s22, 19456
  s_nop 0
  buffer_load_dwordx4 v2, s[4:7], s25 offen lds
  s_add_u32 s25, s24, 320
  s_and_b32 s25, s25, 511
  s_lshl_b32 s25, s25, 13
  s_add_u32 s25, s25, s23
  s_add_u32 m0, s22, 20480
  s_nop 0
  buffer_load_dwordx4 v2, s[4:7], s25 offen lds
  s_add_u32 s25, s24, 336
  s_and_b32 s25, s25, 511
  s_lshl_b32 s25, s25, 13
  s_add_u32 s25, s25, s23
  s_add_u32 m0, s22, 21504
  s_nop 0
  buffer_load_dwordx4 v2, s[4:7], s25 offen lds
  s_add_u32 s25, s24, 352
  s_and_b32 s25, s25, 511
  s_lshl_b32 s25, s25, 13
  s_add_u32 s25, s25, s23
  s_add_u32 m0, s22, 22528
  s_nop 0
  buffer_load_dwordx4 v2, s[4:7], s25 offen lds
  s_add_u32 s25, s24, 368
  s_and_b32 s25, s25, 511
  s_lshl_b32 s25, s25, 13
  s_add_u32 s25, s25, s23
  s_add_u32 m0, s22, 23552
  s_nop 0
  buffer_load_dwordx4 v2, s[4:7], s25 offen lds
  s_add_u32 s25, s24, 384
  s_and_b32 s25, s25, 511
  s_lshl_b32 s25, s25, 13
  s_add_u32 s25, s25, s23
  s_add_u32 m0, s22, 24576
  s_nop 0
  buffer_load_dwordx4 v2, s[4:7], s25 offen lds
  s_add_u32 s25, s24, 400
  s_and_b32 s25, s25, 511
  s_lshl_b32 s25, s25, 13
  s_add_u32 s25, s25, s23
  s_add_u32 m0, s22, 25600
  s_nop 0
  buffer_load_dwordx4 v2, s[4:7], s25 offen lds
  s_add_u32 s25, s24, 416
  s_and_b32 s25, s25, 511
  s_lshl_b32 s25, s25, 13
  s_add_u32 s25, s25, s23
  s_add_u32 m0, s22, 26624
  s_nop 0
  buffer_load_dwordx4 v2, s[4:7], s25 offen lds
  s_add_u32 s25, s24, 432
  s_and_b32 s25, s25, 511
  s_lshl_b32 s25, s25, 13
  s_add_u32 s25, s25, s23
  s_add_u32 m0, s22, 27648
  s_nop 0
  buffer_load_dwordx4 v2, s[4:7], s25 offen lds
  s_add_u32 s25, s24, 448
  s_and_b32 s25, s25, 511
  s_lshl_b32 s25, s25, 13
  s_add_u32 s25, s25, s23
  s_add_u32 m0, s22, 28672
  s_nop 0
  buffer_load_dwordx4 v2, s[4:7], s25 offen lds
  s_add_u32 s25, s24, 464
  s_and_b32 s25, s25, 511
  s_lshl_b32 s25, s25, 13
  s_add_u32 s25, s25, s23
  s_add_u32 m0, s22, 29696
  s_nop 0
  buffer_load_dwordx4 v2, s[4:7], s25 offen lds
  s_add_u32 s25, s24, 480
  s_and_b32 s25, s25, 511
  s_lshl_b32 s25, s25, 13
  s_add_u32 s25, s25, s23
  s_add_u32 m0, s22, 30720
  s_nop 0
  buffer_load_dwordx4 v2, s[4:7], s25 offen lds
  s_add_u32 s25, s24, 496
  s_and_b32 s25, s25, 511
  s_lshl_b32 s25, s25, 13
  s_add_u32 s25, s25, s23
  s_add_u32 m0, s22, 31744
  s_nop 0
  buffer_load_dwordx4 v2, s[4:7], s25 offen lds
  s_waitcnt vmcnt(30)
  ds_read_b64_tr_b16 a[0:1], v6 offset:0
  ds_read_b64_tr_b16 a[2:3], v6 offset:256
  ds_read_b64_tr_b16 a[64:65], v7 offset:0
  ds_read_b64_tr_b16 a[66:67], v7 offset:256
  s_waitcnt lgkmcnt(0)
  s_add_u32 s25, s24, 0
  s_and_b32 s25, s25, 511
  s_lshl_b32 s25, s25, 13
  s_add_u32 s25, s25, s23
  s_add_u32 m0, s22, 0
  s_nop 0
  buffer_load_dwordx4 v2, s[48:51], s25 offen lds
  s_add_u32 s25, s24, 16
  s_and_b32 s25, s25, 511
  s_lshl_b32 s25, s25, 13
  s_add_u32 s25, s25, s23
  s_add_u32 m0, s22, 1024
  s_nop 0
  buffer_load_dwordx4 v2, s[48:51], s25 offen lds
  s_waitcnt vmcnt(30)
  ds_read_b64_tr_b16 a[4:5], v6 offset:2048
  ds_read_b64_tr_b16 a[6:7], v6 offset:2304
  ds_read_b64_tr_b16 a[68:69], v7 offset:2048
  ds_read_b64_tr_b16 a[70:71], v7 offset:2304
  s_waitcnt lgkmcnt(0)
  s_add_u32 s25, s24, 32
  s_and_b32 s25, s25, 511
  s_lshl_b32 s25, s25, 13
  s_add_u32 s25, s25, s23
  s_add_u32 m0, s22, 2048
  s_nop 0
  buffer_load_dwordx4 v2, s[48:51], s25 offen lds
  s_add_u32 s25, s24, 48
  s_and_b32 s25, s25, 511
  s_lshl_b32 s25, s25, 13
  s_add_u32 s25, s25, s23
  s_add_u32 m0, s22, 3072
  s_nop 0
  buffer_load_dwordx4 v2, s[48:51], s25 offen lds
  s_waitcnt vmcnt(30)
  ds_read_b64_tr_b16 a[8:9], v6 offset:4096
  ds_read_b64_tr_b16 a[10:11], v6 offset:4352
  ds_read_b64_tr_b16 a[72:73], v7 offset:4096
  ds_read_b64_tr_b16 a[74:75], v7 offset:4352
  s_waitcnt lgkmcnt(0)
  s_add_u32 s25, s24, 64
  s_and_b32 s25, s25, 511
  s_lshl_b32 s25, s25, 13
  s_add_u32 s25, s25, s23
  s_add_u32 m0, s22, 4096
  s_nop 0
  buffer_load_dwordx4 v2, s[48:51], s25 offen lds
  s_add_u32 s25, s24, 80
  s_and_b32 s25, s25, 511
  s_lshl_b32 s25, s25, 13
  s_add_u32 s25, s25, s23
  s_add_u32 m0, s22, 5120
  s_nop 0
  buffer_load_dwordx4 v2, s[48:51], s25 offen lds
  s_waitcnt vmcnt(30)
  ds_read_b64_tr_b16 a[12:13], v6 offset:6144
  ds_read_b64_tr_b16 a[14:15], v6 offset:6400
  ds_read_b64_tr_b16 a[76:77], v7 offset:6144
  ds_read_b64_tr_b16 a[78:79], v7 offset:6400
  s_waitcnt lgkmcnt(0)
  s_add_u32 s25, s24, 96
  s_and_b32 s25, s25, 511
  s_lshl_b32 s25, s25, 13
  s_add_u32 s25, s25, s23
  s_add_u32 m0, s22, 6144
  s_nop 0
  buffer_load_dwordx4 v2, s[48:51], s25 offen lds
  s_add_u32 s25, s24, 112
  s_and_b32 s25, s25, 511
  s_lshl_b32 s25, s25, 13
  s_add_u32 s25, s25, s23
  s_add_u32 m0, s22, 7168
  s_nop 0
  buffer_load_dwordx4 v2, s[48:51], s25 offen lds
  s_waitcnt vmcnt(30)
  ds_read_b64_tr_b16 a[16:17], v6 offset:8192
  ds_read_b64_tr_b16 a[18:19], v6 offset:8448
  ds_read_b64_tr_b16 a[80:81], v7 offset:8192
  ds_read_b64_tr_b16 a[82:83], v7 offset:8448
  s_waitcnt lgkmcnt(0)
  s_add_u32 s25, s24, 128
  s_and_b32 s25, s25, 511
  s_lshl_b32 s25, s25, 13
  s_add_u32 s25, s25, s23
  s_add_u32 m0, s22, 8192
  s_nop 0
  buffer_load_dwordx4 v2, s[48:51], s25 offen lds
  s_add_u32 s25, s24, 144
  s_and_b32 s25, s25, 511
  s_lshl_b32 s25, s25, 13
  s_add_u32 s25, s25, s23
  s_add_u32 m0, s22, 9216
  s_nop 0
  buffer_load_dwordx4 v2, s[48:51], s25 offen lds
  s_waitcnt vmcnt(30)
  ds_read_b64_tr_b16 a[20:21], v6 offset:10240
  ds_read_b64_tr_b16 a[22:23], v6 offset:10496
  ds_read_b64_tr_b16 a[84:85], v7 offset:10240
  ds_read_b64_tr_b16 a[86:87], v7 offset:10496
  s_waitcnt lgkmcnt(0)
  s_add_u32 s25, s24, 160
  s_and_b32 s25, s25, 511
  s_lshl_b32 s25, s25, 13
  s_add_u32 s25, s25, s23
  s_add_u32 m0, s22, 10240
  s_nop 0
  buffer_load_dwordx4 v2, s[48:51], s25 offen lds
  s_add_u32 s25, s24, 176
  s_and_b32 s25, s25, 511
  s_lshl_b32 s25, s25, 13
  s_add_u32 s25, s25, s23
  s_add_u32 m0, s22, 11264
  s_nop 0
  buffer_load_dwordx4 v2, s[48:51], s25 offen lds
  s_waitcnt vmcnt(30)
  ds_read_b64_tr_b16 a[24:25], v6 offset:12288
  ds_read_b64_tr_b16 a[26:27], v6 offset:12544
  ds_read_b64_tr_b16 a[88:89], v7 offset:12288
  ds_read_b64_tr_b16 a[90:91], v7 offset:12544
  s_waitcnt lgkmcnt(0)
  s_add_u32 s25, s24, 192
  s_and_b32 s25, s25, 511
  s_lshl_b32 s25, s25, 13
  s_add_u32 s25, s25, s23
  s_add_u32 m0, s22, 12288
  s_nop 0
  buffer_load_dwordx4 v2, s[48:51], s25 offen lds
  s_add_u32 s25, s24, 208
  s_and_b32 s25, s25, 511
  s_lshl_b32 s25, s25, 13
  s_add_u32 s25, s25, s23
  s_add_u32 m0, s22, 13312
  s_nop 0
  buffer_load_dwordx4 v2, s[48:51], s25 offen lds
  s_waitcnt vmcnt(30)
  ds_read_b64_tr_b16 a[28:29], v6 offset:14336
  ds_read_b64_tr_b16 a[30:31], v6 offset:14592
  ds_read_b64_tr_b16 a[92:93], v7 offset:14336
  ds_read_b64_tr_b16 a[94:95], v7 offset:14592
  s_waitcnt lgkmcnt(0)
  s_add_u32 s25, s24, 224
  s_and_b32 s25, s25, 511
  s_lshl_b32 s25, s25, 13
  s_add_u32 s25, s25, s23
  s_add_u32 m0, s22, 14336
  s_nop 0
  buffer_load_dwordx4 v2, s[48:51], s25 offen lds
  s_add_u32 s25, s24, 240
  s_and_b32 s25, s25, 511
  s_lshl_b32 s25, s25, 13
  s_add_u32 s25, s25, s23
  s_add_u32 m0, s22, 15360
  s_nop 0
  buffer_load_dwordx4 v2, s[48:51], s25 offen lds
  s_waitcnt vmcnt(30)
  ds_read_b64_tr_b16 a[32:33], v6 offset:16384
  ds_read_b64_tr_b16 a[34:35], v6 offset:16640
  ds_read_b64_tr_b16 a[96:97], v7 offset:16384
  ds_read_b64_tr_b16 a[98:99], v7 offset:16640
  s_waitcnt lgkmcnt(0)
  s_add_u32 s25, s24, 256
  s_and_b32 s25, s25, 511
  s_lshl_b32 s25, s25, 13
  s_add_u32 s25, s25, s23
  s_add_u32 m0, s22, 16384
  s_nop 0
  buffer_load_dwordx4 v2, s[48:51], s25 offen lds
  s_add_u32 s25, s24, 272
  s_and_b32 s25, s25, 511
  s_lshl_b32 s25, s25, 13
  s_add_u32 s25, s25, s23
  s_add_u32 m0, s22, 17408
  s_nop 0
  buffer_load_dwordx4 v2, s[48:51], s25 offen lds
  s_waitcnt vmcnt(30)
  ds_read_b64_tr_b16 a[36:37], v6 offset:18432
  ds_read_b64_tr_b16 a[38:39], v6 offset:18688
  ds_read_b64_tr_b16 a[100:101], v7 offset:18432
  ds_read_b64_tr_b16 a[102:103], v7 offset:18688
  s_waitcnt lgkmcnt(0)
  s_add_u32 s25, s24, 288
  s_and_b32 s25, s25, 511
  s_lshl_b32 s25, s25, 13
  s_add_u32 s25, s25, s23
  s_add_u32 m0, s22, 18432
  s_nop 0
  buffer_load_dwordx4 v2, s[48:51], s25 offen lds
  s_add_u32 s25, s24, 304
  s_and_b32 s25, s25, 511
  s_lshl_b32 s25, s25, 13
  s_add_u32 s25, s25, s23
  s_add_u32 m0, s22, 19456
  s_nop 0
  buffer_load_dwordx4 v2, s[48:51], s25 offen lds
  s_waitcnt vmcnt(30)
  ds_read_b64_tr_b16 a[40:41], v6 offset:20480
  ds_read_b64_tr_b16 a[42:43], v6 offset:20736
  ds_read_b64_tr_b16 a[104:105], v7 offset:20480
  ds_read_b64_tr_b16 a[106:107], v7 offset:20736
  s_waitcnt lgkmcnt(0)
  s_add_u32 s25, s24, 320
  s_and_b32 s25, s25, 511
  s_lshl_b32 s25, s25, 13
  s_add_u32 s25, s25, s23
  s_add_u32 m0, s22, 20480
  s_nop 0
  buffer_load_dwordx4 v2, s[48:51], s25 offen lds
  s_add_u32 s25, s24, 336
  s_and_b32 s25, s25, 511
  s_lshl_b32 s25, s25, 13
  s_add_u32 s25, s25, s23
  s_add_u32 m0, s22, 21504
  s_nop 0
  buffer_load_dwordx4 v2, s[48:51], s25 offen lds
  s_waitcnt vmcnt(30)
  ds_read_b64_tr_b16 a[44:45], v6 offset:22528
  ds_read_b64_tr_b16 a[46:47], v6 offset:22784
  ds_read_b64_tr_b16 a[108:109], v7 offset:22528
  ds_read_b64_tr_b16 a[110:111], v7 offset:22784
  s_waitcnt lgkmcnt(0)
  s_add_u32 s25, s24, 352
  s_and_b32 s25, s25, 511
  s_lshl_b32 s25, s25, 13
  s_add_u32 s25, s25, s23
  s_add_u32 m0, s22, 22528
  s_nop 0
  buffer_load_dwordx4 v2, s[48:51], s25 offen lds
  s_add_u32 s25, s24, 368
  s_and_b32 s25, s25, 511
  s_lshl_b32 s25, s25, 13
  s_add_u32 s25, s25, s23
  s_add_u32 m0, s22, 23552
  s_nop 0
  buffer_load_dwordx4 v2, s[48:51], s25 offen lds
  s_waitcnt vmcnt(30)
  ds_read_b64_tr_b16 a[48:49], v6 offset:24576
  ds_read_b64_tr_b16 a[50:51], v6 offset:24832
  ds_read_b64_tr_b16 a[112:113], v7 offset:24576
  ds_read_b64_tr_b16 a[114:115], v7 offset:24832
  s_waitcnt lgkmcnt(0)
  s_add_u32 s25, s24, 384
  s_and_b32 s25, s25, 511
  s_lshl_b32 s25, s25, 13
  s_add_u32 s25, s25, s23
  s_add_u32 m0, s22, 24576
  s_nop 0
  buffer_load_dwordx4 v2, s[48:51], s25 offen lds
  s_add_u32 s25, s24, 400
  s_and_b32 s25, s25, 511
  s_lshl_b32 s25, s25, 13
  s_add_u32 s25, s25, s23
  s_add_u32 m0, s22, 25600
  s_nop 0
  buffer_load_dwordx4 v2, s[48:51], s25 offen lds
  s_waitcnt vmcnt(30)
  ds_read_b64_tr_b16 a[52:53], v6 offset:26624
  ds_read_b64_tr_b16 a[54:55], v6 offset:26880
  ds_read_b64_tr_b16 a[116:117], v7 offset:26624
  ds_read_b64_tr_b16 a[118:119], v7 offset:26880
  s_waitcnt lgkmcnt(0)
  s_add_u32 s25, s24, 416
  s_and_b32 s25, s25, 511
  s_lshl_b32 s25, s25, 13
  s_add_u32 s25, s25, s23
  s_add_u32 m0, s22, 26624
  s_nop 0
  buffer_load_dwordx4 v2, s[48:51], s25 offen lds
  s_add_u32 s25, s24, 432
  s_and_b32 s25, s25, 511
  s_lshl_b32 s25, s25, 13
  s_add_u32 s25, s25, s23
  s_add_u32 m0, s22, 27648
  s_nop 0
  buffer_load_dwordx4 v2, s[48:51], s25 offen lds
  s_waitcnt vmcnt(30)
  ds_read_b64_tr_b16 a[56:57], v6 offset:28672
  ds_read_b64_tr_b16 a[58:59], v6 offset:28928
  ds_read_b64_tr_b16 a[120:121], v7 offset:28672
  ds_read_b64_tr_b16 a[122:123], v7 offset:28928
  s_waitcnt lgkmcnt(0)
  s_add_u32 s25, s24, 448
  s_and_b32 s25, s25, 511
  s_lshl_b32 s25, s25, 13
  s_add_u32 s25, s25, s23
  s_add_u32 m0, s22, 28672
  s_nop 0
  buffer_load_dwordx4 v2, s[48:51], s25 offen lds
  s_add_u32 s25, s24, 464
  s_and_b32 s25, s25, 511
  s_lshl_b32 s25, s25, 13
  s_add_u32 s25, s25, s23
  s_add_u32 m0, s22, 29696
  s_nop 0
  buffer_load_dwordx4 v2, s[48:51], s25 offen lds
  s_waitcnt vmcnt(30)
  ds_read_b64_tr_b16 a[60:61], v6 offset:30720
  ds_read_b64_tr_b16 a[62:63], v6 offset:30976
  ds_read_b64_tr_b16 a[124:125], v7 offset:30720
  ds_read_b64_tr_b16 a[126:127], v7 offset:30976
  s_waitcnt lgkmcnt(0)
  s_add_u32 s25, s24, 480
  s_and_b32 s25, s25, 511
  s_lshl_b32 s25, s25, 13
  s_add_u32 s25, s25, s23
  s_add_u32 m0, s22, 30720
  s_nop 0
  buffer_load_dwordx4 v2, s[48:51], s25 offen lds
  s_add_u32 s25, s24, 496
  s_and_b32 s25, s25, 511
  s_lshl_b32 s25, s25, 13
  s_add_u32 s25, s25, s23
  s_add_u32 m0, s22, 31744
  s_nop 0
  buffer_load_dwordx4 v2, s[48:51], s25 offen lds
  s_waitcnt vmcnt(30)
  ds_read_b64_tr_b16 a[128:129], v6 offset:0
  ds_read_b64_tr_b16 a[130:131], v6 offset:256
  ds_read_b64_tr_b16 a[192:193], v7 offset:0
  ds_read_b64_tr_b16 a[194:195], v7 offset:256
  s_waitcnt lgkmcnt(0)
  s_add_u32 s25, s24, 0
  s_and_b32 s25, s25, 511
  s_lshl_b32 s25, s25, 13
  s_add_u32 s25, s25, s23
  s_add_u32 m0, s22, 0
  s_nop 0
  buffer_load_dwordx4 v2, s[52:55], s25 offen lds
  s_add_u32 s25, s24, 16
  s_and_b32 s25, s25, 511
  s_lshl_b32 s25, s25, 13
  s_add_u32 s25, s25, s23
  s_add_u32 m0, s22, 1024
  s_nop 0
  buffer_load_dwordx4 v2, s[52:55], s25 offen lds
  s_waitcnt vmcnt(30)
  ds_read_b64_tr_b16 a[132:133], v6 offset:2048
  ds_read_b64_tr_b16 a[134:135], v6 offset:2304
  ds_read_b64_tr_b16 a[196:197], v7 offset:2048
  ds_read_b64_tr_b16 a[198:199], v7 offset:2304
  s_waitcnt lgkmcnt(0)
  s_add_u32 s25, s24, 32
  s_and_b32 s25, s25, 511
  s_lshl_b32 s25, s25, 13
  s_add_u32 s25, s25, s23
  s_add_u32 m0, s22, 2048
  s_nop 0
  buffer_load_dwordx4 v2, s[52:55], s25 offen lds
  s_add_u32 s25, s24, 48
  s_and_b32 s25, s25, 511
  s_lshl_b32 s25, s25, 13
  s_add_u32 s25, s25, s23
  s_add_u32 m0, s22, 3072
  s_nop 0
  buffer_load_dwordx4 v2, s[52:55], s25 offen lds
  s_waitcnt vmcnt(30)
  ds_read_b64_tr_b16 a[136:137], v6 offset:4096
  ds_read_b64_tr_b16 a[138:139], v6 offset:4352
  ds_read_b64_tr_b16 a[200:201], v7 offset:4096
  ds_read_b64_tr_b16 a[202:203], v7 offset:4352
  s_waitcnt lgkmcnt(0)
  s_add_u32 s25, s24, 64
  s_and_b32 s25, s25, 511
  s_lshl_b32 s25, s25, 13
  s_add_u32 s25, s25, s23
  s_add_u32 m0, s22, 4096
  s_nop 0
  buffer_load_dwordx4 v2, s[52:55], s25 offen lds
  s_add_u32 s25, s24, 80
  s_and_b32 s25, s25, 511
  s_lshl_b32 s25, s25, 13
  s_add_u32 s25, s25, s23
  s_add_u32 m0, s22, 5120
  s_nop 0
  buffer_load_dwordx4 v2, s[52:55], s25 offen lds
  s_waitcnt vmcnt(30)
  ds_read_b64_tr_b16 a[140:141], v6 offset:6144
  ds_read_b64_tr_b16 a[142:143], v6 offset:6400
  ds_read_b64_tr_b16 a[204:205], v7 offset:6144
  ds_read_b64_tr_b16 a[206:207], v7 offset:6400
  s_waitcnt lgkmcnt(0)
  s_add_u32 s25, s24, 96
  s_and_b32 s25, s25, 511
  s_lshl_b32 s25, s25, 13
  s_add_u32 s25, s25, s23
  s_add_u32 m0, s22, 6144
  s_nop 0
  buffer_load_dwordx4 v2, s[52:55], s25 offen lds
  s_add_u32 s25, s24, 112
  s_and_b32 s25, s25, 511
  s_lshl_b32 s25, s25, 13
  s_add_u32 s25, s25, s23
  s_add_u32 m0, s22, 7168
  s_nop 0
  buffer_load_dwordx4 v2, s[52:55], s25 offen lds
  s_waitcnt vmcnt(30)
  ds_read_b64_tr_b16 a[144:145], v6 offset:8192
  ds_read_b64_tr_b16 a[146:147], v6 offset:8448
  ds_read_b64_tr_b16 a[208:209], v7 offset:8192
  ds_read_b64_tr_b16 a[210:211], v7 offset:8448
  s_waitcnt lgkmcnt(0)
  s_add_u32 s25, s24, 128
  s_and_b32 s25, s25, 511
  s_lshl_b32 s25, s25, 13
  s_add_u32 s25, s25, s23
  s_add_u32 m0, s22, 8192
  s_nop 0
  buffer_load_dwordx4 v2, s[52:55], s25 offen lds
  s_add_u32 s25, s24, 144
  s_and_b32 s25, s25, 511
  s_lshl_b32 s25, s25, 13
  s_add_u32 s25, s25, s23
  s_add_u32 m0, s22, 9216
  s_nop 0
  buffer_load_dwordx4 v2, s[52:55], s25 offen lds
  s_waitcnt vmcnt(30)
  ds_read_b64_tr_b16 a[148:149], v6 offset:10240
  ds_read_b64_tr_b16 a[150:151], v6 offset:10496
  ds_read_b64_tr_b16 a[212:213], v7 offset:10240
  ds_read_b64_tr_b16 a[214:215], v7 offset:10496
  s_waitcnt lgkmcnt(0)
  s_add_u32 s25, s24, 160
  s_and_b32 s25, s25, 511
  s_lshl_b32 s25, s25, 13
  s_add_u32 s25, s25, s23
  s_add_u32 m0, s22, 10240
  s_nop 0
  buffer_load_dwordx4 v2, s[52:55], s25 offen lds
  s_add_u32 s25, s24, 176
  s_and_b32 s25, s25, 511
  s_lshl_b32 s25, s25, 13
  s_add_u32 s25, s25, s23
  s_add_u32 m0, s22, 11264
  s_nop 0
  buffer_load_dwordx4 v2, s[52:55], s25 offen lds
  s_waitcnt vmcnt(30)
  ds_read_b64_tr_b16 a[152:153], v6 offset:12288
  ds_read_b64_tr_b16 a[154:155], v6 offset:12544
  ds_read_b64_tr_b16 a[216:217], v7 offset:12288
  ds_read_b64_tr_b16 a[218:219], v7 offset:12544
  s_waitcnt lgkmcnt(0)
  s_add_u32 s25, s24, 192
  s_and_b32 s25, s25, 511
  s_lshl_b32 s25, s25, 13
  s_add_u32 s25, s25, s23
  s_add_u32 m0, s22, 12288
  s_nop 0
  buffer_load_dwordx4 v2, s[52:55], s25 offen lds
  s_add_u32 s25, s24, 208
  s_and_b32 s25, s25, 511
  s_lshl_b32 s25, s25, 13
  s_add_u32 s25, s25, s23
  s_add_u32 m0, s22, 13312
  s_nop 0
  buffer_load_dwordx4 v2, s[52:55], s25 offen lds
  s_waitcnt vmcnt(30)
  ds_read_b64_tr_b16 a[156:157], v6 offset:14336
  ds_read_b64_tr_b16 a[158:159], v6 offset:14592
  ds_read_b64_tr_b16 a[220:221], v7 offset:14336
  ds_read_b64_tr_b16 a[222:223], v7 offset:14592
  s_waitcnt lgkmcnt(0)
  s_add_u32 s25, s24, 224
  s_and_b32 s25, s25, 511
  s_lshl_b32 s25, s25, 13
  s_add_u32 s25, s25, s23
  s_add_u32 m0, s22, 14336
  s_nop 0
  buffer_load_dwordx4 v2, s[52:55], s25 offen lds
  s_add_u32 s25, s24, 240
  s_and_b32 s25, s25, 511
  s_lshl_b32 s25, s25, 13
  s_add_u32 s25, s25, s23
  s_add_u32 m0, s22, 15360
  s_nop 0
  buffer_load_dwordx4 v2, s[52:55], s25 offen lds
  s_waitcnt vmcnt(30)
  ds_read_b64_tr_b16 a[160:161], v6 offset:16384
  ds_read_b64_tr_b16 a[162:163], v6 offset:16640
  ds_read_b64_tr_b16 a[224:225], v7 offset:16384
  ds_read_b64_tr_b16 a[226:227], v7 offset:16640
  s_waitcnt lgkmcnt(0)
  s_add_u32 s25, s24, 256
  s_and_b32 s25, s25, 511
  s_lshl_b32 s25, s25, 13
  s_add_u32 s25, s25, s23
  s_add_u32 m0, s22, 16384
  s_nop 0
  buffer_load_dwordx4 v2, s[52:55], s25 offen lds
  s_add_u32 s25, s24, 272
  s_and_b32 s25, s25, 511
  s_lshl_b32 s25, s25, 13
  s_add_u32 s25, s25, s23
  s_add_u32 m0, s22, 17408
  s_nop 0
  buffer_load_dwordx4 v2, s[52:55], s25 offen lds
  s_waitcnt vmcnt(30)
  ds_read_b64_tr_b16 a[164:165], v6 offset:18432
  ds_read_b64_tr_b16 a[166:167], v6 offset:18688
  ds_read_b64_tr_b16 a[228:229], v7 offset:18432
  ds_read_b64_tr_b16 a[230:231], v7 offset:18688
  s_waitcnt lgkmcnt(0)
  s_add_u32 s25, s24, 288
  s_and_b32 s25, s25, 511
  s_lshl_b32 s25, s25, 13
  s_add_u32 s25, s25, s23
  s_add_u32 m0, s22, 18432
  s_nop 0
  buffer_load_dwordx4 v2, s[52:55], s25 offen lds
  s_add_u32 s25, s24, 304
  s_and_b32 s25, s25, 511
  s_lshl_b32 s25, s25, 13
  s_add_u32 s25, s25, s23
  s_add_u32 m0, s22, 19456
  s_nop 0
  buffer_load_dwordx4 v2, s[52:55], s25 offen lds
  s_waitcnt vmcnt(30)
  ds_read_b64_tr_b16 a[168:169], v6 offset:20480
  ds_read_b64_tr_b16 a[170:171], v6 offset:20736
  ds_read_b64_tr_b16 a[232:233], v7 offset:20480
  ds_read_b64_tr_b16 a[234:235], v7 offset:20736
  s_waitcnt lgkmcnt(0)
  s_add_u32 s25, s24, 320
  s_and_b32 s25, s25, 511
  s_lshl_b32 s25, s25, 13
  s_add_u32 s25, s25, s23
  s_add_u32 m0, s22, 20480
  s_nop 0
  buffer_load_dwordx4 v2, s[52:55], s25 offen lds
  s_add_u32 s25, s24, 336
  s_and_b32 s25, s25, 511
  s_lshl_b32 s25, s25, 13
  s_add_u32 s25, s25, s23
  s_add_u32 m0, s22, 21504
  s_nop 0
  buffer_load_dwordx4 v2, s[52:55], s25 offen lds
  s_waitcnt vmcnt(30)
  ds_read_b64_tr_b16 a[172:173], v6 offset:22528
  ds_read_b64_tr_b16 a[174:175], v6 offset:22784
  ds_read_b64_tr_b16 a[236:237], v7 offset:22528
  ds_read_b64_tr_b16 a[238:239], v7 offset:22784
  s_waitcnt lgkmcnt(0)
  s_add_u32 s25, s24, 352
  s_and_b32 s25, s25, 511
  s_lshl_b32 s25, s25, 13
  s_add_u32 s25, s25, s23
  s_add_u32 m0, s22, 22528
  s_nop 0
  buffer_load_dwordx4 v2, s[52:55], s25 offen lds
  s_add_u32 s25, s24, 368
  s_and_b32 s25, s25, 511
  s_lshl_b32 s25, s25, 13
  s_add_u32 s25, s25, s23
  s_add_u32 m0, s22, 23552
  s_nop 0
  buffer_load_dwordx4 v2, s[52:55], s25 offen lds
  s_waitcnt vmcnt(30)
  ds_read_b64_tr_b16 a[176:177], v6 offset:24576
  ds_read_b64_tr_b16 a[178:179], v6 offset:24832
  ds_read_b64_tr_b16 a[240:241], v7 offset:24576
  ds_read_b64_tr_b16 a[242:243], v7 offset:24832
  s_waitcnt lgkmcnt(0)
  s_add_u32 s25, s24, 384
  s_and_b32 s25, s25, 511
  s_lshl_b32 s25, s25, 13
  s_add_u32 s25, s25, s23
  s_add_u32 m0, s22, 24576
  s_nop 0
  buffer_load_dwordx4 v2, s[52:55], s25 offen lds
  s_add_u32 s25, s24, 400
  s_and_b32 s25, s25, 511
  s_lshl_b32 s25, s25, 13
  s_add_u32 s25, s25, s23
  s_add_u32 m0, s22, 25600
  s_nop 0
  buffer_load_dwordx4 v2, s[52:55], s25 offen lds
  s_waitcnt vmcnt(30)
  ds_read_b64_tr_b16 a[180:181], v6 offset:26624
  ds_read_b64_tr_b16 a[182:183], v6 offset:26880
  ds_read_b64_tr_b16 a[244:245], v7 offset:26624
  ds_read_b64_tr_b16 a[246:247], v7 offset:26880
  s_waitcnt lgkmcnt(0)
  s_add_u32 s25, s24, 416
  s_and_b32 s25, s25, 511
  s_lshl_b32 s25, s25, 13
  s_add_u32 s25, s25, s23
  s_add_u32 m0, s22, 26624
  s_nop 0
  buffer_load_dwordx4 v2, s[52:55], s25 offen lds
  s_add_u32 s25, s24, 432
  s_and_b32 s25, s25, 511
  s_lshl_b32 s25, s25, 13
  s_add_u32 s25, s25, s23
  s_add_u32 m0, s22, 27648
  s_nop 0
  buffer_load_dwordx4 v2, s[52:55], s25 offen lds
  s_waitcnt vmcnt(30)
  ds_read_b64_tr_b16 a[184:185], v6 offset:28672
  ds_read_b64_tr_b16 a[186:187], v6 offset:28928
  ds_read_b64_tr_b16 a[248:249], v7 offset:28672
  ds_read_b64_tr_b16 a[250:251], v7 offset:28928
  s_waitcnt lgkmcnt(0)
  s_add_u32 s25, s24, 448
  s_and_b32 s25, s25, 511
  s_lshl_b32 s25, s25, 13
  s_add_u32 s25, s25, s23
  s_add_u32 m0, s22, 28672
  s_nop 0
  buffer_load_dwordx4 v2, s[52:55], s25 offen lds
  s_add_u32 s25, s24, 464
  s_and_b32 s25, s25, 511
  s_lshl_b32 s25, s25, 13
  s_add_u32 s25, s25, s23
  s_add_u32 m0, s22, 29696
  s_nop 0
  buffer_load_dwordx4 v2, s[52:55], s25 offen lds
  s_waitcnt vmcnt(30)
  ds_read_b64_tr_b16 a[188:189], v6 offset:30720
  ds_read_b64_tr_b16 a[190:191], v6 offset:30976
  ds_read_b64_tr_b16 a[252:253], v7 offset:30720
  ds_read_b64_tr_b16 a[254:255], v7 offset:30976
  s_waitcnt lgkmcnt(0)
  s_add_u32 s25, s24, 480
  s_and_b32 s25, s25, 511
  s_lshl_b32 s25, s25, 13
  s_add_u32 s25, s25, s23
  s_add_u32 m0, s22, 30720
  s_nop 0
  buffer_load_dwordx4 v2, s[52:55], s25 offen lds
  s_add_u32 s25, s24, 496
  s_and_b32 s25, s25, 511
  s_lshl_b32 s25, s25, 13
  s_add_u32 s25, s25, s23
  s_add_u32 m0, s22, 31744
  s_nop 0
  buffer_load_dwordx4 v2, s[52:55], s25 offen lds
  s_waitcnt vmcnt(30)
  ds_read_b64_tr_b16 v[128:129], v6 offset:0
  ds_read_b64_tr_b16 v[130:131], v6 offset:256
  ds_read_b64_tr_b16 v[192:193], v7 offset:0
  ds_read_b64_tr_b16 v[194:195], v7 offset:256
  s_waitcnt lgkmcnt(0)
  s_waitcnt vmcnt(28)
  ds_read_b64_tr_b16 v[132:133], v6 offset:2048
  ds_read_b64_tr_b16 v[134:135], v6 offset:2304
  ds_read_b64_tr_b16 v[196:197], v7 offset:2048
  ds_read_b64_tr_b16 v[198:199], v7 offset:2304
  s_waitcnt lgkmcnt(0)
  s_waitcnt vmcnt(26)
  ds_read_b64_tr_b16 v[136:137], v6 offset:4096
  ds_read_b64_tr_b16 v[138:139], v6 offset:4352
  ds_read_b64_tr_b16 v[200:201], v7 offset:4096
  ds_read_b64_tr_b16 v[202:203], v7 offset:4352
  s_waitcnt lgkmcnt(0)
  s_waitcnt vmcnt(24)
  ds_read_b64_tr_b16 v[140:141], v6 offset:6144
  ds_read_b64_tr_b16 v[142:143], v6 offset:6400
  ds_read_b64_tr_b16 v[204:205], v7 offset:6144
  ds_read_b64_tr_b16 v[206:207], v7 offset:6400
  s_waitcnt lgkmcnt(0)
  s_waitcnt vmcnt(22)
  ds_read_b64_tr_b16 v[144:145], v6 offset:8192
  ds_read_b64_tr_b16 v[146:147], v6 offset:8448
  ds_read_b64_tr_b16 v[208:209], v7 offset:8192
  ds_read_b64_tr_b16 v[210:211], v7 offset:8448
  s_waitcnt lgkmcnt(0)
  s_waitcnt vmcnt(20)
  ds_read_b64_tr_b16 v[148:149], v6 offset:10240
  ds_read_b64_tr_b16 v[150:151], v6 offset:10496
  ds_read_b64_tr_b16 v[212:213], v7 offset:10240
  ds_read_b64_tr_b16 v[214:215], v7 offset:10496
  s_waitcnt lgkmcnt(0)
  s_waitcnt vmcnt(18)
  ds_read_b64_tr_b16 v[152:153], v6 offset:12288
  ds_read_b64_tr_b16 v[154:155], v6 offset:12544
  ds_read_b64_tr_b16 v[216:217], v7 offset:12288
  ds_read_b64_tr_b16 v[218:219], v7 offset:12544
  s_waitcnt lgkmcnt(0)
  s_waitcnt vmcnt(16)
  ds_read_b64_tr_b16 v[156:157], v6 offset:14336
  ds_read_b64_tr_b16 v[158:159], v6 offset:14592
  ds_read_b64_tr_b16 v[220:221], v7 offset:14336
  ds_read_b64_tr_b16 v[222:223], v7 offset:14592
  s_waitcnt lgkmcnt(0)
  s_waitcnt vmcnt(14)
  ds_read_b64_tr_b16 v[160:161], v6 offset:16384
  ds_read_b64_tr_b16 v[162:163], v6 offset:16640
  ds_read_b64_tr_b16 v[224:225], v7 offset:16384
  ds_read_b64_tr_b16 v[226:227], v7 offset:16640
  s_waitcnt lgkmcnt(0)
  s_waitcnt vmcnt(12)
  ds_read_b64_tr_b16 v[164:165], v6 offset:18432
  ds_read_b64_tr_b16 v[166:167], v6 offset:18688
  ds_read_b64_tr_b16 v[228:229], v7 offset:18432
  ds_read_b64_tr_b16 v[230:231], v7 offset:18688
  s_waitcnt lgkmcnt(0)
  s_waitcnt vmcnt(10)
  ds_read_b64_tr_b16 v[168:169], v6 offset:20480
  ds_read_b64_tr_b16 v[170:171], v6 offset:20736
  ds_read_b64_tr_b16 v[232:233], v7 offset:20480
  ds_read_b64_tr_b16 v[234:235], v7 offset:20736
  s_waitcnt lgkmcnt(0)
  s_waitcnt vmcnt(8)
  ds_read_b64_tr_b16 v[172:173], v6 offset:22528
  ds_read_b64_tr_b16 v[174:175], v6 offset:22784
  ds_read_b64_tr_b16 v[236:237], v7 offset:22528
  ds_read_b64_tr_b16 v[238:239], v7 offset:22784
  s_waitcnt lgkmcnt(0)
  s_waitcnt vmcnt(6)
  ds_read_b64_tr_b16 v[176:177], v6 offset:24576
  ds_read_b64_tr_b16 v[178:179], v6 offset:24832
  ds_read_b64_tr_b16 v[240:241], v7 offset:24576
  ds_read_b64_tr_b16 v[242:243], v7 offset:24832
  s_waitcnt lgkmcnt(0)
  s_waitcnt vmcnt(4)
  ds_read_b64_tr_b16 v[180:181], v6 offset:26624
  ds_read_b64_tr_b16 v[182:183], v6 offset:26880
  ds_read_b64_tr_b16 v[244:245], v7 offset:26624
  ds_read_b64_tr_b16 v[246:247], v7 offset:26880
  s_waitcnt lgkmcnt(0)
  s_waitcnt vmcnt(2)
  ds_read_b64_tr_b16 v[184:185], v6 offset:28672
  ds_read_b64_tr_b16 v[186:187], v6 offset:28928
  ds_read_b64_tr_b16 v[248:249], v7 offset:28672
  ds_read_b64_tr_b16 v[250:251], v7 offset:28928
  s_waitcnt lgkmcnt(0)
  s_waitcnt vmcnt(0)
  ds_read_b64_tr_b16 v[188:189], v6 offset:30720
  ds_read_b64_tr_b16 v[190:191], v6 offset:30976
  ds_read_b64_tr_b16 v[252:253], v7 offset:30720
  ds_read_b64_tr_b16 v[254:255], v7 offset:30976
  s_waitcnt lgkmcnt(0)
  s_load_dwordx2 s[4:5], s[0:1], 0
  s_waitcnt lgkmcnt(0)
  s_mov_b32 s6, 2097152
  s_mov_b32 s7, 0x20000
L_clr_t1:
  v_mov_b32 v2, 64
  buffer_load_dword v2, v2, s[12:15], 0 offen sc1
  s_waitcnt vmcnt(0)
  v_cmp_eq_u32 vcc, 0, v2
  s_add_u32 s19, s19, 1
  s_cmp_lt_u32 s19, 2097152
  s_cselect_b64 s[20:21], -1, 0
  s_and_b64 vcc, vcc, s[20:21]
  s_cbranch_vccnz L_clr_t1
  s_barrier
  v_and_b32 v2, 15, v0
  v_lshlrev_b32 v2, 10, v2
  v_lshrrev_b32 v3, 4, v0
  v_lshl_add_u32 v8, v3, 4, v2
  v_lshlrev_b32 v9, 4, v0
  s_mov_b32 s32, 0
  s_mov_b32 s33, -1
  s_mov_b32 s36, -1
  s_lshl_b32 s20, s31, 15
  s_lshl_b32 s21, s16, 8
  s_add_u32 s20, s20, s21
  s_lshl_b32 s21, s16, 12
  s_add_u32 s21, s21, s32
  s_add_u32 s22, s20, 0
  s_add_u32 m0, s21, 0
  s_nop 0
  buffer_load_dwordx4 v8, s[4:7], s22 offen lds
  s_add_u32 s22, s20, 64
  s_add_u32 m0, s21, 1024
  s_nop 0
  buffer_load_dwordx4 v8, s[4:7], s22 offen lds
  s_add_u32 s22, s20, 128
  s_add_u32 m0, s21, 2048
  s_nop 0
  buffer_load_dwordx4 v8, s[4:7], s22 offen lds
  s_add_u32 s22, s20, 192
  s_add_u32 m0, s21, 3072
  s_nop 0
  buffer_load_dwordx4 v8, s[4:7], s22 offen lds
  s_add_u32 s22, s20, 16384
  s_add_u32 m0, s21, 16384
  s_nop 0
  buffer_load_dwordx4 v8, s[4:7], s22 offen lds
  s_add_u32 s22, s20, 16448
  s_add_u32 m0, s21, 17408
  s_nop 0
  buffer_load_dwordx4 v8, s[4:7], s22 offen lds
  s_add_u32 s22, s20, 16512
  s_add_u32 m0, s21, 18432
  s_nop 0
  buffer_load_dwordx4 v8, s[4:7], s22 offen lds
  s_add_u32 s22, s20, 16576
  s_add_u32 m0, s21, 19456
  s_nop 0
  buffer_load_dwordx4 v8, s[4:7], s22 offen lds
  s_waitcnt vmcnt(0)
L_t1_loop:
  s_waitcnt vmcnt(6)
  s_barrier
  s_cmp_lt_i32 s33, 0
  s_cbranch_scc1 L_t1_noflag
  s_lshl_b32 s20, s17, 8
  s_lshl_b32 s21, s33, 2
  s_add_u32 s20, s20, s21
  s_add_u32 s20, s20, 0
  v_mov_b32 v2, 0
  v_mov_b32 v3, 1
  s_cmp_eq_u32 s16, 0
  s_cselect_b64 exec, 1, 0
  buffer_store_dword v3, v2, s[8:11], s20 offen sc1
  s_mov_b64 exec, -1
L_t1_noflag:
  s_add_u32 s34, s31, 7
  s_xor_b32 s35, s32, 32768
  s_cmp_lt_u32 s34, 64
  s_cbranch_scc0 L_t1_nodma
  s_lshl_b32 s20, s34, 15
  s_lshl_b32 s21, s16, 8
  s_add_u32 s20, s20, s21
  s_lshl_b32 s21, s16, 12
  s_add_u32 s21, s21, s35
  s_add_u32 s22, s20, 0
  s_add_u32 m0, s21, 0
  s_nop 0
  buffer_load_dwordx4 v8, s[4:7], s22 offen lds
  s_add_u32 s22, s20, 64
  s_add_u32 m0, s21, 1024
  s_nop 0
  buffer_load_dwordx4 v8, s[4:7], s22 offen lds
  s_add_u32 s22, s20, 128
  s_add_u32 m0, s21, 2048
  s_nop 0
  buffer_load_dwordx4 v8, s[4:7], s22 offen lds
  s_add_u32 s22, s20, 192
  s_add_u32 m0, s21, 3072
  s_nop 0
  buffer_load_dwordx4 v8, s[4:7], s22 offen lds
  s_add_u32 s22, s20, 16384
  s_add_u32 m0, s21, 16384
  s_nop 0
  buffer_load_dwordx4 v8, s[4:7], s22 offen lds
  s_add_u32 s22, s20, 16448
  s_add_u32 m0, s21, 17408
  s_nop 0
  buffer_load_dwordx4 v8, s[4:7], s22 offen lds
  s_add_u32 s22, s20, 16512
  s_add_u32 m0, s21, 18432
  s_nop 0
  buffer_load_dwordx4 v8, s[4:7], s22 offen lds
  s_add_u32 s22, s20, 16576
  s_add_u32 m0, s21, 19456
  s_nop 0
  buffer_load_dwordx4 v8, s[4:7], s22 offen lds
L_t1_nodma:
  v_add_u32 v10, s32, v9
  ds_read_b128 v[64:67], v10 offset:0
  ds_read_b128 v[68:71], v10 offset:16384
  ds_read_b128 v[72:75], v10 offset:1024
  ds_read_b128 v[76:79], v10 offset:17408
  s_waitcnt lgkmcnt(2)
  v_mfma_f32_16x16x32_bf16 v[16:19], a[0:3], v[64:67], 0
  v_mfma_f32_16x16x32_bf16 v[32:35], a[128:131], v[64:67], 0
  v_mfma_f32_16x16x32_bf16 v[48:51], v[64:67], v[128:131], 0
  v_mfma_f32_16x16x32_bf16 v[20:23], a[0:3], v[68:71], 0
  v_mfma_f32_16x16x32_bf16 v[36:39], a[128:131], v[68:71], 0
  v_mfma_f32_16x16x32_bf16 v[52:55], v[68:71], v[128:131], 0
  v_mfma_f32_16x16x32_bf16 v[24:27], a[64:67], v[64:67], 0
  v_mfma_f32_16x16x32_bf16 v[40:43], a[192:195], v[64:67], 0
  v_mfma_f32_16x16x32_bf16 v[56:59], v[64:67], v[192:195], 0
  v_mfma_f32_16x16x32_bf16 v[28:31], a[64:67], v[68:71], 0
  v_mfma_f32_16x16x32_bf16 v[44:47], a[192:195], v[68:71], 0
  v_mfma_f32_16x16x32_bf16 v[60:63], v[68:71], v[192:195], 0
  ds_read_b128 v[64:67], v10 offset:2048
  ds_read_b128 v[68:71], v10 offset:18432
  s_waitcnt lgkmcnt(2)
  v_mfma_f32_16x16x32_bf16 v[16:19], a[4:7], v[72:75], v[16:19]
  v_mfma_f32_16x16x32_bf16 v[32:35], a[132:135], v[72:75], v[32:35]
  v_mfma_f32_16x16x32_bf16 v[48:51], v[72:75], v[132:135], v[48:51]
  v_mfma_f32_16x16x32_bf16 v[20:23], a[4:7], v[76:79], v[20:23]
  v_mfma_f32_16x16x32_bf16 v[36:39], a[132:135], v[76:79], v[36:39]
  v_mfma_f32_16x16x32_bf16 v[52:55], v[76:79], v[132:135], v[52:55]
  v_mfma_f32_16x16x32_bf16 v[24:27], a[68:71], v[72:75], v[24:27]
  v_mfma_f32_16x16x32_bf16 v[40:43], a[196:199], v[72:75], v[40:43]
  v_mfma_f32_16x16x32_bf16 v[56:59], v[72:75], v[196:199], v[56:59]
  v_mfma_f32_16x16x32_bf16 v[28:31], a[68:71], v[76:79], v[28:31]
  v_mfma_f32_16x16x32_bf16 v[44:47], a[196:199], v[76:79], v[44:47]
  v_mfma_f32_16x16x32_bf16 v[60:63], v[76:79], v[196:199], v[60:63]
  ds_read_b128 v[72:75], v10 offset:3072
  ds_read_b128 v[76:79], v10 offset:19456
  s_waitcnt lgkmcnt(2)
  v_mfma_f32_16x16x32_bf16 v[16:19], a[8:11], v[64:67], v[16:19]
  v_mfma_f32_16x16x32_bf16 v[32:35], a[136:139], v[64:67], v[32:35]
  v_mfma_f32_16x16x32_bf16 v[48:51], v[64:67], v[136:139], v[48:51]
  v_mfma_f32_16x16x32_bf16 v[20:23], a[8:11], v[68:71], v[20:23]
  v_mfma_f32_16x16x32_bf16 v[36:39], a[136:139], v[68:71], v[36:39]
  v_mfma_f32_16x16x32_bf16 v[52:55], v[68:71], v[136:139], v[52:55]
  v_mfma_f32_16x16x32_bf16 v[24:27], a[72:75], v[64:67], v[24:27]
  v_mfma_f32_16x16x32_bf16 v[40:43], a[200:203], v[64:67], v[40:43]
  v_mfma_f32_16x16x32_bf16 v[56:59], v[64:67], v[200:203], v[56:59]
  v_mfma_f32_16x16x32_bf16 v[28:31], a[72:75], v[68:71], v[28:31]
  v_mfma_f32_16x16x32_bf16 v[44:47], a[200:203], v[68:71], v[44:47]
  v_mfma_f32_16x16x32_bf16 v[60:63], v[68:71], v[200:203], v[60:63]
  ds_read_b128 v[64:67], v10 offset:4096
  ds_read_b128 v[68:71], v10 offset:20480
  s_waitcnt lgkmcnt(2)
  v_mfma_f32_16x16x32_bf16 v[16:19], a[12:15], v[72:75], v[16:19]
  v_mfma_f32_16x16x32_bf16 v[32:35], a[140:143], v[72:75], v[32:35]
  v_mfma_f32_16x16x32_bf16 v[48:51], v[72:75], v[140:143], v[48:51]
  v_mfma_f32_16x16x32_bf16 v[20:23], a[12:15], v[76:79], v[20:23]
  v_mfma_f32_16x16x32_bf16 v[36:39], a[140:143], v[76:79], v[36:39]
  v_mfma_f32_16x16x32_bf16 v[52:55], v[76:79], v[140:143], v[52:55]
  v_mfma_f32_16x16x32_bf16 v[24:27], a[76:79], v[72:75], v[24:27]
  v_mfma_f32_16x16x32_bf16 v[40:43], a[204:207], v[72:75], v[40:43]
  v_mfma_f32_16x16x32_bf16 v[56:59], v[72:75], v[204:207], v[56:59]
  v_mfma_f32_16x16x32_bf16 v[28:31], a[76:79], v[76:79], v[28:31]
  v_mfma_f32_16x16x32_bf16 v[44:47], a[204:207], v[76:79], v[44:47]
  v_mfma_f32_16x16x32_bf16 v[60:63], v[76:79], v[204:207], v[60:63]
  ds_read_b128 v[72:75], v10 offset:5120
  ds_read_b128 v[76:79], v10 offset:21504
  s_waitcnt lgkmcnt(2)
  v_mfma_f32_16x16x32_bf16 v[16:19], a[16:19], v[64:67], v[16:19]
  v_mfma_f32_16x16x32_bf16 v[32:35], a[144:147], v[64:67], v[32:35]
  v_mfma_f32_16x16x32_bf16 v[48:51], v[64:67], v[144:147], v[48:51]
  v_mfma_f32_16x16x32_bf16 v[20:23], a[16:19], v[68:71], v[20:23]
  v_mfma_f32_16x16x32_bf16 v[36:39], a[144:147], v[68:71], v[36:39]
  v_mfma_f32_16x16x32_bf16 v[52:55], v[68:71], v[144:147], v[52:55]
  v_mfma_f32_16x16x32_bf16 v[24:27], a[80:83], v[64:67], v[24:27]
  v_mfma_f32_16x16x32_bf16 v[40:43], a[208:211], v[64:67], v[40:43]
  v_mfma_f32_16x16x32_bf16 v[56:59], v[64:67], v[208:211], v[56:59]
  v_mfma_f32_16x16x32_bf16 v[28:31], a[80:83], v[68:71], v[28:31]
  v_mfma_f32_16x16x32_bf16 v[44:47], a[208:211], v[68:71], v[44:47]
  v_mfma_f32_16x16x32_bf16 v[60:63], v[68:71], v[208:211], v[60:63]
  ds_read_b128 v[64:67], v10 offset:6144
  ds_read_b128 v[68:71], v10 offset:22528
  s_waitcnt lgkmcnt(2)
  v_mfma_f32_16x16x32_bf16 v[16:19], a[20:23], v[72:75], v[16:19]
  v_mfma_f32_16x16x32_bf16 v[32:35], a[148:151], v[72:75], v[32:35]
  v_mfma_f32_16x16x32_bf16 v[48:51], v[72:75], v[148:151], v[48:51]
  v_mfma_f32_16x16x32_bf16 v[20:23], a[20:23], v[76:79], v[20:23]
  v_mfma_f32_16x16x32_bf16 v[36:39], a[148:151], v[76:79], v[36:39]
  v_mfma_f32_16x16x32_bf16 v[52:55], v[76:79], v[148:151], v[52:55]
  v_mfma_f32_16x16x32_bf16 v[24:27], a[84:87], v[72:75], v[24:27]
  v_mfma_f32_16x16x32_bf16 v[40:43], a[212:215], v[72:75], v[40:43]
  v_mfma_f32_16x16x32_bf16 v[56:59], v[72:75], v[212:215], v[56:59]
  v_mfma_f32_16x16x32_bf16 v[28:31], a[84:87], v[76:79], v[28:31]
  v_mfma_f32_16x16x32_bf16 v[44:47], a[212:215], v[76:79], v[44:47]
  v_mfma_f32_16x16x32_bf16 v[60:63], v[76:79], v[212:215], v[60:63]
  ds_read_b128 v[72:75], v10 offset:7168
  ds_read_b128 v[76:79], v10 offset:23552
  s_waitcnt lgkmcnt(2)
  v_mfma_f32_16x16x32_bf16 v[16:19], a[24:27], v[64:67], v[16:19]
  v_mfma_f32_16x16x32_bf16 v[32:35], a[152:155], v[64:67], v[32:35]
  v_mfma_f32_16x16x32_bf16 v[48:51], v[64:67], v[152:155], v[48:51]
  v_mfma_f32_16x16x32_bf16 v[20:23], a[24:27], v[68:71], v[20:23]
  v_mfma_f32_16x16x32_bf16 v[36:39], a[152:155], v[68:71], v[36:39]
  v_mfma_f32_16x16x32_bf16 v[52:55], v[68:71], v[152:155], v[52:55]
  v_mfma_f32_16x16x32_bf16 v[24:27], a[88:91], v[64:67], v[24:27]
  v_mfma_f32_16x16x32_bf16 v[40:43], a[216:219], v[64:67], v[40:43]
  v_mfma_f32_16x16x32_bf16 v[56:59], v[64:67], v[216:219], v[56:59]
  v_mfma_f32_16x16x32_bf16 v[28:31], a[88:91], v[68:71], v[28:31]
  v_mfma_f32_16x16x32_bf16 v[44:47], a[216:219], v[68:71], v[44:47]
  v_mfma_f32_16x16x32_bf16 v[60:63], v[68:71], v[216:219], v[60:63]
  ds_read_b128 v[64:67], v10 offset:8192
  ds_read_b128 v[68:71], v10 offset:24576
  s_waitcnt lgkmcnt(2)
  v_mfma_f32_16x16x32_bf16 v[16:19], a[28:31], v[72:75], v[16:19]
  v_mfma_f32_16x16x32_bf16 v[32:35], a[156:159], v[72:75], v[32:35]
  v_mfma_f32_16x16x32_bf16 v[48:51], v[72:75], v[156:159], v[48:51]
  v_mfma_f32_16x16x32_bf16 v[20:23], a[28:31], v[76:79], v[20:23]
  v_mfma_f32_16x16x32_bf16 v[36:39], a[156:159], v[76:79], v[36:39]
  v_mfma_f32_16x16x32_bf16 v[52:55], v[76:79], v[156:159], v[52:55]
  v_mfma_f32_16x16x32_bf16 v[24:27], a[92:95], v[72:75], v[24:27]
  v_mfma_f32_16x16x32_bf16 v[40:43], a[220:223], v[72:75], v[40:43]
  v_mfma_f32_16x16x32_bf16 v[56:59], v[72:75], v[220:223], v[56:59]
  v_mfma_f32_16x16x32_bf16 v[28:31], a[92:95], v[76:79], v[28:31]
  v_mfma_f32_16x16x32_bf16 v[44:47], a[220:223], v[76:79], v[44:47]
  v_mfma_f32_16x16x32_bf16 v[60:63], v[76:79], v[220:223], v[60:63]
  ds_read_b128 v[72:75], v10 offset:9216
  ds_read_b128 v[76:79], v10 offset:25600
  s_waitcnt lgkmcnt(2)
  v_mfma_f32_16x16x32_bf16 v[16:19], a[32:35], v[64:67], v[16:19]
  v_mfma_f32_16x16x32_bf16 v[32:35], a[160:163], v[64:67], v[32:35]
  v_mfma_f32_16x16x32_bf16 v[48:51], v[64:67], v[160:163], v[48:51]
  v_mfma_f32_16x16x32_bf16 v[20:23], a[32:35], v[68:71], v[20:23]
  v_mfma_f32_16x16x32_bf16 v[36:39], a[160:163], v[68:71], v[36:39]
  v_mfma_f32_16x16x32_bf16 v[52:55], v[68:71], v[160:163], v[52:55]
  v_mfma_f32_16x16x32_bf16 v[24:27], a[96:99], v[64:67], v[24:27]
  v_mfma_f32_16x16x32_bf16 v[40:43], a[224:227], v[64:67], v[40:43]
  v_mfma_f32_16x16x32_bf16 v[56:59], v[64:67], v[224:227], v[56:59]
  v_mfma_f32_16x16x32_bf16 v[28:31], a[96:99], v[68:71], v[28:31]
  v_mfma_f32_16x16x32_bf16 v[44:47], a[224:227], v[68:71], v[44:47]
  v_mfma_f32_16x16x32_bf16 v[60:63], v[68:71], v[224:227], v[60:63]
  ds_read_b128 v[64:67], v10 offset:10240
  ds_read_b128 v[68:71], v10 offset:26624
  s_waitcnt lgkmcnt(2)
  v_mfma_f32_16x16x32_bf16 v[16:19], a[36:39], v[72:75], v[16:19]
  v_mfma_f32_16x16x32_bf16 v[32:35], a[164:167], v[72:75], v[32:35]
  v_mfma_f32_16x16x32_bf16 v[48:51], v[72:75], v[164:167], v[48:51]
  v_mfma_f32_16x16x32_bf16 v[20:23], a[36:39], v[76:79], v[20:23]
  v_mfma_f32_16x16x32_bf16 v[36:39], a[164:167], v[76:79], v[36:39]
  v_mfma_f32_16x16x32_bf16 v[52:55], v[76:79], v[164:167], v[52:55]
  v_mfma_f32_16x16x32_bf16 v[24:27], a[100:103], v[72:75], v[24:27]
  v_mfma_f32_16x16x32_bf16 v[40:43], a[228:231], v[72:75], v[40:43]
  v_mfma_f32_16x16x32_bf16 v[56:59], v[72:75], v[228:231], v[56:59]
  v_mfma_f32_16x16x32_bf16 v[28:31], a[100:103], v[76:79], v[28:31]
  v_mfma_f32_16x16x32_bf16 v[44:47], a[228:231], v[76:79], v[44:47]
  v_mfma_f32_16x16x32_bf16 v[60:63], v[76:79], v[228:231], v[60:63]
  ds_read_b128 v[72:75], v10 offset:11264
  ds_read_b128 v[76:79], v10 offset:27648
  s_waitcnt lgkmcnt(2)
  v_mfma_f32_16x16x32_bf16 v[16:19], a[40:43], v[64:67], v[16:19]
  v_mfma_f32_16x16x32_bf16 v[32:35], a[168:171], v[64:67], v[32:35]
  v_mfma_f32_16x16x32_bf16 v[48:51], v[64:67], v[168:171], v[48:51]
  v_mfma_f32_16x16x32_bf16 v[20:23], a[40:43], v[68:71], v[20:23]
  v_mfma_f32_16x16x32_bf16 v[36:39], a[168:171], v[68:71], v[36:39]
  v_mfma_f32_16x16x32_bf16 v[52:55], v[68:71], v[168:171], v[52:55]
  v_mfma_f32_16x16x32_bf16 v[24:27], a[104:107], v[64:67], v[24:27]
  v_mfma_f32_16x16x32_bf16 v[40:43], a[232:235], v[64:67], v[40:43]
  v_mfma_f32_16x16x32_bf16 v[56:59], v[64:67], v[232:235], v[56:59]
  v_mfma_f32_16x16x32_bf16 v[28:31], a[104:107], v[68:71], v[28:31]
  v_mfma_f32_16x16x32_bf16 v[44:47], a[232:235], v[68:71], v[44:47]
  v_mfma_f32_16x16x32_bf16 v[60:63], v[68:71], v[232:235], v[60:63]
  ds_read_b128 v[64:67], v10 offset:12288
  ds_read_b128 v[68:71], v10 offset:28672
  s_waitcnt lgkmcnt(2)
  v_mfma_f32_16x16x32_bf16 v[16:19], a[44:47], v[72:75], v[16:19]
  v_mfma_f32_16x16x32_bf16 v[32:35], a[172:175], v[72:75], v[32:35]
  v_mfma_f32_16x16x32_bf16 v[48:51], v[72:75], v[172:175], v[48:51]
  v_mfma_f32_16x16x32_bf16 v[20:23], a[44:47], v[76:79], v[20:23]
  v_mfma_f32_16x16x32_bf16 v[36:39], a[172:175], v[76:79], v[36:39]
  v_mfma_f32_16x16x32_bf16 v[52:55], v[76:79], v[172:175], v[52:55]
  v_mfma_f32_16x16x32_bf16 v[24:27], a[108:111], v[72:75], v[24:27]
  v_mfma_f32_16x16x32_bf16 v[40:43], a[236:239], v[72:75], v[40:43]
  v_mfma_f32_16x16x32_bf16 v[56:59], v[72:75], v[236:239], v[56:59]
  v_mfma_f32_16x16x32_bf16 v[28:31], a[108:111], v[76:79], v[28:31]
  v_mfma_f32_16x16x32_bf16 v[44:47], a[236:239], v[76:79], v[44:47]
  v_mfma_f32_16x16x32_bf16 v[60:63], v[76:79], v[236:239], v[60:63]
  ds_read_b128 v[72:75], v10 offset:13312
  ds_read_b128 v[76:79], v10 offset:29696
  s_waitcnt lgkmcnt(2)
  v_mfma_f32_16x16x32_bf16 v[16:19], a[48:51], v[64:67], v[16:19]
  v_mfma_f32_16x16x32_bf16 v[32:35], a[176:179], v[64:67], v[32:35]
  v_mfma_f32_16x16x32_bf16 v[48:51], v[64:67], v[176:179], v[48:51]
  v_mfma_f32_16x16x32_bf16 v[20:23], a[48:51], v[68:71], v[20:23]
  v_mfma_f32_16x16x32_bf16 v[36:39], a[176:179], v[68:71], v[36:39]
  v_mfma_f32_16x16x32_bf16 v[52:55], v[68:71], v[176:179], v[52:55]
  v_mfma_f32_16x16x32_bf16 v[24:27], a[112:115], v[64:67], v[24:27]
  v_mfma_f32_16x16x32_bf16 v[40:43], a[240:243], v[64:67], v[40:43]
  v_mfma_f32_16x16x32_bf16 v[56:59], v[64:67], v[240:243], v[56:59]
  v_mfma_f32_16x16x32_bf16 v[28:31], a[112:115], v[68:71], v[28:31]
  v_mfma_f32_16x16x32_bf16 v[44:47], a[240:243], v[68:71], v[44:47]
  v_mfma_f32_16x16x32_bf16 v[60:63], v[68:71], v[240:243], v[60:63]
  ds_read_b128 v[64:67], v10 offset:14336
  ds_read_b128 v[68:71], v10 offset:30720
  s_waitcnt lgkmcnt(2)
  v_mfma_f32_16x16x32_bf16 v[16:19], a[52:55], v[72:75], v[16:19]
  v_mfma_f32_16x16x32_bf16 v[32:35], a[180:183], v[72:75], v[32:35]
  v_mfma_f32_16x16x32_bf16 v[48:51], v[72:75], v[180:183], v[48:51]
  v_mfma_f32_16x16x32_bf16 v[20:23], a[52:55], v[76:79], v[20:23]
  v_mfma_f32_16x16x32_bf16 v[36:39], a[180:183], v[76:79], v[36:39]
  v_mfma_f32_16x16x32_bf16 v[52:55], v[76:79], v[180:183], v[52:55]
  v_mfma_f32_16x16x32_bf16 v[24:27], a[116:119], v[72:75], v[24:27]
  v_mfma_f32_16x16x32_bf16 v[40:43], a[244:247], v[72:75], v[40:43]
  v_mfma_f32_16x16x32_bf16 v[56:59], v[72:75], v[244:247], v[56:59]
  v_mfma_f32_16x16x32_bf16 v[28:31], a[116:119], v[76:79], v[28:31]
  v_mfma_f32_16x16x32_bf16 v[44:47], a[244:247], v[76:79], v[44:47]
  v_mfma_f32_16x16x32_bf16 v[60:63], v[76:79], v[244:247], v[60:63]
  ds_read_b128 v[72:75], v10 offset:15360
  ds_read_b128 v[76:79], v10 offset:31744
  s_waitcnt lgkmcnt(2)
  v_mfma_f32_16x16x32_bf16 v[16:19], a[56:59], v[64:67], v[16:19]
  v_mfma_f32_16x16x32_bf16 v[32:35], a[184:187], v[64:67], v[32:35]
  v_mfma_f32_16x16x32_bf16 v[48:51], v[64:67], v[184:187], v[48:51]
  v_mfma_f32_16x16x32_bf16 v[20:23], a[56:59], v[68:71], v[20:23]
  v_mfma_f32_16x16x32_bf16 v[36:39], a[184:187], v[68:71], v[36:39]
  v_mfma_f32_16x16x32_bf16 v[52:55], v[68:71], v[184:187], v[52:55]
  v_mfma_f32_16x16x32_bf16 v[24:27], a[120:123], v[64:67], v[24:27]
  v_mfma_f32_16x16x32_bf16 v[40:43], a[248:251], v[64:67], v[40:43]
  v_mfma_f32_16x16x32_bf16 v[56:59], v[64:67], v[248:251], v[56:59]
  v_mfma_f32_16x16x32_bf16 v[28:31], a[120:123], v[68:71], v[28:31]
  v_mfma_f32_16x16x32_bf16 v[44:47], a[248:251], v[68:71], v[44:47]
  v_mfma_f32_16x16x32_bf16 v[60:63], v[68:71], v[248:251], v[60:63]
  s_waitcnt lgkmcnt(0)
  v_mfma_f32_16x16x32_bf16 v[16:19], a[60:63], v[72:75], v[16:19]
  v_mfma_f32_16x16x32_bf16 v[32:35], a[188:191], v[72:75], v[32:35]
  v_mfma_f32_16x16x32_bf16 v[48:51], v[72:75], v[188:191], v[48:51]
  v_mfma_f32_16x16x32_bf16 v[20:23], a[60:63], v[76:79], v[20:23]
  v_mfma_f32_16x16x32_bf16 v[36:39], a[188:191], v[76:79], v[36:39]
  v_mfma_f32_16x16x32_bf16 v[52:55], v[76:79], v[188:191], v[52:55]
  v_mfma_f32_16x16x32_bf16 v[24:27], a[124:127], v[72:75], v[24:27]
  v_mfma_f32_16x16x32_bf16 v[40:43], a[252:255], v[72:75], v[40:43]
  v_mfma_f32_16x16x32_bf16 v[56:59], v[72:75], v[252:255], v[56:59]
  v_mfma_f32_16x16x32_bf16 v[28:31], a[124:127], v[76:79], v[28:31]
  v_mfma_f32_16x16x32_bf16 v[44:47], a[252:255], v[76:79], v[44:47]
  v_mfma_f32_16x16x32_bf16 v[60:63], v[76:79], v[252:255], v[60:63]
  v_cvt_pk_bf16_f32 v80, v16, v17
  v_cvt_pk_bf16_f32 v81, v18, v19
  v_cvt_pk_bf16_f32 v82, v24, v25
  v_cvt_pk_bf16_f32 v83, v26, v27
  v_cvt_pk_bf16_f32 v88, v32, v33
  v_cvt_pk_bf16_f32 v89, v34, v35
  v_cvt_pk_bf16_f32 v90, v40, v41
  v_cvt_pk_bf16_f32 v91, v42, v43
  v_cvt_pk_bf16_f32 v84, v20, v21
  v_cvt_pk_bf16_f32 v85, v22, v23
  v_cvt_pk_bf16_f32 v86, v28, v29
  v_cvt_pk_bf16_f32 v87, v30, v31
  v_cvt_pk_bf16_f32 v92, v36, v37
  v_cvt_pk_bf16_f32 v93, v38, v39
  v_cvt_pk_bf16_f32 v94, v44, v45
  v_cvt_pk_bf16_f32 v95, v46, v47
  v_cvt_pk_bf16_f32 v96, v48, v49
  v_cvt_pk_bf16_f32 v97, v50, v51
  v_cvt_pk_bf16_f32 v98, v52, v53
  v_cvt_pk_bf16_f32 v99, v54, v55
  v_cvt_pk_bf16_f32 v100, v56, v57
  v_cvt_pk_bf16_f32 v101, v58, v59
  v_cvt_pk_bf16_f32 v102, v60, v61
  v_cvt_pk_bf16_f32 v103, v62, v63
  s_lshl_b32 s20, s31, 5
  s_add_u32 s20, s20, s17
  s_lshl_b32 s21, s20, 13
  s_lshl_b32 s22, s16, 11
  s_add_u32 s21, s21, s22
  s_add_u32 s21, s21, 50331648
  s_lshl_b32 s23, s20, 14
  s_lshl_b32 s22, s16, 12
  s_add_u32 s23, s23, s22
  s_add_u32 s23, s23, 16777216
  buffer_store_dwordx4 v[80:83], v9, s[8:11], s21 offen sc1
  buffer_store_dwordx4 v[84:87], v9, s[8:11], s21 offen offset:1024 sc1
  buffer_store_dwordx4 v[88:91], v9, s[8:11], s23 offen sc1
  buffer_store_dwordx4 v[92:95], v9, s[8:11], s23 offen offset:1024 sc1
  buffer_store_dwordx4 v[96:99], v9, s[8:11], s23 offen offset:2048 sc1
  buffer_store_dwordx4 v[100:103], v9, s[8:11], s23 offen offset:3072 sc1
  s_cmp_lt_i32 s36, 0
  s_cbranch_scc0 L_t1_notfirst
  s_waitcnt vmcnt(0)
  s_barrier
  s_lshl_b32 s20, s17, 8
  s_lshl_b32 s21, s31, 2
  s_add_u32 s20, s20, s21
  s_add_u32 s20, s20, 0
  v_mov_b32 v2, 0
  v_mov_b32 v3, 1
  s_cmp_eq_u32 s16, 0
  s_cselect_b64 exec, 1, 0
  buffer_store_dword v3, v2, s[8:11], s20 offen sc1
  s_mov_b64 exec, -1
  s_waitcnt vmcnt(0)
L_t1_notfirst:
  s_mov_b32 s33, s36
  s_mov_b32 s36, s31
  s_mov_b32 s31, s34
  s_mov_b32 s32, s35
  s_cmp_lt_u32 s31, 64
  s_cbranch_scc1 L_t1_loop
  s_waitcnt vmcnt(0)
  s_barrier
  s_cmp_lt_i32 s33, 0
  s_cbranch_scc1 L_t1_fin_a
  s_lshl_b32 s20, s17, 8
  s_lshl_b32 s21, s33, 2
  s_add_u32 s20, s20, s21
  s_add_u32 s20, s20, 0
  v_mov_b32 v2, 0
  v_mov_b32 v3, 1
  s_cmp_eq_u32 s16, 0
  s_cselect_b64 exec, 1, 0
  buffer_store_dword v3, v2, s[8:11], s20 offen sc1
  s_mov_b64 exec, -1
L_t1_fin_a:
  s_cmp_lt_i32 s36, 0
  s_cbranch_scc1 L_t1_fin_b
  s_lshl_b32 s20, s17, 8
  s_lshl_b32 s21, s36, 2
  s_add_u32 s20, s20, s21
  s_add_u32 s20, s20, 0
  v_mov_b32 v2, 0
  v_mov_b32 v3, 1
  s_cmp_eq_u32 s16, 0
  s_cselect_b64 exec, 1, 0
  buffer_store_dword v3, v2, s[8:11], s20 offen sc1
  s_mov_b64 exec, -1
L_t1_fin_b:
  s_waitcnt vmcnt(0)
  s_mov_b32 s17, s30
  s_barrier
  s_and_b32 s30, s17, 3
  s_lshl_b32 s30, s30, 2
  s_add_u32 s30, s30, s16
  s_lshr_b32 s31, s17, 2
  s_load_dwordx2 s[4:5], s[0:1], 64
  s_load_dwordx2 s[56:57], s[0:1], 0
  s_waitcnt lgkmcnt(0)
  s_mov_b32 s6, 524288
  s_mov_b32 s7, 0x20000
  s_mov_b32 s58, 2097152
  s_mov_b32 s59, 0x20000
  v_lshrrev_b32 v2, 2, v0
  v_and_b32 v3, 3, v0
  v_lshrrev_b32 v4, 5, v0
  v_lshlrev_b32 v4, 1, v4
  v_xor_b32 v3, v3, v4
  v_lshlrev_b32 v2, 10, v2
  v_lshl_add_u32 v8, v3, 4, v2
  s_lshl_b32 s22, s16, 15
  s_lshl_b32 s23, s30, 6
  s_add_u32 s25, s23, 0
  s_add_u32 m0, s22, 0
  s_nop 0
  buffer_load_dwordx4 v8, s[4:7], s25 offen lds
  s_add_u32 s25, s23, 16384
  s_add_u32 m0, s22, 1024
  s_nop 0
  buffer_load_dwordx4 v8, s[4:7], s25 offen lds
  s_add_u32 s25, s23, 32768
  s_add_u32 m0, s22, 2048
  s_nop 0
  buffer_load_dwordx4 v8, s[4:7], s25 offen lds
  s_add_u32 s25, s23, 49152
  s_add_u32 m0, s22, 3072
  s_nop 0
  buffer_load_dwordx4 v8, s[4:7], s25 offen lds
  s_add_u32 s25, s23, 65536
  s_add_u32 m0, s22, 4096
  s_nop 0
  buffer_load_dwordx4 v8, s[4:7], s25 offen lds
  s_add_u32 s25, s23, 81920
  s_add_u32 m0, s22, 5120
  s_nop 0
  buffer_load_dwordx4 v8, s[4:7], s25 offen lds
  s_add_u32 s25, s23, 98304
  s_add_u32 m0, s22, 6144
  s_nop 0
  buffer_load_dwordx4 v8, s[4:7], s25 offen lds
  s_add_u32 s25, s23, 114688
  s_add_u32 m0, s22, 7168
  s_nop 0
  buffer_load_dwordx4 v8, s[4:7], s25 offen lds
  s_add_u32 s25, s23, 131072
  s_add_u32 m0, s22, 8192
  s_nop 0
  buffer_load_dwordx4 v8, s[4:7], s25 offen lds
  s_add_u32 s25, s23, 147456
  s_add_u32 m0, s22, 9216
  s_nop 0
  buffer_load_dwordx4 v8, s[4:7], s25 offen lds
  s_add_u32 s25, s23, 163840
  s_add_u32 m0, s22, 10240
  s_nop 0
  buffer_load_dwordx4 v8, s[4:7], s25 offen lds
  s_add_u32 s25, s23, 180224
  s_add_u32 m0, s22, 11264
  s_nop 0
  buffer_load_dwordx4 v8, s[4:7], s25 offen lds
  s_add_u32 s25, s23, 196608
  s_add_u32 m0, s22, 12288
  s_nop 0
  buffer_load_dwordx4 v8, s[4:7], s25 offen lds
  s_add_u32 s25, s23, 212992
  s_add_u32 m0, s22, 13312
  s_nop 0
  buffer_load_dwordx4 v8, s[4:7], s25 offen lds
  s_add_u32 s25, s23, 229376
  s_add_u32 m0, s22, 14336
  s_nop 0
  buffer_load_dwordx4 v8, s[4:7], s25 offen lds
  s_add_u32 s25, s23, 245760
  s_add_u32 m0, s22, 15360
  s_nop 0
  buffer_load_dwordx4 v8, s[4:7], s25 offen lds
  s_add_u32 s25, s23, 262144
  s_add_u32 m0, s22, 16384
  s_nop 0
  buffer_load_dwordx4 v8, s[4:7], s25 offen lds
  s_add_u32 s25, s23, 278528
  s_add_u32 m0, s22, 17408
  s_nop 0
  buffer_load_dwordx4 v8, s[4:7], s25 offen lds
  s_add_u32 s25, s23, 294912
  s_add_u32 m0, s22, 18432
  s_nop 0
  buffer_load_dwordx4 v8, s[4:7], s25 offen lds
  s_add_u32 s25, s23, 311296
  s_add_u32 m0, s22, 19456
  s_nop 0
  buffer_load_dwordx4 v8, s[4:7], s25 offen lds
  s_add_u32 s25, s23, 327680
  s_add_u32 m0, s22, 20480
  s_nop 0
  buffer_load_dwordx4 v8, s[4:7], s25 offen lds
  s_add_u32 s25, s23, 344064
  s_add_u32 m0, s22, 21504
  s_nop 0
  buffer_load_dwordx4 v8, s[4:7], s25 offen lds
  s_add_u32 s25, s23, 360448
  s_add_u32 m0, s22, 22528
  s_nop 0
  buffer_load_dwordx4 v8, s[4:7], s25 offen lds
  s_add_u32 s25, s23, 376832
  s_add_u32 m0, s22, 23552
  s_nop 0
  buffer_load_dwordx4 v8, s[4:7], s25 offen lds
  s_add_u32 s25, s23, 393216
  s_add_u32 m0, s22, 24576
  s_nop 0
  buffer_load_dwordx4 v8, s[4:7], s25 offen lds
  s_add_u32 s25, s23, 409600
  s_add_u32 m0, s22, 25600
  s_nop 0
  buffer_load_dwordx4 v8, s[4:7], s25 offen lds
  s_add_u32 s25, s23, 425984
  s_add_u32 m0, s22, 26624
  s_nop 0
  buffer_load_dwordx4 v8, s[4:7], s25 offen lds
  s_add_u32 s25, s23, 442368
  s_add_u32 m0, s22, 27648
  s_nop 0
  buffer_load_dwordx4 v8, s[4:7], s25 offen lds
  s_add_u32 s25, s23, 458752
  s_add_u32 m0, s22, 28672
  s_nop 0
  buffer_load_dwordx4 v8, s[4:7], s25 offen lds
  s_add_u32 s25, s23, 475136
  s_add_u32 m0, s22, 29696
  s_nop 0
  buffer_load_dwordx4 v8, s[4:7], s25 offen lds
  s_add_u32 s25, s23, 491520
  s_add_u32 m0, s22, 30720
  s_nop 0
  buffer_load_dwordx4 v8, s[4:7], s25 offen lds
  s_add_u32 s25, s23, 507904
  s_add_u32 m0, s22, 31744
  s_nop 0
  buffer_load_dwordx4 v8, s[4:7], s25 offen lds
  v_lshrrev_b32 v2, 5, v0
  v_bfe_u32 v3, v0, 2, 2
  v_lshl_add_u32 v3, v2, 3, v3
  v_lshlrev_b32 v3, 6, v3
  v_bfe_u32 v4, v0, 4, 1
  v_lshlrev_b32 v4, 1, v4
  v_bfe_u32 v5, v0, 1, 1
  v_add_u32 v4, v4, v5
  v_lshlrev_b32 v5, 1, v2
  v_xor_b32 v4, v4, v5
  v_lshl_add_u32 v3, v4, 4, v3
  v_and_b32 v4, 1, v0
  v_lshl_add_u32 v3, v4, 3, v3
  v_add_u32 v10, s22, v3
  s_waitcnt vmcnt(0)
  ds_read_b64_tr_b16 a[0:1], v10 offset:0
  ds_read_b64_tr_b16 a[2:3], v10 offset:256
  ds_read_b64_tr_b16 a[4:5], v10 offset:1024
  ds_read_b64_tr_b16 a[6:7], v10 offset:1280
  ds_read_b64_tr_b16 a[8:9], v10 offset:2048
  ds_read_b64_tr_b16 a[10:11], v10 offset:2304
  ds_read_b64_tr_b16 a[12:13], v10 offset:3072
  ds_read_b64_tr_b16 a[14:15], v10 offset:3328
  ds_read_b64_tr_b16 a[16:17], v10 offset:4096
  ds_read_b64_tr_b16 a[18:19], v10 offset:4352
  ds_read_b64_tr_b16 a[20:21], v10 offset:5120
  ds_read_b64_tr_b16 a[22:23], v10 offset:5376
  s_waitcnt lgkmcnt(0)
  ds_read_b64_tr_b16 a[24:25], v10 offset:6144
  ds_read_b64_tr_b16 a[26:27], v10 offset:6400
  ds_read_b64_tr_b16 a[28:29], v10 offset:7168
  ds_read_b64_tr_b16 a[30:31], v10 offset:7424
  ds_read_b64_tr_b16 a[32:33], v10 offset:8192
  ds_read_b64_tr_b16 a[34:35], v10 offset:8448
  ds_read_b64_tr_b16 a[36:37], v10 offset:9216
  ds_read_b64_tr_b16 a[38:39], v10 offset:9472
  ds_read_b64_tr_b16 a[40:41], v10 offset:10240
  ds_read_b64_tr_b16 a[42:43], v10 offset:10496
  ds_read_b64_tr_b16 a[44:45], v10 offset:11264
  ds_read_b64_tr_b16 a[46:47], v10 offset:11520
  s_waitcnt lgkmcnt(0)
  ds_read_b64_tr_b16 a[48:49], v10 offset:12288
  ds_read_b64_tr_b16 a[50:51], v10 offset:12544
  ds_read_b64_tr_b16 a[52:53], v10 offset:13312
  ds_read_b64_tr_b16 a[54:55], v10 offset:13568
  ds_read_b64_tr_b16 a[56:57], v10 offset:14336
  ds_read_b64_tr_b16 a[58:59], v10 offset:14592
  ds_read_b64_tr_b16 a[60:61], v10 offset:15360
  ds_read_b64_tr_b16 a[62:63], v10 offset:15616
  ds_read_b64_tr_b16 a[64:65], v10 offset:16384
  ds_read_b64_tr_b16 a[66:67], v10 offset:16640
  ds_read_b64_tr_b16 a[68:69], v10 offset:17408
  ds_read_b64_tr_b16 a[70:71], v10 offset:17664
  s_waitcnt lgkmcnt(0)
  ds_read_b64_tr_b16 a[72:73], v10 offset:18432
  ds_read_b64_tr_b16 a[74:75], v10 offset:18688
  ds_read_b64_tr_b16 a[76:77], v10 offset:19456
  ds_read_b64_tr_b16 a[78:79], v10 offset:19712
  ds_read_b64_tr_b16 a[80:81], v10 offset:20480
  ds_read_b64_tr_b16 a[82:83], v10 offset:20736
  ds_read_b64_tr_b16 a[84:85], v10 offset:21504
  ds_read_b64_tr_b16 a[86:87], v10 offset:21760
  ds_read_b64_tr_b16 a[88:89], v10 offset:22528
  ds_read_b64_tr_b16 a[90:91], v10 offset:22784
  ds_read_b64_tr_b16 a[92:93], v10 offset:23552
  ds_read_b64_tr_b16 a[94:95], v10 offset:23808
  s_waitcnt lgkmcnt(0)
  ds_read_b64_tr_b16 a[96:97], v10 offset:24576
  ds_read_b64_tr_b16 a[98:99], v10 offset:24832
  ds_read_b64_tr_b16 a[100:101], v10 offset:25600
  ds_read_b64_tr_b16 a[102:103], v10 offset:25856
  ds_read_b64_tr_b16 a[104:105], v10 offset:26624
  ds_read_b64_tr_b16 a[106:107], v10 offset:26880
  ds_read_b64_tr_b16 a[108:109], v10 offset:27648
  ds_read_b64_tr_b16 a[110:111], v10 offset:27904
  ds_read_b64_tr_b16 a[112:113], v10 offset:28672
  ds_read_b64_tr_b16 a[114:115], v10 offset:28928
  ds_read_b64_tr_b16 a[116:117], v10 offset:29696
  ds_read_b64_tr_b16 a[118:119], v10 offset:29952
  s_waitcnt lgkmcnt(0)
  ds_read_b64_tr_b16 a[120:121], v10 offset:30720
  ds_read_b64_tr_b16 a[122:123], v10 offset:30976
  ds_read_b64_tr_b16 a[124:125], v10 offset:31744
  ds_read_b64_tr_b16 a[126:127], v10 offset:32000
  s_waitcnt lgkmcnt(0)
L_b2_wait:
  v_and_b32 v2, 15, v0
  v_lshlrev_b32 v2, 2, v2
  s_mov_b32 s20, 14336
  buffer_load_dword v2, v2, s[8:11], s20 offen sc1
  s_waitcnt vmcnt(0)
  v_cmp_eq_u32 vcc, 0, v2
  s_add_u32 s19, s19, 1
  s_cmp_lt_u32 s19, 2097152
  s_cselect_b64 s[20:21], -1, 0
  s_and_b64 vcc, vcc, s[20:21]
  s_cbranch_vccnz L_b2_wait
  s_barrier
  v_lshlrev_b32 v9, 4, v0
  s_lshl_b32 s22, s16, 15
  s_add_u32 s25, s22, 1966080
  s_add_u32 m0, s22, 0
  s_nop 0
  buffer_load_dwordx4 v9, s[8:11], s25 offen sc1 lds
  s_add_u32 s25, s22, 1967104
  s_add_u32 m0, s22, 1024
  s_nop 0
  buffer_load_dwordx4 v9, s[8:11], s25 offen sc1 lds
  s_add_u32 s25, s22, 1968128
  s_add_u32 m0, s22, 2048
  s_nop 0
  buffer_load_dwordx4 v9, s[8:11], s25 offen sc1 lds
  s_add_u32 s25, s22, 1969152
  s_add_u32 m0, s22, 3072
  s_nop 0
  buffer_load_dwordx4 v9, s[8:11], s25 offen sc1 lds
  s_add_u32 s25, s22, 1970176
  s_add_u32 m0, s22, 4096
  s_nop 0
  buffer_load_dwordx4 v9, s[8:11], s25 offen sc1 lds
  s_add_u32 s25, s22, 1971200
  s_add_u32 m0, s22, 5120
  s_nop 0
  buffer_load_dwordx4 v9, s[8:11], s25 offen sc1 lds
  s_add_u32 s25, s22, 1972224
  s_add_u32 m0, s22, 6144
  s_nop 0
  buffer_load_dwordx4 v9, s[8:11], s25 offen sc1 lds
  s_add_u32 s25, s22, 1973248
  s_add_u32 m0, s22, 7168
  s_nop 0
  buffer_load_dwordx4 v9, s[8:11], s25 offen sc1 lds
  s_add_u32 s25, s22, 1974272
  s_add_u32 m0, s22, 8192
  s_nop 0
  buffer_load_dwordx4 v9, s[8:11], s25 offen sc1 lds
  s_add_u32 s25, s22, 1975296
  s_add_u32 m0, s22, 9216
  s_nop 0
  buffer_load_dwordx4 v9, s[8:11], s25 offen sc1 lds
  s_add_u32 s25, s22, 1976320
  s_add_u32 m0, s22, 10240
  s_nop 0
  buffer_load_dwordx4 v9, s[8:11], s25 offen sc1 lds
  s_add_u32 s25, s22, 1977344
  s_add_u32 m0, s22, 11264
  s_nop 0
  buffer_load_dwordx4 v9, s[8:11], s25 offen sc1 lds
  s_add_u32 s25, s22, 1978368
  s_add_u32 m0, s22, 12288
  s_nop 0
  buffer_load_dwordx4 v9, s[8:11], s25 offen sc1 lds
  s_add_u32 s25, s22, 1979392
  s_add_u32 m0, s22, 13312
  s_nop 0
  buffer_load_dwordx4 v9, s[8:11], s25 offen sc1 lds
  s_add_u32 s25, s22, 1980416
  s_add_u32 m0, s22, 14336
  s_nop 0
  buffer_load_dwordx4 v9, s[8:11], s25 offen sc1 lds
  s_add_u32 s25, s22, 1981440
  s_add_u32 m0, s22, 15360
  s_nop 0
  buffer_load_dwordx4 v9, s[8:11], s25 offen sc1 lds
  s_add_u32 s25, s22, 1982464
  s_add_u32 m0, s22, 16384
  s_nop 0
  buffer_load_dwordx4 v9, s[8:11], s25 offen sc1 lds
  s_add_u32 s25, s22, 1983488
  s_add_u32 m0, s22, 17408
  s_nop 0
  buffer_load_dwordx4 v9, s[8:11], s25 offen sc1 lds
  s_add_u32 s25, s22, 1984512
  s_add_u32 m0, s22, 18432
  s_nop 0
  buffer_load_dwordx4 v9, s[8:11], s25 offen sc1 lds
  s_add_u32 s25, s22, 1985536
  s_add_u32 m0, s22, 19456
  s_nop 0
  buffer_load_dwordx4 v9, s[8:11], s25 offen sc1 lds
  s_add_u32 s25, s22, 1986560
  s_add_u32 m0, s22, 20480
  s_nop 0
  buffer_load_dwordx4 v9, s[8:11], s25 offen sc1 lds
  s_add_u32 s25, s22, 1987584
  s_add_u32 m0, s22, 21504
  s_nop 0
  buffer_load_dwordx4 v9, s[8:11], s25 offen sc1 lds
  s_add_u32 s25, s22, 1988608
  s_add_u32 m0, s22, 22528
  s_nop 0
  buffer_load_dwordx4 v9, s[8:11], s25 offen sc1 lds
  s_add_u32 s25, s22, 1989632
  s_add_u32 m0, s22, 23552
  s_nop 0
  buffer_load_dwordx4 v9, s[8:11], s25 offen sc1 lds
  s_add_u32 s25, s22, 1990656
  s_add_u32 m0, s22, 24576
  s_nop 0
  buffer_load_dwordx4 v9, s[8:11], s25 offen sc1 lds
  s_add_u32 s25, s22, 1991680
  s_add_u32 m0, s22, 25600
  s_nop 0
  buffer_load_dwordx4 v9, s[8:11], s25 offen sc1 lds
  s_add_u32 s25, s22, 1992704
  s_add_u32 m0, s22, 26624
  s_nop 0
  buffer_load_dwordx4 v9, s[8:11], s25 offen sc1 lds
  s_add_u32 s25, s22, 1993728
  s_add_u32 m0, s22, 27648
  s_nop 0
  buffer_load_dwordx4 v9, s[8:11], s25 offen sc1 lds
  s_add_u32 s25, s22, 1994752
  s_add_u32 m0, s22, 28672
  s_nop 0
  buffer_load_dwordx4 v9, s[8:11], s25 offen sc1 lds
  s_add_u32 s25, s22, 1995776
  s_add_u32 m0, s22, 29696
  s_nop 0
  buffer_load_dwordx4 v9, s[8:11], s25 offen sc1 lds
  s_add_u32 s25, s22, 1996800
  s_add_u32 m0, s22, 30720
  s_nop 0
  buffer_load_dwordx4 v9, s[8:11], s25 offen sc1 lds
  s_add_u32 s25, s22, 1997824
  s_add_u32 m0, s22, 31744
  s_nop 0
  buffer_load_dwordx4 v9, s[8:11], s25 offen sc1 lds
  v_mov_b32 v4, 0x3f803f80
  v_mov_b32 v5, 0x3f803f80
  v_mov_b32 v6, 0x3f803f80
  v_mov_b32 v7, 0x3f803f80
  v_add_u32 v2, 131072, v9
  ds_write_b128 v2, v[4:7]
  v_lshrrev_b32 v2, 5, v0
  v_lshlrev_b32 v2, 8, v2
  v_and_b32 v3, 15, v0
  v_lshl_add_u32 v2, v3, 4, v2
  v_add_u32 v2, 65536, v2
  v_mov_b32 v3, 131072
  v_bfe_u32 v4, v0, 4, 1
  v_cmp_eq_u32 vcc, 0, v4
  s_nop 1
  v_cndmask_b32 v11, v3, v2, vcc
  v_mov_b32 v3, 0
  v_mov_b32 v2, 1024
  v_cndmask_b32 v12, v3, v2, vcc
  v_and_b32 v2, 31, v0
  v_lshlrev_b32 v2, 10, v2
  v_lshrrev_b32 v3, 5, v0
  v_lshl_add_u32 v8, v3, 4, v2
  v_bfe_u32 v2, v0, 4, 1
  v_lshlrev_b32 v2, 10, v2
  v_lshl_add_u32 v2, v3, 8, v2
  v_and_b32 v3, 15, v0
  v_lshl_add_u32 v13, v3, 4, v2
  s_waitcnt vmcnt(0) lgkmcnt(0)
  s_barrier
L_b2_task:
  s_lshl_b32 s22, s31, 15
  buffer_load_dwordx4 a[128:131], v8, s[56:59], s22 offen offset:0
  buffer_load_dwordx4 a[132:135], v8, s[56:59], s22 offen offset:32
  buffer_load_dwordx4 a[136:139], v8, s[56:59], s22 offen offset:64
  buffer_load_dwordx4 a[140:143], v8, s[56:59], s22 offen offset:96
  buffer_load_dwordx4 a[144:147], v8, s[56:59], s22 offen offset:128
  buffer_load_dwordx4 a[148:151], v8, s[56:59], s22 offen offset:160
  buffer_load_dwordx4 a[152:155], v8, s[56:59], s22 offen offset:192
  buffer_load_dwordx4 a[156:159], v8, s[56:59], s22 offen offset:224
  buffer_load_dwordx4 a[160:163], v8, s[56:59], s22 offen offset:256
  buffer_load_dwordx4 a[164:167], v8, s[56:59], s22 offen offset:288
  buffer_load_dwordx4 a[168:171], v8, s[56:59], s22 offen offset:320
  buffer_load_dwordx4 a[172:175], v8, s[56:59], s22 offen offset:352
  buffer_load_dwordx4 a[176:179], v8, s[56:59], s22 offen offset:384
  buffer_load_dwordx4 a[180:183], v8, s[56:59], s22 offen offset:416
  buffer_load_dwordx4 a[184:187], v8, s[56:59], s22 offen offset:448
  buffer_load_dwordx4 a[188:191], v8, s[56:59], s22 offen offset:480
  buffer_load_dwordx4 a[192:195], v8, s[56:59], s22 offen offset:512
  buffer_load_dwordx4 a[196:199], v8, s[56:59], s22 offen offset:544
  buffer_load_dwordx4 a[200:203], v8, s[56:59], s22 offen offset:576
  buffer_load_dwordx4 a[204:207], v8, s[56:59], s22 offen offset:608
  buffer_load_dwordx4 a[208:211], v8, s[56:59], s22 offen offset:640
  buffer_load_dwordx4 a[212:215], v8, s[56:59], s22 offen offset:672
  buffer_load_dwordx4 a[216:219], v8, s[56:59], s22 offen offset:704
  buffer_load_dwordx4 a[220:223], v8, s[56:59], s22 offen offset:736
  buffer_load_dwordx4 a[224:227], v8, s[56:59], s22 offen offset:768
  buffer_load_dwordx4 a[228:231], v8, s[56:59], s22 offen offset:800
  buffer_load_dwordx4 a[232:235], v8, s[56:59], s22 offen offset:832
  buffer_load_dwordx4 a[236:239], v8, s[56:59], s22 offen offset:864
  buffer_load_dwordx4 a[240:243], v8, s[56:59], s22 offen offset:896
  buffer_load_dwordx4 a[244:247], v8, s[56:59], s22 offen offset:928
  buffer_load_dwordx4 a[248:251], v8, s[56:59], s22 offen offset:960
  buffer_load_dwordx4 a[252:255], v8, s[56:59], s22 offen offset:992
  s_waitcnt vmcnt(31)
  v_mfma_f32_32x32x16_bf16 v[32:47], a[0:3], a[128:131], 0
  s_waitcnt vmcnt(30)
  v_mfma_f32_32x32x16_bf16 v[32:47], a[4:7], a[132:135], v[32:47]
  s_waitcnt vmcnt(29)
  v_mfma_f32_32x32x16_bf16 v[32:47], a[8:11], a[136:139], v[32:47]
  s_waitcnt vmcnt(28)
  v_mfma_f32_32x32x16_bf16 v[32:47], a[12:15], a[140:143], v[32:47]
  s_waitcnt vmcnt(27)
  v_mfma_f32_32x32x16_bf16 v[32:47], a[16:19], a[144:147], v[32:47]
  s_waitcnt vmcnt(26)
  v_mfma_f32_32x32x16_bf16 v[32:47], a[20:23], a[148:151], v[32:47]
  s_waitcnt vmcnt(25)
  v_mfma_f32_32x32x16_bf16 v[32:47], a[24:27], a[152:155], v[32:47]
  s_waitcnt vmcnt(24)
  v_mfma_f32_32x32x16_bf16 v[32:47], a[28:31], a[156:159], v[32:47]
  s_waitcnt vmcnt(23)
  v_mfma_f32_32x32x16_bf16 v[32:47], a[32:35], a[160:163], v[32:47]
  s_waitcnt vmcnt(22)
  v_mfma_f32_32x32x16_bf16 v[32:47], a[36:39], a[164:167], v[32:47]
  s_waitcnt vmcnt(21)
  v_mfma_f32_32x32x16_bf16 v[32:47], a[40:43], a[168:171], v[32:47]
  s_waitcnt vmcnt(20)
  v_mfma_f32_32x32x16_bf16 v[32:47], a[44:47], a[172:175], v[32:47]
  s_waitcnt vmcnt(19)
  v_mfma_f32_32x32x16_bf16 v[32:47], a[48:51], a[176:179], v[32:47]
  s_waitcnt vmcnt(18)
  v_mfma_f32_32x32x16_bf16 v[32:47], a[52:55], a[180:183], v[32:47]
  s_waitcnt vmcnt(17)
  v_mfma_f32_32x32x16_bf16 v[32:47], a[56:59], a[184:187], v[32:47]
  s_waitcnt vmcnt(16)
  v_mfma_f32_32x32x16_bf16 v[32:47], a[60:63], a[188:191], v[32:47]
  s_waitcnt vmcnt(15)
  v_mfma_f32_32x32x16_bf16 v[32:47], a[64:67], a[192:195], v[32:47]
  s_waitcnt vmcnt(14)
  v_mfma_f32_32x32x16_bf16 v[32:47], a[68:71], a[196:199], v[32:47]
  s_waitcnt vmcnt(13)
  v_mfma_f32_32x32x16_bf16 v[32:47], a[72:75], a[200:203], v[32:47]
  s_waitcnt vmcnt(12)
  v_mfma_f32_32x32x16_bf16 v[32:47], a[76:79], a[204:207], v[32:47]
  s_waitcnt vmcnt(11)
  v_mfma_f32_32x32x16_bf16 v[32:47], a[80:83], a[208:211], v[32:47]
  s_waitcnt vmcnt(10)
  v_mfma_f32_32x32x16_bf16 v[32:47], a[84:87], a[212:215], v[32:47]
  s_waitcnt vmcnt(9)
  v_mfma_f32_32x32x16_bf16 v[32:47], a[88:91], a[216:219], v[32:47]
  s_waitcnt vmcnt(8)
  v_mfma_f32_32x32x16_bf16 v[32:47], a[92:95], a[220:223], v[32:47]
  s_waitcnt vmcnt(7)
  v_mfma_f32_32x32x16_bf16 v[32:47], a[96:99], a[224:227], v[32:47]
  s_waitcnt vmcnt(6)
  v_mfma_f32_32x32x16_bf16 v[32:47], a[100:103], a[228:231], v[32:47]
  s_waitcnt vmcnt(5)
  v_mfma_f32_32x32x16_bf16 v[32:47], a[104:107], a[232:235], v[32:47]
  s_waitcnt vmcnt(4)
  v_mfma_f32_32x32x16_bf16 v[32:47], a[108:111], a[236:239], v[32:47]
  s_waitcnt vmcnt(3)
  v_mfma_f32_32x32x16_bf16 v[32:47], a[112:115], a[240:243], v[32:47]
  s_waitcnt vmcnt(2)
  v_mfma_f32_32x32x16_bf16 v[32:47], a[116:119], a[244:247], v[32:47]
  s_waitcnt vmcnt(1)
  v_mfma_f32_32x32x16_bf16 v[32:47], a[120:123], a[248:251], v[32:47]
  s_waitcnt vmcnt(0)
  v_mfma_f32_32x32x16_bf16 v[32:47], a[124:127], a[252:255], v[32:47]
  s_mov_b32 s24, 0x3eb8aa3b
  s_nop 10
  v_mul_f32 v32, s24, v32
  s_nop 9
  v_mul_f32 v33, s24, v33
  s_nop 8
  v_mul_f32 v34, s24, v34
  s_nop 7
  v_mul_f32 v35, s24, v35
  s_nop 6
  v_mul_f32 v36, s24, v36
  s_nop 5
  v_mul_f32 v37, s24, v37
  s_nop 4
  v_mul_f32 v38, s24, v38
  s_nop 3
  v_mul_f32 v39, s24, v39
  s_nop 2
  v_mul_f32 v40, s24, v40
  s_nop 1
  v_mul_f32 v41, s24, v41
  s_nop 0
  v_mul_f32 v42, s24, v42
  v_mul_f32 v43, s24, v43
  v_mul_f32 v44, s24, v44
  v_mul_f32 v45, s24, v45
  v_mul_f32 v46, s24, v46
  v_mul_f32 v47, s24, v47
  v_cvt_pk_bf16_f32 v16, v32, v33
  v_cvt_pk_bf16_f32 v17, v34, v35
  v_cvt_pk_bf16_f32 v18, v36, v37
  v_cvt_pk_bf16_f32 v19, v38, v39
  v_cvt_pk_bf16_f32 v20, v40, v41
  v_cvt_pk_bf16_f32 v21, v42, v43
  v_cvt_pk_bf16_f32 v22, v44, v45
  v_cvt_pk_bf16_f32 v23, v46, v47
  v_mov_b32 v24, 0xff800000
  v_mov_b32 v25, 0xff800000
  v_mov_b32 v14, v9
  ds_read_b128 v[160:163], v14 offset:0
  ds_read_b128 v[164:167], v14 offset:1024
  s_waitcnt lgkmcnt(1)
  v_mfma_f32_32x32x16_bf16 v[32:47], v[160:163], v[16:19], 0
  v_mfma_f32_32x32x16_bf16 v[48:63], v[160:163], v[20:23], 0
  s_mov_b32 s26, 0
L_b2_p1:
  ds_read_b128 v[168:171], v14 offset:2048
  s_waitcnt lgkmcnt(1)
  v_mfma_f32_32x32x16_bf16 v[64:79], v[164:167], v[16:19], 0
  v_max3_f32 v24, v32, v33, v24
  v_max3_f32 v24, v34, v35, v24
  v_max3_f32 v24, v36, v37, v24
  v_max3_f32 v24, v38, v39, v24
  v_max3_f32 v24, v40, v41, v24
  v_max3_f32 v24, v42, v43, v24
  v_max3_f32 v24, v44, v45, v24
  v_max3_f32 v24, v46, v47, v24
  v_mfma_f32_32x32x16_bf16 v[80:95], v[164:167], v[20:23], 0
  v_max3_f32 v25, v48, v49, v25
  v_max3_f32 v25, v50, v51, v25
  v_max3_f32 v25, v52, v53, v25
  v_max3_f32 v25, v54, v55, v25
  v_max3_f32 v25, v56, v57, v25
  v_max3_f32 v25, v58, v59, v25
  v_max3_f32 v25, v60, v61, v25
  v_max3_f32 v25, v62, v63, v25
  ds_read_b128 v[172:175], v14 offset:3072
  s_waitcnt lgkmcnt(1)
  v_mfma_f32_32x32x16_bf16 v[32:47], v[168:171], v[16:19], 0
  v_max3_f32 v24, v64, v65, v24
  v_max3_f32 v24, v66, v67, v24
  v_max3_f32 v24, v68, v69, v24
  v_max3_f32 v24, v70, v71, v24
  v_max3_f32 v24, v72, v73, v24
  v_max3_f32 v24, v74, v75, v24
  v_max3_f32 v24, v76, v77, v24
  v_max3_f32 v24, v78, v79, v24
  v_mfma_f32_32x32x16_bf16 v[48:63], v[168:171], v[20:23], 0
  v_max3_f32 v25, v80, v81, v25
  v_max3_f32 v25, v82, v83, v25
  v_max3_f32 v25, v84, v85, v25
  v_max3_f32 v25, v86, v87, v25
  v_max3_f32 v25, v88, v89, v25
  v_max3_f32 v25, v90, v91, v25
  v_max3_f32 v25, v92, v93, v25
  v_max3_f32 v25, v94, v95, v25
  ds_read_b128 v[160:163], v14 offset:4096
  s_waitcnt lgkmcnt(1)
  v_mfma_f32_32x32x16_bf16 v[64:79], v[172:175], v[16:19], 0
  v_max3_f32 v24, v32, v33, v24
  v_max3_f32 v24, v34, v35, v24
  v_max3_f32 v24, v36, v37, v24
  v_max3_f32 v24, v38, v39, v24
  v_max3_f32 v24, v40, v41, v24
  v_max3_f32 v24, v42, v43, v24
  v_max3_f32 v24, v44, v45, v24
  v_max3_f32 v24, v46, v47, v24
  v_mfma_f32_32x32x16_bf16 v[80:95], v[172:175], v[20:23], 0
  v_max3_f32 v25, v48, v49, v25
  v_max3_f32 v25, v50, v51, v25
  v_max3_f32 v25, v52, v53, v25
  v_max3_f32 v25, v54, v55, v25
  v_max3_f32 v25, v56, v57, v25
  v_max3_f32 v25, v58, v59, v25
  v_max3_f32 v25, v60, v61, v25
  v_max3_f32 v25, v62, v63, v25
  ds_read_b128 v[164:167], v14 offset:5120
  s_waitcnt lgkmcnt(1)
  v_mfma_f32_32x32x16_bf16 v[32:47], v[160:163], v[16:19], 0
  v_max3_f32 v24, v64, v65, v24
  v_max3_f32 v24, v66, v67, v24
  v_max3_f32 v24, v68, v69, v24
  v_max3_f32 v24, v70, v71, v24
  v_max3_f32 v24, v72, v73, v24
  v_max3_f32 v24, v74, v75, v24
  v_max3_f32 v24, v76, v77, v24
  v_max3_f32 v24, v78, v79, v24
  v_mfma_f32_32x32x16_bf16 v[48:63], v[160:163], v[20:23], 0
  v_max3_f32 v25, v80, v81, v25
  v_max3_f32 v25, v82, v83, v25
  v_max3_f32 v25, v84, v85, v25
  v_max3_f32 v25, v86, v87, v25
  v_max3_f32 v25, v88, v89, v25
  v_max3_f32 v25, v90, v91, v25
  v_max3_f32 v25, v92, v93, v25
  v_max3_f32 v25, v94, v95, v25
  v_add_u32 v14, 4096, v14
  s_add_u32 s26, s26, 4
  s_cmp_lt_u32 s26, 64
  s_cbranch_scc1 L_b2_p1
  s_waitcnt lgkmcnt(0)
  v_mov_b32 v2, v24
  s_nop 1
  v_permlane32_swap_b32 v24, v2
  v_max_f32 v24, v24, v2
  v_sub_f32 v24, 0, v24
  v_mov_b32 v96, v24
  v_mov_b32 v97, v24
  v_mov_b32 v98, v24
  v_mov_b32 v99, v24
  v_mov_b32 v100, v24
  v_mov_b32 v101, v24
  v_mov_b32 v102, v24
  v_mov_b32 v103, v24
  v_mov_b32 v104, v24
  v_mov_b32 v105, v24
  v_mov_b32 v106, v24
  v_mov_b32 v107, v24
  v_mov_b32 v108, v24
  v_mov_b32 v109, v24
  v_mov_b32 v110, v24
  v_mov_b32 v111, v24
  v_mov_b32 v128, 0
  v_mov_b32 v129, 0
  v_mov_b32 v130, 0
  v_mov_b32 v131, 0
  v_mov_b32 v132, 0
  v_mov_b32 v133, 0
  v_mov_b32 v134, 0
  v_mov_b32 v135, 0
  v_mov_b32 v136, 0
  v_mov_b32 v137, 0
  v_mov_b32 v138, 0
  v_mov_b32 v139, 0
  v_mov_b32 v140, 0
  v_mov_b32 v141, 0
  v_mov_b32 v142, 0
  v_mov_b32 v143, 0
  v_mov_b32 v2, v25
  s_nop 1
  v_permlane32_swap_b32 v25, v2
  v_max_f32 v25, v25, v2
  v_sub_f32 v25, 0, v25
  v_mov_b32 v112, v25
  v_mov_b32 v113, v25
  v_mov_b32 v114, v25
  v_mov_b32 v115, v25
  v_mov_b32 v116, v25
  v_mov_b32 v117, v25
  v_mov_b32 v118, v25
  v_mov_b32 v119, v25
  v_mov_b32 v120, v25
  v_mov_b32 v121, v25
  v_mov_b32 v122, v25
  v_mov_b32 v123, v25
  v_mov_b32 v124, v25
  v_mov_b32 v125, v25
  v_mov_b32 v126, v25
  v_mov_b32 v127, v25
  v_mov_b32 v144, 0
  v_mov_b32 v145, 0
  v_mov_b32 v146, 0
  v_mov_b32 v147, 0
  v_mov_b32 v148, 0
  v_mov_b32 v149, 0
  v_mov_b32 v150, 0
  v_mov_b32 v151, 0
  v_mov_b32 v152, 0
  v_mov_b32 v153, 0
  v_mov_b32 v154, 0
  v_mov_b32 v155, 0
  v_mov_b32 v156, 0
  v_mov_b32 v157, 0
  v_mov_b32 v158, 0
  v_mov_b32 v159, 0
  v_mov_b32 v14, v9
  v_mov_b32 v15, v11
  ds_read_b128 v[160:163], v14 offset:0
  ds_read_b128 v[164:167], v14 offset:1024
  ds_read_b128 v[176:179], v15
  ds_read_b128 v[180:183], v15 offset:512
  v_add_u32 v15, v15, v12
  s_waitcnt lgkmcnt(3)
  v_mfma_f32_32x32x16_bf16 v[32:47], v[160:163], v[16:19], v[96:111]
  v_mfma_f32_32x32x16_bf16 v[48:63], v[160:163], v[20:23], v[112:127]
  s_mov_b32 s26, 0
L_b2_p2:
  ds_read_b128 v[168:171], v14 offset:2048
  ds_read_b128 v[184:187], v15
  ds_read_b128 v[188:191], v15 offset:512
  v_add_u32 v15, v15, v12
  s_waitcnt lgkmcnt(3)
  v_mfma_f32_32x32x16_bf16 v[64:79], v[164:167], v[16:19], v[96:111]
  v_exp_f32 v32, v32
  v_exp_f32 v33, v33
  v_exp_f32 v34, v34
  v_exp_f32 v35, v35
  v_exp_f32 v36, v36
  v_mfma_f32_32x32x16_bf16 v[80:95], v[164:167], v[20:23], v[112:127]
  v_exp_f32 v37, v37
  v_exp_f32 v38, v38
  v_exp_f32 v39, v39
  v_exp_f32 v40, v40
  v_exp_f32 v41, v41
  v_exp_f32 v42, v42
  v_exp_f32 v43, v43
  v_exp_f32 v44, v44
  v_exp_f32 v45, v45
  v_exp_f32 v46, v46
  v_exp_f32 v47, v47
  v_cvt_pk_bf16_f32 v192, v32, v33
  v_cvt_pk_bf16_f32 v193, v34, v35
  v_cvt_pk_bf16_f32 v194, v36, v37
  v_cvt_pk_bf16_f32 v195, v38, v39
  v_cvt_pk_bf16_f32 v196, v40, v41
  v_cvt_pk_bf16_f32 v197, v42, v43
  v_cvt_pk_bf16_f32 v198, v44, v45
  v_cvt_pk_bf16_f32 v199, v46, v47
  v_exp_f32 v48, v48
  v_exp_f32 v49, v49
  v_mfma_f32_32x32x16_bf16 v[128:143], v[176:179], v[192:195], v[128:143]
  v_exp_f32 v50, v50
  v_exp_f32 v51, v51
  v_exp_f32 v52, v52
  v_exp_f32 v53, v53
  v_exp_f32 v54, v54
  v_mfma_f32_32x32x16_bf16 v[128:143], v[180:183], v[196:199], v[128:143]
  v_exp_f32 v55, v55
  v_exp_f32 v56, v56
  v_exp_f32 v57, v57
  v_exp_f32 v58, v58
  v_exp_f32 v59, v59
  v_exp_f32 v60, v60
  v_exp_f32 v61, v61
  v_exp_f32 v62, v62
  v_exp_f32 v63, v63
  v_cvt_pk_bf16_f32 v200, v48, v49
  v_cvt_pk_bf16_f32 v201, v50, v51
  v_cvt_pk_bf16_f32 v202, v52, v53
  v_cvt_pk_bf16_f32 v203, v54, v55
  v_cvt_pk_bf16_f32 v204, v56, v57
  v_cvt_pk_bf16_f32 v205, v58, v59
  v_cvt_pk_bf16_f32 v206, v60, v61
  v_cvt_pk_bf16_f32 v207, v62, v63
  s_nop 1
  v_mfma_f32_32x32x16_bf16 v[144:159], v[176:179], v[200:203], v[144:159]
  v_mfma_f32_32x32x16_bf16 v[144:159], v[180:183], v[204:207], v[144:159]
  ds_read_b128 v[172:175], v14 offset:3072
  ds_read_b128 v[176:179], v15
  ds_read_b128 v[180:183], v15 offset:512
  v_add_u32 v15, v15, v12
  s_waitcnt lgkmcnt(3)
  v_mfma_f32_32x32x16_bf16 v[32:47], v[168:171], v[16:19], v[96:111]
  v_exp_f32 v64, v64
  v_exp_f32 v65, v65
  v_exp_f32 v66, v66
  v_exp_f32 v67, v67
  v_exp_f32 v68, v68
  v_mfma_f32_32x32x16_bf16 v[48:63], v[168:171], v[20:23], v[112:127]
  v_exp_f32 v69, v69
  v_exp_f32 v70, v70
  v_exp_f32 v71, v71
  v_exp_f32 v72, v72
  v_exp_f32 v73, v73
  v_exp_f32 v74, v74
  v_exp_f32 v75, v75
  v_exp_f32 v76, v76
  v_exp_f32 v77, v77
  v_exp_f32 v78, v78
  v_exp_f32 v79, v79
  v_cvt_pk_bf16_f32 v192, v64, v65
  v_cvt_pk_bf16_f32 v193, v66, v67
  v_cvt_pk_bf16_f32 v194, v68, v69
  v_cvt_pk_bf16_f32 v195, v70, v71
  v_cvt_pk_bf16_f32 v196, v72, v73
  v_cvt_pk_bf16_f32 v197, v74, v75
  v_cvt_pk_bf16_f32 v198, v76, v77
  v_cvt_pk_bf16_f32 v199, v78, v79
  v_exp_f32 v80, v80
  v_exp_f32 v81, v81
  v_mfma_f32_32x32x16_bf16 v[128:143], v[184:187], v[192:195], v[128:143]
  v_exp_f32 v82, v82
  v_exp_f32 v83, v83
  v_exp_f32 v84, v84
  v_exp_f32 v85, v85
  v_exp_f32 v86, v86
  v_mfma_f32_32x32x16_bf16 v[128:143], v[188:191], v[196:199], v[128:143]
  v_exp_f32 v87, v87
  v_exp_f32 v88, v88
  v_exp_f32 v89, v89
  v_exp_f32 v90, v90
  v_exp_f32 v91, v91
  v_exp_f32 v92, v92
  v_exp_f32 v93, v93
  v_exp_f32 v94, v94
  v_exp_f32 v95, v95
  v_cvt_pk_bf16_f32 v200, v80, v81
  v_cvt_pk_bf16_f32 v201, v82, v83
  v_cvt_pk_bf16_f32 v202, v84, v85
  v_cvt_pk_bf16_f32 v203, v86, v87
  v_cvt_pk_bf16_f32 v204, v88, v89
  v_cvt_pk_bf16_f32 v205, v90, v91
  v_cvt_pk_bf16_f32 v206, v92, v93
  v_cvt_pk_bf16_f32 v207, v94, v95
  s_nop 1
  v_mfma_f32_32x32x16_bf16 v[144:159], v[184:187], v[200:203], v[144:159]
  v_mfma_f32_32x32x16_bf16 v[144:159], v[188:191], v[204:207], v[144:159]
  ds_read_b128 v[160:163], v14 offset:4096
  ds_read_b128 v[184:187], v15
  ds_read_b128 v[188:191], v15 offset:512
  v_add_u32 v15, v15, v12
  s_waitcnt lgkmcnt(3)
  v_mfma_f32_32x32x16_bf16 v[64:79], v[172:175], v[16:19], v[96:111]
  v_exp_f32 v32, v32
  v_exp_f32 v33, v33
  v_exp_f32 v34, v34
  v_exp_f32 v35, v35
  v_exp_f32 v36, v36
  v_mfma_f32_32x32x16_bf16 v[80:95], v[172:175], v[20:23], v[112:127]
  v_exp_f32 v37, v37
  v_exp_f32 v38, v38
  v_exp_f32 v39, v39
  v_exp_f32 v40, v40
  v_exp_f32 v41, v41
  v_exp_f32 v42, v42
  v_exp_f32 v43, v43
  v_exp_f32 v44, v44
  v_exp_f32 v45, v45
  v_exp_f32 v46, v46
  v_exp_f32 v47, v47
  v_cvt_pk_bf16_f32 v192, v32, v33
  v_cvt_pk_bf16_f32 v193, v34, v35
  v_cvt_pk_bf16_f32 v194, v36, v37
  v_cvt_pk_bf16_f32 v195, v38, v39
  v_cvt_pk_bf16_f32 v196, v40, v41
  v_cvt_pk_bf16_f32 v197, v42, v43
  v_cvt_pk_bf16_f32 v198, v44, v45
  v_cvt_pk_bf16_f32 v199, v46, v47
  v_exp_f32 v48, v48
  v_exp_f32 v49, v49
  v_mfma_f32_32x32x16_bf16 v[128:143], v[176:179], v[192:195], v[128:143]
  v_exp_f32 v50, v50
  v_exp_f32 v51, v51
  v_exp_f32 v52, v52
  v_exp_f32 v53, v53
  v_exp_f32 v54, v54
  v_mfma_f32_32x32x16_bf16 v[128:143], v[180:183], v[196:199], v[128:143]
  v_exp_f32 v55, v55
  v_exp_f32 v56, v56
  v_exp_f32 v57, v57
  v_exp_f32 v58, v58
  v_exp_f32 v59, v59
  v_exp_f32 v60, v60
  v_exp_f32 v61, v61
  v_exp_f32 v62, v62
  v_exp_f32 v63, v63
  v_cvt_pk_bf16_f32 v200, v48, v49
  v_cvt_pk_bf16_f32 v201, v50, v51
  v_cvt_pk_bf16_f32 v202, v52, v53
  v_cvt_pk_bf16_f32 v203, v54, v55
  v_cvt_pk_bf16_f32 v204, v56, v57
  v_cvt_pk_bf16_f32 v205, v58, v59
  v_cvt_pk_bf16_f32 v206, v60, v61
  v_cvt_pk_bf16_f32 v207, v62, v63
  s_nop 1
  v_mfma_f32_32x32x16_bf16 v[144:159], v[176:179], v[200:203], v[144:159]
  v_mfma_f32_32x32x16_bf16 v[144:159], v[180:183], v[204:207], v[144:159]
  ds_read_b128 v[164:167], v14 offset:5120
  ds_read_b128 v[176:179], v15
  ds_read_b128 v[180:183], v15 offset:512
  v_add_u32 v15, v15, v12
  s_waitcnt lgkmcnt(3)
  v_mfma_f32_32x32x16_bf16 v[32:47], v[160:163], v[16:19], v[96:111]
  v_exp_f32 v64, v64
  v_exp_f32 v65, v65
  v_exp_f32 v66, v66
  v_exp_f32 v67, v67
  v_exp_f32 v68, v68
  v_mfma_f32_32x32x16_bf16 v[48:63], v[160:163], v[20:23], v[112:127]
  v_exp_f32 v69, v69
  v_exp_f32 v70, v70
  v_exp_f32 v71, v71
  v_exp_f32 v72, v72
  v_exp_f32 v73, v73
  v_exp_f32 v74, v74
  v_exp_f32 v75, v75
  v_exp_f32 v76, v76
  v_exp_f32 v77, v77
  v_exp_f32 v78, v78
  v_exp_f32 v79, v79
  v_cvt_pk_bf16_f32 v192, v64, v65
  v_cvt_pk_bf16_f32 v193, v66, v67
  v_cvt_pk_bf16_f32 v194, v68, v69
  v_cvt_pk_bf16_f32 v195, v70, v71
  v_cvt_pk_bf16_f32 v196, v72, v73
  v_cvt_pk_bf16_f32 v197, v74, v75
  v_cvt_pk_bf16_f32 v198, v76, v77
  v_cvt_pk_bf16_f32 v199, v78, v79
  v_exp_f32 v80, v80
  v_exp_f32 v81, v81
  v_mfma_f32_32x32x16_bf16 v[128:143], v[184:187], v[192:195], v[128:143]
  v_exp_f32 v82, v82
  v_exp_f32 v83, v83
  v_exp_f32 v84, v84
  v_exp_f32 v85, v85
  v_exp_f32 v86, v86
  v_mfma_f32_32x32x16_bf16 v[128:143], v[188:191], v[196:199], v[128:143]
  v_exp_f32 v87, v87
  v_exp_f32 v88, v88
  v_exp_f32 v89, v89
  v_exp_f32 v90, v90
  v_exp_f32 v91, v91
  v_exp_f32 v92, v92
  v_exp_f32 v93, v93
  v_exp_f32 v94, v94
  v_exp_f32 v95, v95
  v_cvt_pk_bf16_f32 v200, v80, v81
  v_cvt_pk_bf16_f32 v201, v82, v83
  v_cvt_pk_bf16_f32 v202, v84, v85
  v_cvt_pk_bf16_f32 v203, v86, v87
  v_cvt_pk_bf16_f32 v204, v88, v89
  v_cvt_pk_bf16_f32 v205, v90, v91
  v_cvt_pk_bf16_f32 v206, v92, v93
  v_cvt_pk_bf16_f32 v207, v94, v95
  s_nop 1
  v_mfma_f32_32x32x16_bf16 v[144:159], v[184:187], v[200:203], v[144:159]
  v_mfma_f32_32x32x16_bf16 v[144:159], v[188:191], v[204:207], v[144:159]
  v_add_u32 v14, 4096, v14
  s_add_u32 s26, s26, 4
  s_cmp_lt_u32 s26, 64
  s_cbranch_scc1 L_b2_p2
  s_waitcnt lgkmcnt(0)
  s_lshl_b32 s20, s31, 4
  s_add_u32 s20, s20, s30
  s_lshl_b32 s20, s20, 11
  s_add_u32 s20, s20, 2097152
  v_rcp_f32 v2, v136
  s_nop 0
  v_mul_f32 v128, v128, v2
  v_mul_f32 v129, v129, v2
  v_mul_f32 v130, v130, v2
  v_mul_f32 v131, v131, v2
  v_mul_f32 v132, v132, v2
  v_mul_f32 v133, v133, v2
  v_mul_f32 v134, v134, v2
  v_mul_f32 v135, v135, v2
  v_cvt_pk_bf16_f32 v192, v128, v129
  v_cvt_pk_bf16_f32 v193, v130, v131
  v_cvt_pk_bf16_f32 v194, v132, v133
  v_cvt_pk_bf16_f32 v195, v134, v135
  buffer_store_dwordx4 v[192:195], v13, s[8:11], s20 offen offset:0 sc1
  v_rcp_f32 v2, v152
  s_nop 0
  v_mul_f32 v144, v144, v2
  v_mul_f32 v145, v145, v2
  v_mul_f32 v146, v146, v2
  v_mul_f32 v147, v147, v2
  v_mul_f32 v148, v148, v2
  v_mul_f32 v149, v149, v2
  v_mul_f32 v150, v150, v2
  v_mul_f32 v151, v151, v2
  v_cvt_pk_bf16_f32 v200, v144, v145
  v_cvt_pk_bf16_f32 v201, v146, v147
  v_cvt_pk_bf16_f32 v202, v148, v149
  v_cvt_pk_bf16_f32 v203, v150, v151
  buffer_store_dwordx4 v[200:203], v13, s[8:11], s20 offen offset:512 sc1
  s_waitcnt vmcnt(0)
  s_barrier
  s_lshl_b32 s20, s31, 2
  s_and_b32 s21, s17, 3
  s_add_u32 s20, s20, s21
  s_lshl_b32 s20, s20, 2
  s_add_u32 s20, s20, 16384
  v_mov_b32 v2, 0
  v_mov_b32 v3, 1
  s_cmp_eq_u32 s16, 0
  s_cselect_b64 exec, 1, 0
  buffer_store_dword v3, v2, s[8:11], s20 offen sc1
  s_mov_b64 exec, -1
  s_add_u32 s31, s31, 56
  s_cmp_lt_u32 s31, 64
  s_cbranch_scc1 L_b2_task
  s_waitcnt vmcnt(0)
  s_cmp_lt_u32 s17, 160
  s_cbranch_scc1 L_go_t3b
  s_sub_u32 s30, s17, 160
  s_cmp_lt_u32 s30, 32
  s_cbranch_scc0 L_t3a_done
  s_and_b32 s35, s30, 7
  s_lshr_b32 s31, s30, 3
  s_lshl_b32 s32, s35, 2
  s_add_u32 s32, s32, s16
  v_lshlrev_b32 v9, 4, v0
  v_and_b32 v10, 15, v0
  v_lshrrev_b32 v11, 4, v0
  v_lshlrev_b32 v11, 2, v11
  s_mov_b32 s48, 0x3e0293ee
  v_add_u32 v2, 0, v11
  v_cmp_le_u32 s[50:51], v2, v10
  v_add_u32 v2, 1, v11
  v_cmp_le_u32 s[52:53], v2, v10
  v_add_u32 v2, 2, v11
  v_cmp_le_u32 s[54:55], v2, v10
  v_add_u32 v2, 3, v11
  v_cmp_le_u32 s[56:57], v2, v10
L_t3a_task:
  s_lshl_b32 s20, s31, 5
  s_add_u32 s20, s20, s32
  s_lshl_b32 s21, s20, 13
  s_add_u32 s22, s21, 50331648
  s_add_u32 s23, s21, 67108864
  s_add_u32 s25, s21, 83886080
  s_lshl_b32 s24, s20, 14
  s_add_u32 s24, s24, 16777216
  s_lshl_b32 s33, s32, 7
  s_add_u32 s33, s33, 8192
  s_lshl_b32 s34, s32, 8
  s_lshl_b32 s20, s31, 2
  s_add_u32 s34, s34, s20
  s_add_u32 s34, s34, 0
L_t3a_w1:
  v_mov_b32 v2, 0
  buffer_load_dword v4, v2, s[8:11], s34 offen sc1
  s_waitcnt vmcnt(0)
  v_cmp_eq_u32 vcc, 0, v4
  s_cbranch_vccz L_t3a_g1
  s_sleep 8
  s_add_u32 s19, s19, 1
  s_cmp_lt_u32 s19, 2097152
  s_cselect_b64 s[20:21], -1, 0
  s_and_b64 vcc, vcc, s[20:21]
  s_cbranch_vccnz L_t3a_w1
L_t3a_g1:
  s_add_u32 s26, s22, 0
  s_add_u32 s27, s24, 0
  buffer_load_dwordx4 v[16:19], v9, s[8:11], s26 offen offset:0 sc1
  buffer_load_dwordx4 v[20:23], v9, s[8:11], s26 offen offset:1024 sc1
  buffer_load_dwordx4 v[48:51], v9, s[8:11], s27 offen offset:0 sc1
  buffer_load_dwordx4 v[52:55], v9, s[8:11], s27 offen offset:1024 sc1
  buffer_load_dwordx4 v[80:83], v9, s[8:11], s27 offen offset:2048 sc1
  buffer_load_dwordx4 v[84:87], v9, s[8:11], s27 offen offset:3072 sc1
  s_add_u32 s26, s22, 2048
  s_add_u32 s27, s24, 4096
  buffer_load_dwordx4 v[24:27], v9, s[8:11], s26 offen offset:0 sc1
  buffer_load_dwordx4 v[28:31], v9, s[8:11], s26 offen offset:1024 sc1
  buffer_load_dwordx4 v[56:59], v9, s[8:11], s27 offen offset:0 sc1
  buffer_load_dwordx4 v[60:63], v9, s[8:11], s27 offen offset:1024 sc1
  buffer_load_dwordx4 v[88:91], v9, s[8:11], s27 offen offset:2048 sc1
  buffer_load_dwordx4 v[92:95], v9, s[8:11], s27 offen offset:3072 sc1
  s_add_u32 s26, s22, 4096
  s_add_u32 s27, s24, 8192
  buffer_load_dwordx4 v[32:35], v9, s[8:11], s26 offen offset:0 sc1
  buffer_load_dwordx4 v[36:39], v9, s[8:11], s26 offen offset:1024 sc1
  buffer_load_dwordx4 v[64:67], v9, s[8:11], s27 offen offset:0 sc1
  buffer_load_dwordx4 v[68:71], v9, s[8:11], s27 offen offset:1024 sc1
  buffer_load_dwordx4 v[96:99], v9, s[8:11], s27 offen offset:2048 sc1
  buffer_load_dwordx4 v[100:103], v9, s[8:11], s27 offen offset:3072 sc1
  s_add_u32 s26, s22, 6144
  s_add_u32 s27, s24, 12288
  buffer_load_dwordx4 v[40:43], v9, s[8:11], s26 offen offset:0 sc1
  buffer_load_dwordx4 v[44:47], v9, s[8:11], s26 offen offset:1024 sc1
  buffer_load_dwordx4 v[72:75], v9, s[8:11], s27 offen offset:0 sc1
  buffer_load_dwordx4 v[76:79], v9, s[8:11], s27 offen offset:1024 sc1
  buffer_load_dwordx4 v[104:107], v9, s[8:11], s27 offen offset:2048 sc1
  buffer_load_dwordx4 v[108:111], v9, s[8:11], s27 offen offset:3072 sc1
  s_waitcnt vmcnt(20)
  v_mfma_f32_16x16x32_bf16 v[152:155], v[48:51], v[16:19], 0
  v_mfma_f32_16x16x32_bf16 v[156:159], v[48:51], v[20:23], 0
  v_mfma_f32_16x16x32_bf16 v[160:163], v[52:55], v[20:23], 0
  s_waitcnt vmcnt(14)
  v_mfma_f32_16x16x32_bf16 v[152:155], v[56:59], v[24:27], v[152:155]
  v_mfma_f32_16x16x32_bf16 v[156:159], v[56:59], v[28:31], v[156:159]
  v_mfma_f32_16x16x32_bf16 v[160:163], v[60:63], v[28:31], v[160:163]
  s_waitcnt vmcnt(8)
  v_mfma_f32_16x16x32_bf16 v[152:155], v[64:67], v[32:35], v[152:155]
  v_mfma_f32_16x16x32_bf16 v[156:159], v[64:67], v[36:39], v[156:159]
  v_mfma_f32_16x16x32_bf16 v[160:163], v[68:71], v[36:39], v[160:163]
  s_waitcnt vmcnt(2)
  v_mfma_f32_16x16x32_bf16 v[152:155], v[72:75], v[40:43], v[152:155]
  v_mfma_f32_16x16x32_bf16 v[156:159], v[72:75], v[44:47], v[156:159]
  v_mfma_f32_16x16x32_bf16 v[160:163], v[76:79], v[44:47], v[160:163]
L_t3a_w2:
  v_mov_b32 v2, 0
  buffer_load_dword v3, v2, s[8:11], s33 offen sc1
  s_waitcnt vmcnt(0)
  v_cmp_ge_u32 vcc, s31, v3
  s_cbranch_vccz L_t3a_g2
  v_readfirstlane_b32 s20, v3
  s_nop 3
  s_sub_u32 s20, s31, s20
  s_cmp_ge_u32 s20, 2
  s_cbranch_scc0 L_t3a_short
  s_sleep 32
L_t3a_short:
  s_sleep 2
  s_add_u32 s19, s19, 1
  s_cmp_lt_u32 s19, 2097152
  s_cselect_b64 s[20:21], -1, 0
  s_and_b64 vcc, vcc, s[20:21]
  s_cbranch_vccnz L_t3a_w2
L_t3a_g2:
  s_add_u32 s28, s23, 0
  buffer_load_dwordx4 v[112:115], v9, s[8:11], s28 offen sc1
  buffer_load_dwordx4 v[128:131], v9, s[8:11], s28 offen offset:1024 sc1
  s_add_u32 s28, s23, 2048
  buffer_load_dwordx4 v[116:119], v9, s[8:11], s28 offen sc1
  buffer_load_dwordx4 v[132:135], v9, s[8:11], s28 offen offset:1024 sc1
  s_add_u32 s28, s23, 4096
  buffer_load_dwordx4 v[120:123], v9, s[8:11], s28 offen sc1
  buffer_load_dwordx4 v[136:139], v9, s[8:11], s28 offen offset:1024 sc1
  s_add_u32 s28, s23, 6144
  buffer_load_dwordx4 v[124:127], v9, s[8:11], s28 offen sc1
  buffer_load_dwordx4 v[140:143], v9, s[8:11], s28 offen offset:1024 sc1
  s_waitcnt vmcnt(7)
  v_mfma_f32_16x16x32_bf16 v[144:147], v[112:115], v[16:19], 0
  v_mfma_f32_16x16x32_bf16 v[148:151], v[112:115], v[20:23], 0
  s_waitcnt vmcnt(5)
  v_mfma_f32_16x16x32_bf16 v[144:147], v[116:119], v[24:27], v[144:147]
  v_mfma_f32_16x16x32_bf16 v[148:151], v[116:119], v[28:31], v[148:151]
  s_waitcnt vmcnt(3)
  v_mfma_f32_16x16x32_bf16 v[144:147], v[120:123], v[32:35], v[144:147]
  v_mfma_f32_16x16x32_bf16 v[148:151], v[120:123], v[36:39], v[148:151]
  s_waitcnt vmcnt(1)
  v_mfma_f32_16x16x32_bf16 v[144:147], v[124:127], v[40:43], v[144:147]
  v_mfma_f32_16x16x32_bf16 v[148:151], v[124:127], v[44:47], v[148:151]
  s_waitcnt vmcnt(0)
  v_mov_b32 v5, 0xf149f2ca
  v_cndmask_b32 v152, v5, v152, s[50:51]
  v_cndmask_b32 v160, v5, v160, s[50:51]
  v_cndmask_b32 v153, v5, v153, s[52:53]
  v_cndmask_b32 v161, v5, v161, s[52:53]
  v_cndmask_b32 v154, v5, v154, s[54:55]
  v_cndmask_b32 v162, v5, v162, s[54:55]
  v_cndmask_b32 v155, v5, v155, s[56:57]
  v_cndmask_b32 v163, v5, v163, s[56:57]
  v_max3_f32 v2, v144, v146, v152
  v_max3_f32 v2, v2, v153, v154
  v_max_f32 v2, v2, v155
  v_mov_b32 v3, v2
  s_nop 1
  v_permlane16_swap_b32 v2, v3
  v_max_f32 v2, v2, v3
  v_mov_b32 v3, v2
  s_nop 1
  v_permlane32_swap_b32 v2, v3
  v_max_f32 v2, v2, v3
  v_mul_f32 v2, s48, v2
  v_fma_f32 v144, v144, s48, -v2
  v_fma_f32 v145, v145, s48, -v2
  v_fma_f32 v146, v146, s48, -v2
  v_fma_f32 v147, v147, s48, -v2
  v_fma_f32 v152, v152, s48, -v2
  v_fma_f32 v153, v153, s48, -v2
  v_fma_f32 v154, v154, s48, -v2
  v_fma_f32 v155, v155, s48, -v2
  v_exp_f32 v144, v144
  v_exp_f32 v145, v145
  v_exp_f32 v146, v146
  v_exp_f32 v147, v147
  v_exp_f32 v152, v152
  v_exp_f32 v153, v153
  v_exp_f32 v154, v154
  v_exp_f32 v155, v155
  v_cvt_pk_bf16_f32 v164, v144, v145
  v_cvt_pk_bf16_f32 v165, v146, v147
  v_cvt_pk_bf16_f32 v168, v152, v153
  v_cvt_pk_bf16_f32 v169, v154, v155
  v_add_f32 v3, v144, v146
  v_add_f32 v3, v3, v152
  v_add_f32 v3, v3, v153
  v_add_f32 v3, v3, v154
  v_add_f32 v3, v3, v155
  v_mov_b32 v4, v3
  s_nop 1
  v_permlane16_swap_b32 v3, v4
  v_add_f32 v3, v3, v4
  v_mov_b32 v4, v3
  s_nop 1
  v_permlane32_swap_b32 v3, v4
  v_add_f32 v3, v3, v4
  v_rcp_f32 v6, v3
  v_max3_f32 v2, v148, v150, v156
  v_max3_f32 v2, v2, v157, v158
  v_max_f32 v2, v2, v159
  v_max3_f32 v2, v2, v160, v161
  v_max3_f32 v2, v2, v162, v163
  v_mov_b32 v3, v2
  s_nop 1
  v_permlane16_swap_b32 v2, v3
  v_max_f32 v2, v2, v3
  v_mov_b32 v3, v2
  s_nop 1
  v_permlane32_swap_b32 v2, v3
  v_max_f32 v2, v2, v3
  v_mul_f32 v2, s48, v2
  v_fma_f32 v148, v148, s48, -v2
  v_fma_f32 v149, v149, s48, -v2
  v_fma_f32 v150, v150, s48, -v2
  v_fma_f32 v151, v151, s48, -v2
  v_fma_f32 v156, v156, s48, -v2
  v_fma_f32 v157, v157, s48, -v2
  v_fma_f32 v158, v158, s48, -v2
  v_fma_f32 v159, v159, s48, -v2
  v_fma_f32 v160, v160, s48, -v2
  v_fma_f32 v161, v161, s48, -v2
  v_fma_f32 v162, v162, s48, -v2
  v_fma_f32 v163, v163, s48, -v2
  v_exp_f32 v148, v148
  v_exp_f32 v149, v149
  v_exp_f32 v150, v150
  v_exp_f32 v151, v151
  v_exp_f32 v156, v156
  v_exp_f32 v157, v157
  v_exp_f32 v158, v158
  v_exp_f32 v159, v159
  v_exp_f32 v160, v160
  v_exp_f32 v161, v161
  v_exp_f32 v162, v162
  v_exp_f32 v163, v163
  v_cvt_pk_bf16_f32 v166, v148, v149
  v_cvt_pk_bf16_f32 v167, v150, v151
  v_cvt_pk_bf16_f32 v172, v156, v157
  v_cvt_pk_bf16_f32 v173, v158, v159
  v_cvt_pk_bf16_f32 v174, v160, v161
  v_cvt_pk_bf16_f32 v175, v162, v163
  v_add_f32 v3, v148, v150
  v_add_f32 v3, v3, v156
  v_add_f32 v3, v3, v157
  v_add_f32 v3, v3, v158
  v_add_f32 v3, v3, v159
  v_add_f32 v3, v3, v160
  v_add_f32 v3, v3, v161
  v_add_f32 v3, v3, v162
  v_add_f32 v3, v3, v163
  v_mov_b32 v4, v3
  s_nop 1
  v_permlane16_swap_b32 v3, v4
  v_add_f32 v3, v3, v4
  v_mov_b32 v4, v3
  s_nop 1
  v_permlane32_swap_b32 v3, v4
  v_add_f32 v3, v3, v4
  v_rcp_f32 v7, v3
  v_mfma_f32_16x16x16_bf16 v[176:179], v[80:81], v[168:169], 0
  v_mfma_f32_16x16x32_bf16 v[180:183], v[80:83], v[172:175], 0
  v_mfma_f32_16x16x16_bf16 v[176:179], v[128:129], v[164:165], v[176:179]
  v_mfma_f32_16x16x16_bf16 v[180:183], v[128:129], v[166:167], v[180:183]
  v_mfma_f32_16x16x16_bf16 v[184:187], v[84:85], v[168:169], 0
  v_mfma_f32_16x16x32_bf16 v[188:191], v[84:87], v[172:175], 0
  v_mfma_f32_16x16x16_bf16 v[184:187], v[130:131], v[164:165], v[184:187]
  v_mfma_f32_16x16x16_bf16 v[188:191], v[130:131], v[166:167], v[188:191]
  v_mfma_f32_16x16x16_bf16 v[192:195], v[88:89], v[168:169], 0
  v_mfma_f32_16x16x32_bf16 v[196:199], v[88:91], v[172:175], 0
  v_mfma_f32_16x16x16_bf16 v[192:195], v[132:133], v[164:165], v[192:195]
  v_mfma_f32_16x16x16_bf16 v[196:199], v[132:133], v[166:167], v[196:199]
  v_mfma_f32_16x16x16_bf16 v[200:203], v[92:93], v[168:169], 0
  v_mfma_f32_16x16x32_bf16 v[204:207], v[92:95], v[172:175], 0
  v_mfma_f32_16x16x16_bf16 v[200:203], v[134:135], v[164:165], v[200:203]
  v_mfma_f32_16x16x16_bf16 v[204:207], v[134:135], v[166:167], v[204:207]
  v_mfma_f32_16x16x16_bf16 v[208:211], v[96:97], v[168:169], 0
  v_mfma_f32_16x16x32_bf16 v[212:215], v[96:99], v[172:175], 0
  v_mfma_f32_16x16x16_bf16 v[208:211], v[136:137], v[164:165], v[208:211]
  v_mfma_f32_16x16x16_bf16 v[212:215], v[136:137], v[166:167], v[212:215]
  v_mfma_f32_16x16x16_bf16 v[216:219], v[100:101], v[168:169], 0
  v_mfma_f32_16x16x32_bf16 v[220:223], v[100:103], v[172:175], 0
  v_mfma_f32_16x16x16_bf16 v[216:219], v[138:139], v[164:165], v[216:219]
  v_mfma_f32_16x16x16_bf16 v[220:223], v[138:139], v[166:167], v[220:223]
  v_mfma_f32_16x16x16_bf16 v[224:227], v[104:105], v[168:169], 0
  v_mfma_f32_16x16x32_bf16 v[228:231], v[104:107], v[172:175], 0
  v_mfma_f32_16x16x16_bf16 v[224:227], v[140:141], v[164:165], v[224:227]
  v_mfma_f32_16x16x16_bf16 v[228:231], v[140:141], v[166:167], v[228:231]
  v_mfma_f32_16x16x16_bf16 v[232:235], v[108:109], v[168:169], 0
  v_mfma_f32_16x16x32_bf16 v[236:239], v[108:111], v[172:175], 0
  v_mfma_f32_16x16x16_bf16 v[232:235], v[142:143], v[164:165], v[232:235]
  v_mfma_f32_16x16x16_bf16 v[236:239], v[142:143], v[166:167], v[236:239]
  v_mul_f32 v176, v176, v6
  v_mul_f32 v177, v177, v6
  v_mul_f32 v178, v178, v6
  v_mul_f32 v179, v179, v6
  v_cvt_pk_bf16_f32 v16, v176, v177
  v_cvt_pk_bf16_f32 v17, v178, v179
  v_mul_f32 v184, v184, v6
  v_mul_f32 v185, v185, v6
  v_mul_f32 v186, v186, v6
  v_mul_f32 v187, v187, v6
  v_cvt_pk_bf16_f32 v18, v184, v185
  v_cvt_pk_bf16_f32 v19, v186, v187
  s_add_u32 s26, s25, 0
  buffer_store_dwordx4 v[16:19], v9, s[8:11], s26 offen offset:0 sc1
  v_mul_f32 v180, v180, v7
  v_mul_f32 v181, v181, v7
  v_mul_f32 v182, v182, v7
  v_mul_f32 v183, v183, v7
  v_cvt_pk_bf16_f32 v20, v180, v181
  v_cvt_pk_bf16_f32 v21, v182, v183
  v_mul_f32 v188, v188, v7
  v_mul_f32 v189, v189, v7
  v_mul_f32 v190, v190, v7
  v_mul_f32 v191, v191, v7
  v_cvt_pk_bf16_f32 v22, v188, v189
  v_cvt_pk_bf16_f32 v23, v190, v191
  s_add_u32 s26, s25, 0
  buffer_store_dwordx4 v[20:23], v9, s[8:11], s26 offen offset:1024 sc1
  v_mul_f32 v192, v192, v6
  v_mul_f32 v193, v193, v6
  v_mul_f32 v194, v194, v6
  v_mul_f32 v195, v195, v6
  v_cvt_pk_bf16_f32 v24, v192, v193
  v_cvt_pk_bf16_f32 v25, v194, v195
  v_mul_f32 v200, v200, v6
  v_mul_f32 v201, v201, v6
  v_mul_f32 v202, v202, v6
  v_mul_f32 v203, v203, v6
  v_cvt_pk_bf16_f32 v26, v200, v201
  v_cvt_pk_bf16_f32 v27, v202, v203
  s_add_u32 s26, s25, 2048
  buffer_store_dwordx4 v[24:27], v9, s[8:11], s26 offen offset:0 sc1
  v_mul_f32 v196, v196, v7
  v_mul_f32 v197, v197, v7
  v_mul_f32 v198, v198, v7
  v_mul_f32 v199, v199, v7
  v_cvt_pk_bf16_f32 v28, v196, v197
  v_cvt_pk_bf16_f32 v29, v198, v199
  v_mul_f32 v204, v204, v7
  v_mul_f32 v205, v205, v7
  v_mul_f32 v206, v206, v7
  v_mul_f32 v207, v207, v7
  v_cvt_pk_bf16_f32 v30, v204, v205
  v_cvt_pk_bf16_f32 v31, v206, v207
  s_add_u32 s26, s25, 2048
  buffer_store_dwordx4 v[28:31], v9, s[8:11], s26 offen offset:1024 sc1
  v_mul_f32 v208, v208, v6
  v_mul_f32 v209, v209, v6
  v_mul_f32 v210, v210, v6
  v_mul_f32 v211, v211, v6
  v_cvt_pk_bf16_f32 v32, v208, v209
  v_cvt_pk_bf16_f32 v33, v210, v211
  v_mul_f32 v216, v216, v6
  v_mul_f32 v217, v217, v6
  v_mul_f32 v218, v218, v6
  v_mul_f32 v219, v219, v6
  v_cvt_pk_bf16_f32 v34, v216, v217
  v_cvt_pk_bf16_f32 v35, v218, v219
  s_add_u32 s26, s25, 4096
  buffer_store_dwordx4 v[32:35], v9, s[8:11], s26 offen offset:0 sc1
  v_mul_f32 v212, v212, v7
  v_mul_f32 v213, v213, v7
  v_mul_f32 v214, v214, v7
  v_mul_f32 v215, v215, v7
  v_cvt_pk_bf16_f32 v36, v212, v213
  v_cvt_pk_bf16_f32 v37, v214, v215
  v_mul_f32 v220, v220, v7
  v_mul_f32 v221, v221, v7
  v_mul_f32 v222, v222, v7
  v_mul_f32 v223, v223, v7
  v_cvt_pk_bf16_f32 v38, v220, v221
  v_cvt_pk_bf16_f32 v39, v222, v223
  s_add_u32 s26, s25, 4096
  buffer_store_dwordx4 v[36:39], v9, s[8:11], s26 offen offset:1024 sc1
  v_mul_f32 v224, v224, v6
  v_mul_f32 v225, v225, v6
  v_mul_f32 v226, v226, v6
  v_mul_f32 v227, v227, v6
  v_cvt_pk_bf16_f32 v40, v224, v225
  v_cvt_pk_bf16_f32 v41, v226, v227
  v_mul_f32 v232, v232, v6
  v_mul_f32 v233, v233, v6
  v_mul_f32 v234, v234, v6
  v_mul_f32 v235, v235, v6
  v_cvt_pk_bf16_f32 v42, v232, v233
  v_cvt_pk_bf16_f32 v43, v234, v235
  s_add_u32 s26, s25, 6144
  buffer_store_dwordx4 v[40:43], v9, s[8:11], s26 offen offset:0 sc1
  v_mul_f32 v228, v228, v7
  v_mul_f32 v229, v229, v7
  v_mul_f32 v230, v230, v7
  v_mul_f32 v231, v231, v7
  v_cvt_pk_bf16_f32 v44, v228, v229
  v_cvt_pk_bf16_f32 v45, v230, v231
  v_mul_f32 v236, v236, v7
  v_mul_f32 v237, v237, v7
  v_mul_f32 v238, v238, v7
  v_mul_f32 v239, v239, v7
  v_cvt_pk_bf16_f32 v46, v236, v237
  v_cvt_pk_bf16_f32 v47, v238, v239
  s_add_u32 s26, s25, 6144
  buffer_store_dwordx4 v[44:47], v9, s[8:11], s26 offen offset:1024 sc1
  s_waitcnt vmcnt(0)
  s_barrier
  s_lshl_b32 s20, s31, 3
  s_add_u32 s20, s20, s35
  s_lshl_b32 s20, s20, 2
  s_add_u32 s20, s20, 12288
  v_mov_b32 v2, 0
  v_mov_b32 v3, 1
  s_cmp_eq_u32 s16, 0
  s_cselect_b64 exec, 1, 0
  buffer_store_dword v3, v2, s[8:11], s20 offen sc1
  s_mov_b64 exec, -1
  s_add_u32 s31, s31, 4
  s_cmp_lt_u32 s31, 64
  s_cbranch_scc1 L_t3a_task
  s_waitcnt vmcnt(0)
L_t3a_done:
  s_waitcnt vmcnt(0)
  s_endpgm
L_go_t3b:
  s_barrier
  s_and_b32 s30, s17, 15
  s_lshr_b32 s31, s17, 5
  s_bfe_u32 s33, s17, 0x10004
  s_load_dwordx2 s[4:5], s[0:1], 40
  s_load_dwordx2 s[48:49], s[0:1], 88
  s_load_dwordx2 s[52:53], s[0:1], 104
  s_waitcnt lgkmcnt(0)
  s_mov_b32 s6, 4194304
  s_mov_b32 s7, 0x20000
  s_mov_b32 s50, 524288
  s_mov_b32 s51, 0x20000
  s_mov_b32 s54, 2097152
  s_mov_b32 s55, 0x20000
  v_lshrrev_b32 v2, 2, v0
  v_and_b32 v3, 3, v0
  v_bfe_u32 v4, v0, 3, 1
  v_lshlrev_b32 v4, 1, v4
  v_xor_b32 v3, v3, v4
  v_lshlrev_b32 v2, 10, v2
  v_lshl_add_u32 v8, v3, 4, v2
  s_lshl_b32 s22, s16, 15
  s_lshl_b32 s23, s30, 6
  v_lshrrev_b32 v2, 4, v0
  v_bfe_u32 v3, v0, 2, 2
  v_lshl_add_u32 v4, v2, 2, v3
  v_bfe_u32 v5, v3, 1, 1
  v_lshlrev_b32 v5, 1, v5
  v_and_b32 v6, 3, v0
  v_xor_b32 v5, v5, v6
  v_lshlrev_b32 v5, 4, v5
  v_lshl_add_u32 v10, v4, 6, v5
  v_add_u32 v10, s22, v10
  v_lshrrev_b32 v4, 1, v2
  v_lshlrev_b32 v4, 4, v4
  v_and_b32 v7, 1, v2
  v_lshl_add_u32 v4, v7, 2, v4
  v_add_u32 v4, v4, v3
  v_lshl_add_u32 v11, v4, 6, v5
  v_add_u32 v11, s22, v11
  s_lshl_b32 s24, s16, 20
  s_add_u32 s24, s24, s23
  s_add_u32 s24, s24, 0
  s_add_u32 s25, s24, 0
  s_add_u32 m0, s22, 0
  s_nop 0
  buffer_load_dwordx4 v8, s[4:7], s25 offen lds
  s_add_u32 s25, s24, 16384
  s_add_u32 m0, s22, 1024
  s_nop 0
  buffer_load_dwordx4 v8, s[4:7], s25 offen lds
  s_add_u32 s25, s24, 32768
  s_add_u32 m0, s22, 2048
  s_nop 0
  buffer_load_dwordx4 v8, s[4:7], s25 offen lds
  s_add_u32 s25, s24, 49152
  s_add_u32 m0, s22, 3072
  s_nop 0
  buffer_load_dwordx4 v8, s[4:7], s25 offen lds
  s_add_u32 s25, s24, 65536
  s_add_u32 m0, s22, 4096
  s_nop 0
  buffer_load_dwordx4 v8, s[4:7], s25 offen lds
  s_add_u32 s25, s24, 81920
  s_add_u32 m0, s22, 5120
  s_nop 0
  buffer_load_dwordx4 v8, s[4:7], s25 offen lds
  s_add_u32 s25, s24, 98304
  s_add_u32 m0, s22, 6144
  s_nop 0
  buffer_load_dwordx4 v8, s[4:7], s25 offen lds
  s_add_u32 s25, s24, 114688
  s_add_u32 m0, s22, 7168
  s_nop 0
  buffer_load_dwordx4 v8, s[4:7], s25 offen lds
  s_add_u32 s25, s24, 131072
  s_add_u32 m0, s22, 8192
  s_nop 0
  buffer_load_dwordx4 v8, s[4:7], s25 offen lds
  s_add_u32 s25, s24, 147456
  s_add_u32 m0, s22, 9216
  s_nop 0
  buffer_load_dwordx4 v8, s[4:7], s25 offen lds
  s_add_u32 s25, s24, 163840
  s_add_u32 m0, s22, 10240
  s_nop 0
  buffer_load_dwordx4 v8, s[4:7], s25 offen lds
  s_add_u32 s25, s24, 180224
  s_add_u32 m0, s22, 11264
  s_nop 0
  buffer_load_dwordx4 v8, s[4:7], s25 offen lds
  s_add_u32 s25, s24, 196608
  s_add_u32 m0, s22, 12288
  s_nop 0
  buffer_load_dwordx4 v8, s[4:7], s25 offen lds
  s_add_u32 s25, s24, 212992
  s_add_u32 m0, s22, 13312
  s_nop 0
  buffer_load_dwordx4 v8, s[4:7], s25 offen lds
  s_add_u32 s25, s24, 229376
  s_add_u32 m0, s22, 14336
  s_nop 0
  buffer_load_dwordx4 v8, s[4:7], s25 offen lds
  s_add_u32 s25, s24, 245760
  s_add_u32 m0, s22, 15360
  s_nop 0
  buffer_load_dwordx4 v8, s[4:7], s25 offen lds
  s_add_u32 s25, s24, 262144
  s_add_u32 m0, s22, 16384
  s_nop 0
  buffer_load_dwordx4 v8, s[4:7], s25 offen lds
  s_add_u32 s25, s24, 278528
  s_add_u32 m0, s22, 17408
  s_nop 0
  buffer_load_dwordx4 v8, s[4:7], s25 offen lds
  s_add_u32 s25, s24, 294912
  s_add_u32 m0, s22, 18432
  s_nop 0
  buffer_load_dwordx4 v8, s[4:7], s25 offen lds
  s_add_u32 s25, s24, 311296
  s_add_u32 m0, s22, 19456
  s_nop 0
  buffer_load_dwordx4 v8, s[4:7], s25 offen lds
  s_add_u32 s25, s24, 327680
  s_add_u32 m0, s22, 20480
  s_nop 0
  buffer_load_dwordx4 v8, s[4:7], s25 offen lds
  s_add_u32 s25, s24, 344064
  s_add_u32 m0, s22, 21504
  s_nop 0
  buffer_load_dwordx4 v8, s[4:7], s25 offen lds
  s_add_u32 s25, s24, 360448
  s_add_u32 m0, s22, 22528
  s_nop 0
  buffer_load_dwordx4 v8, s[4:7], s25 offen lds
  s_add_u32 s25, s24, 376832
  s_add_u32 m0, s22, 23552
  s_nop 0
  buffer_load_dwordx4 v8, s[4:7], s25 offen lds
  s_add_u32 s25, s24, 393216
  s_add_u32 m0, s22, 24576
  s_nop 0
  buffer_load_dwordx4 v8, s[4:7], s25 offen lds
  s_add_u32 s25, s24, 409600
  s_add_u32 m0, s22, 25600
  s_nop 0
  buffer_load_dwordx4 v8, s[4:7], s25 offen lds
  s_add_u32 s25, s24, 425984
  s_add_u32 m0, s22, 26624
  s_nop 0
  buffer_load_dwordx4 v8, s[4:7], s25 offen lds
  s_add_u32 s25, s24, 442368
  s_add_u32 m0, s22, 27648
  s_nop 0
  buffer_load_dwordx4 v8, s[4:7], s25 offen lds
  s_add_u32 s25, s24, 458752
  s_add_u32 m0, s22, 28672
  s_nop 0
  buffer_load_dwordx4 v8, s[4:7], s25 offen lds
  s_add_u32 s25, s24, 475136
  s_add_u32 m0, s22, 29696
  s_nop 0
  buffer_load_dwordx4 v8, s[4:7], s25 offen lds
  s_add_u32 s25, s24, 491520
  s_add_u32 m0, s22, 30720
  s_nop 0
  buffer_load_dwordx4 v8, s[4:7], s25 offen lds
  s_add_u32 s25, s24, 507904
  s_add_u32 m0, s22, 31744
  s_nop 0
  buffer_load_dwordx4 v8, s[4:7], s25 offen lds
  s_waitcnt vmcnt(0)
  ds_read_b64_tr_b16 a[0:1], v10 offset:0
  ds_read_b64_tr_b16 a[2:3], v10 offset:1024
  ds_read_b64_tr_b16 a[4:5], v10 offset:8
  ds_read_b64_tr_b16 a[6:7], v10 offset:1032
  ds_read_b64_tr_b16 a[8:9], v10 offset:2048
  ds_read_b64_tr_b16 a[10:11], v10 offset:3072
  ds_read_b64_tr_b16 a[12:13], v10 offset:2056
  ds_read_b64_tr_b16 a[14:15], v10 offset:3080
  ds_read_b64_tr_b16 a[16:17], v10 offset:4096
  ds_read_b64_tr_b16 a[18:19], v10 offset:5120
  ds_read_b64_tr_b16 a[20:21], v10 offset:4104
  ds_read_b64_tr_b16 a[22:23], v10 offset:5128
  s_waitcnt lgkmcnt(0)
  ds_read_b64_tr_b16 a[24:25], v10 offset:6144
  ds_read_b64_tr_b16 a[26:27], v10 offset:7168
  ds_read_b64_tr_b16 a[28:29], v10 offset:6152
  ds_read_b64_tr_b16 a[30:31], v10 offset:7176
  ds_read_b64_tr_b16 a[32:33], v10 offset:8192
  ds_read_b64_tr_b16 a[34:35], v10 offset:9216
  ds_read_b64_tr_b16 a[36:37], v10 offset:8200
  ds_read_b64_tr_b16 a[38:39], v10 offset:9224
  ds_read_b64_tr_b16 a[40:41], v10 offset:10240
  ds_read_b64_tr_b16 a[42:43], v10 offset:11264
  ds_read_b64_tr_b16 a[44:45], v10 offset:10248
  ds_read_b64_tr_b16 a[46:47], v10 offset:11272
  s_waitcnt lgkmcnt(0)
  ds_read_b64_tr_b16 a[48:49], v10 offset:12288
  ds_read_b64_tr_b16 a[50:51], v10 offset:13312
  ds_read_b64_tr_b16 a[52:53], v10 offset:12296
  ds_read_b64_tr_b16 a[54:55], v10 offset:13320
  ds_read_b64_tr_b16 a[56:57], v10 offset:14336
  ds_read_b64_tr_b16 a[58:59], v10 offset:15360
  ds_read_b64_tr_b16 a[60:61], v10 offset:14344
  ds_read_b64_tr_b16 a[62:63], v10 offset:15368
  ds_read_b64_tr_b16 a[64:65], v10 offset:16384
  ds_read_b64_tr_b16 a[66:67], v10 offset:17408
  ds_read_b64_tr_b16 a[68:69], v10 offset:16392
  ds_read_b64_tr_b16 a[70:71], v10 offset:17416
  s_waitcnt lgkmcnt(0)
  ds_read_b64_tr_b16 a[72:73], v10 offset:18432
  ds_read_b64_tr_b16 a[74:75], v10 offset:19456
  ds_read_b64_tr_b16 a[76:77], v10 offset:18440
  ds_read_b64_tr_b16 a[78:79], v10 offset:19464
  ds_read_b64_tr_b16 a[80:81], v10 offset:20480
  ds_read_b64_tr_b16 a[82:83], v10 offset:21504
  ds_read_b64_tr_b16 a[84:85], v10 offset:20488
  ds_read_b64_tr_b16 a[86:87], v10 offset:21512
  ds_read_b64_tr_b16 a[88:89], v10 offset:22528
  ds_read_b64_tr_b16 a[90:91], v10 offset:23552
  ds_read_b64_tr_b16 a[92:93], v10 offset:22536
  ds_read_b64_tr_b16 a[94:95], v10 offset:23560
  s_waitcnt lgkmcnt(0)
  ds_read_b64_tr_b16 a[96:97], v10 offset:24576
  ds_read_b64_tr_b16 a[98:99], v10 offset:25600
  ds_read_b64_tr_b16 a[100:101], v10 offset:24584
  ds_read_b64_tr_b16 a[102:103], v10 offset:25608
  ds_read_b64_tr_b16 a[104:105], v10 offset:26624
  ds_read_b64_tr_b16 a[106:107], v10 offset:27648
  ds_read_b64_tr_b16 a[108:109], v10 offset:26632
  ds_read_b64_tr_b16 a[110:111], v10 offset:27656
  ds_read_b64_tr_b16 a[112:113], v10 offset:28672
  ds_read_b64_tr_b16 a[114:115], v10 offset:29696
  ds_read_b64_tr_b16 a[116:117], v10 offset:28680
  ds_read_b64_tr_b16 a[118:119], v10 offset:29704
  s_waitcnt lgkmcnt(0)
  ds_read_b64_tr_b16 a[120:121], v10 offset:30720
  ds_read_b64_tr_b16 a[122:123], v10 offset:31744
  ds_read_b64_tr_b16 a[124:125], v10 offset:30728
  ds_read_b64_tr_b16 a[126:127], v10 offset:31752
  s_waitcnt lgkmcnt(0)
  s_lshl_b32 s24, s16, 20
  s_add_u32 s24, s24, s23
  s_add_u32 s24, s24, 524288
  s_add_u32 s25, s24, 0
  s_add_u32 m0, s22, 0
  s_nop 0
  buffer_load_dwordx4 v8, s[4:7], s25 offen lds
  s_add_u32 s25, s24, 16384
  s_add_u32 m0, s22, 1024
  s_nop 0
  buffer_load_dwordx4 v8, s[4:7], s25 offen lds
  s_add_u32 s25, s24, 32768
  s_add_u32 m0, s22, 2048
  s_nop 0
  buffer_load_dwordx4 v8, s[4:7], s25 offen lds
  s_add_u32 s25, s24, 49152
  s_add_u32 m0, s22, 3072
  s_nop 0
  buffer_load_dwordx4 v8, s[4:7], s25 offen lds
  s_add_u32 s25, s24, 65536
  s_add_u32 m0, s22, 4096
  s_nop 0
  buffer_load_dwordx4 v8, s[4:7], s25 offen lds
  s_add_u32 s25, s24, 81920
  s_add_u32 m0, s22, 5120
  s_nop 0
  buffer_load_dwordx4 v8, s[4:7], s25 offen lds
  s_add_u32 s25, s24, 98304
  s_add_u32 m0, s22, 6144
  s_nop 0
  buffer_load_dwordx4 v8, s[4:7], s25 offen lds
  s_add_u32 s25, s24, 114688
  s_add_u32 m0, s22, 7168
  s_nop 0
  buffer_load_dwordx4 v8, s[4:7], s25 offen lds
  s_add_u32 s25, s24, 131072
  s_add_u32 m0, s22, 8192
  s_nop 0
  buffer_load_dwordx4 v8, s[4:7], s25 offen lds
  s_add_u32 s25, s24, 147456
  s_add_u32 m0, s22, 9216
  s_nop 0
  buffer_load_dwordx4 v8, s[4:7], s25 offen lds
  s_add_u32 s25, s24, 163840
  s_add_u32 m0, s22, 10240
  s_nop 0
  buffer_load_dwordx4 v8, s[4:7], s25 offen lds
  s_add_u32 s25, s24, 180224
  s_add_u32 m0, s22, 11264
  s_nop 0
  buffer_load_dwordx4 v8, s[4:7], s25 offen lds
  s_add_u32 s25, s24, 196608
  s_add_u32 m0, s22, 12288
  s_nop 0
  buffer_load_dwordx4 v8, s[4:7], s25 offen lds
  s_add_u32 s25, s24, 212992
  s_add_u32 m0, s22, 13312
  s_nop 0
  buffer_load_dwordx4 v8, s[4:7], s25 offen lds
  s_add_u32 s25, s24, 229376
  s_add_u32 m0, s22, 14336
  s_nop 0
  buffer_load_dwordx4 v8, s[4:7], s25 offen lds
  s_add_u32 s25, s24, 245760
  s_add_u32 m0, s22, 15360
  s_nop 0
  buffer_load_dwordx4 v8, s[4:7], s25 offen lds
  s_add_u32 s25, s24, 262144
  s_add_u32 m0, s22, 16384
  s_nop 0
  buffer_load_dwordx4 v8, s[4:7], s25 offen lds
  s_add_u32 s25, s24, 278528
  s_add_u32 m0, s22, 17408
  s_nop 0
  buffer_load_dwordx4 v8, s[4:7], s25 offen lds
  s_add_u32 s25, s24, 294912
  s_add_u32 m0, s22, 18432
  s_nop 0
  buffer_load_dwordx4 v8, s[4:7], s25 offen lds
  s_add_u32 s25, s24, 311296
  s_add_u32 m0, s22, 19456
  s_nop 0
  buffer_load_dwordx4 v8, s[4:7], s25 offen lds
  s_add_u32 s25, s24, 327680
  s_add_u32 m0, s22, 20480
  s_nop 0
  buffer_load_dwordx4 v8, s[4:7], s25 offen lds
  s_add_u32 s25, s24, 344064
  s_add_u32 m0, s22, 21504
  s_nop 0
  buffer_load_dwordx4 v8, s[4:7], s25 offen lds
  s_add_u32 s25, s24, 360448
  s_add_u32 m0, s22, 22528
  s_nop 0
  buffer_load_dwordx4 v8, s[4:7], s25 offen lds
  s_add_u32 s25, s24, 376832
  s_add_u32 m0, s22, 23552
  s_nop 0
  buffer_load_dwordx4 v8, s[4:7], s25 offen lds
  s_add_u32 s25, s24, 393216
  s_add_u32 m0, s22, 24576
  s_nop 0
  buffer_load_dwordx4 v8, s[4:7], s25 offen lds
  s_add_u32 s25, s24, 409600
  s_add_u32 m0, s22, 25600
  s_nop 0
  buffer_load_dwordx4 v8, s[4:7], s25 offen lds
  s_add_u32 s25, s24, 425984
  s_add_u32 m0, s22, 26624
  s_nop 0
  buffer_load_dwordx4 v8, s[4:7], s25 offen lds
  s_add_u32 s25, s24, 442368
  s_add_u32 m0, s22, 27648
  s_nop 0
  buffer_load_dwordx4 v8, s[4:7], s25 offen lds
  s_add_u32 s25, s24, 458752
  s_add_u32 m0, s22, 28672
  s_nop 0
  buffer_load_dwordx4 v8, s[4:7], s25 offen lds
  s_add_u32 s25, s24, 475136
  s_add_u32 m0, s22, 29696
  s_nop 0
  buffer_load_dwordx4 v8, s[4:7], s25 offen lds
  s_add_u32 s25, s24, 491520
  s_add_u32 m0, s22, 30720
  s_nop 0
  buffer_load_dwordx4 v8, s[4:7], s25 offen lds
  s_add_u32 s25, s24, 507904
  s_add_u32 m0, s22, 31744
  s_nop 0
  buffer_load_dwordx4 v8, s[4:7], s25 offen lds
  s_waitcnt vmcnt(0)
  ds_read_b64_tr_b16 a[128:129], v10 offset:0
  ds_read_b64_tr_b16 a[130:131], v10 offset:1024
  ds_read_b64_tr_b16 a[132:133], v10 offset:8
  ds_read_b64_tr_b16 a[134:135], v10 offset:1032
  ds_read_b64_tr_b16 a[136:137], v10 offset:2048
  ds_read_b64_tr_b16 a[138:139], v10 offset:3072
  ds_read_b64_tr_b16 a[140:141], v10 offset:2056
  ds_read_b64_tr_b16 a[142:143], v10 offset:3080
  ds_read_b64_tr_b16 a[144:145], v10 offset:4096
  ds_read_b64_tr_b16 a[146:147], v10 offset:5120
  ds_read_b64_tr_b16 a[148:149], v10 offset:4104
  ds_read_b64_tr_b16 a[150:151], v10 offset:5128
  s_waitcnt lgkmcnt(0)
  ds_read_b64_tr_b16 a[152:153], v10 offset:6144
  ds_read_b64_tr_b16 a[154:155], v10 offset:7168
  ds_read_b64_tr_b16 a[156:157], v10 offset:6152
  ds_read_b64_tr_b16 a[158:159], v10 offset:7176
  ds_read_b64_tr_b16 a[160:161], v10 offset:8192
  ds_read_b64_tr_b16 a[162:163], v10 offset:9216
  ds_read_b64_tr_b16 a[164:165], v10 offset:8200
  ds_read_b64_tr_b16 a[166:167], v10 offset:9224
  ds_read_b64_tr_b16 a[168:169], v10 offset:10240
  ds_read_b64_tr_b16 a[170:171], v10 offset:11264
  ds_read_b64_tr_b16 a[172:173], v10 offset:10248
  ds_read_b64_tr_b16 a[174:175], v10 offset:11272
  s_waitcnt lgkmcnt(0)
  ds_read_b64_tr_b16 a[176:177], v10 offset:12288
  ds_read_b64_tr_b16 a[178:179], v10 offset:13312
  ds_read_b64_tr_b16 a[180:181], v10 offset:12296
  ds_read_b64_tr_b16 a[182:183], v10 offset:13320
  ds_read_b64_tr_b16 a[184:185], v10 offset:14336
  ds_read_b64_tr_b16 a[186:187], v10 offset:15360
  ds_read_b64_tr_b16 a[188:189], v10 offset:14344
  ds_read_b64_tr_b16 a[190:191], v10 offset:15368
  ds_read_b64_tr_b16 a[192:193], v10 offset:16384
  ds_read_b64_tr_b16 a[194:195], v10 offset:17408
  ds_read_b64_tr_b16 a[196:197], v10 offset:16392
  ds_read_b64_tr_b16 a[198:199], v10 offset:17416
  s_waitcnt lgkmcnt(0)
  ds_read_b64_tr_b16 a[200:201], v10 offset:18432
  ds_read_b64_tr_b16 a[202:203], v10 offset:19456
  ds_read_b64_tr_b16 a[204:205], v10 offset:18440
  ds_read_b64_tr_b16 a[206:207], v10 offset:19464
  ds_read_b64_tr_b16 a[208:209], v10 offset:20480
  ds_read_b64_tr_b16 a[210:211], v10 offset:21504
  ds_read_b64_tr_b16 a[212:213], v10 offset:20488
  ds_read_b64_tr_b16 a[214:215], v10 offset:21512
  ds_read_b64_tr_b16 a[216:217], v10 offset:22528
  ds_read_b64_tr_b16 a[218:219], v10 offset:23552
  ds_read_b64_tr_b16 a[220:221], v10 offset:22536
  ds_read_b64_tr_b16 a[222:223], v10 offset:23560
  s_waitcnt lgkmcnt(0)
  ds_read_b64_tr_b16 a[224:225], v10 offset:24576
  ds_read_b64_tr_b16 a[226:227], v10 offset:25600
  ds_read_b64_tr_b16 a[228:229], v10 offset:24584
  ds_read_b64_tr_b16 a[230:231], v10 offset:25608
  ds_read_b64_tr_b16 a[232:233], v10 offset:26624
  ds_read_b64_tr_b16 a[234:235], v10 offset:27648
  ds_read_b64_tr_b16 a[236:237], v10 offset:26632
  ds_read_b64_tr_b16 a[238:239], v10 offset:27656
  ds_read_b64_tr_b16 a[240:241], v10 offset:28672
  ds_read_b64_tr_b16 a[242:243], v10 offset:29696
  ds_read_b64_tr_b16 a[244:245], v10 offset:28680
  ds_read_b64_tr_b16 a[246:247], v10 offset:29704
  s_waitcnt lgkmcnt(0)
  ds_read_b64_tr_b16 a[248:249], v10 offset:30720
  ds_read_b64_tr_b16 a[250:251], v10 offset:31744
  ds_read_b64_tr_b16 a[252:253], v10 offset:30728
  ds_read_b64_tr_b16 a[254:255], v10 offset:31752
  s_waitcnt lgkmcnt(0)
  s_lshl_b32 s24, s16, 17
  s_add_u32 s24, s24, s23
  s_add_u32 s25, s24, 0
  s_add_u32 m0, s22, 0
  s_nop 0
  buffer_load_dwordx4 v8, s[48:51], s25 offen lds
  s_add_u32 s25, s24, 16384
  s_add_u32 m0, s22, 1024
  s_nop 0
  buffer_load_dwordx4 v8, s[48:51], s25 offen lds
  s_add_u32 s25, s24, 32768
  s_add_u32 m0, s22, 2048
  s_nop 0
  buffer_load_dwordx4 v8, s[48:51], s25 offen lds
  s_add_u32 s25, s24, 49152
  s_add_u32 m0, s22, 3072
  s_nop 0
  buffer_load_dwordx4 v8, s[48:51], s25 offen lds
  s_add_u32 s25, s24, 65536
  s_add_u32 m0, s22, 4096
  s_nop 0
  buffer_load_dwordx4 v8, s[48:51], s25 offen lds
  s_add_u32 s25, s24, 81920
  s_add_u32 m0, s22, 5120
  s_nop 0
  buffer_load_dwordx4 v8, s[48:51], s25 offen lds
  s_add_u32 s25, s24, 98304
  s_add_u32 m0, s22, 6144
  s_nop 0
  buffer_load_dwordx4 v8, s[48:51], s25 offen lds
  s_add_u32 s25, s24, 114688
  s_add_u32 m0, s22, 7168
  s_nop 0
  buffer_load_dwordx4 v8, s[48:51], s25 offen lds
  s_waitcnt vmcnt(0)
  ds_read_b64_tr_b16 v[128:129], v11 offset:0
  ds_read_b64_tr_b16 v[130:131], v11 offset:512
  ds_read_b64_tr_b16 v[132:133], v11 offset:8
  ds_read_b64_tr_b16 v[134:135], v11 offset:520
  s_waitcnt lgkmcnt(0)
  ds_read_b64_tr_b16 v[136:137], v11 offset:2048
  ds_read_b64_tr_b16 v[138:139], v11 offset:2560
  ds_read_b64_tr_b16 v[140:141], v11 offset:2056
  ds_read_b64_tr_b16 v[142:143], v11 offset:2568
  s_waitcnt lgkmcnt(0)
  ds_read_b64_tr_b16 v[144:145], v11 offset:4096
  ds_read_b64_tr_b16 v[146:147], v11 offset:4608
  ds_read_b64_tr_b16 v[148:149], v11 offset:4104
  ds_read_b64_tr_b16 v[150:151], v11 offset:4616
  s_waitcnt lgkmcnt(0)
  ds_read_b64_tr_b16 v[152:153], v11 offset:6144
  ds_read_b64_tr_b16 v[154:155], v11 offset:6656
  ds_read_b64_tr_b16 v[156:157], v11 offset:6152
  ds_read_b64_tr_b16 v[158:159], v11 offset:6664
  s_waitcnt lgkmcnt(0)
  s_barrier
  v_lshlrev_b32 v9, 4, v0
  s_lshl_b32 s20, s16, 12
  v_add_u32 v12, s20, v9
  v_and_b32 v2, 15, v0
  s_lshl_b32 s20, s33, 4
  v_add_u32 v2, s20, v2
  v_lshlrev_b32 v14, 2, v2
  v_lshlrev_b32 v2, 10, v2
  v_lshrrev_b32 v3, 4, v0
  v_lshl_add_u32 v15, v3, 4, v2
L_t3b_task:
L_t3b_wait:
  v_and_b32 v2, 7, v0
  v_lshlrev_b32 v2, 2, v2
  s_lshl_b32 s20, s31, 5
  s_add_u32 s20, s20, 12288
  v_and_b32 v3, 3, v0
  v_lshlrev_b32 v3, 2, v3
  s_lshl_b32 s21, s31, 4
  s_add_u32 s21, s21, 16384
  buffer_load_dword v2, v2, s[8:11], s20 offen sc1
  buffer_load_dword v3, v3, s[8:11], s21 offen sc1
  s_waitcnt vmcnt(0)
  v_min_u32 v2, v2, v3
  v_cmp_eq_u32 vcc, 0, v2
  s_cbranch_vccz L_t3b_go
  s_sleep 2
  s_add_u32 s19, s19, 1
  s_cmp_lt_u32 s19, 2097152
  s_cselect_b64 s[20:21], -1, 0
  s_and_b64 vcc, vcc, s[20:21]
  s_cbranch_vccnz L_t3b_wait
L_t3b_go:
  s_lshl_b32 s20, s31, 18
  s_lshl_b32 s21, s16, 16
  s_add_u32 s24, s20, s21
  s_lshl_b32 s22, s33, 10
  s_add_u32 s24, s24, s22
  s_add_u32 s24, s24, 83886080
  s_lshl_b32 s20, s31, 15
  s_lshl_b32 s21, s16, 13
  s_add_u32 s26, s20, s21
  s_add_u32 s26, s26, s22
  s_add_u32 s26, s26, 2097152
  s_lshl_b32 s20, s31, 7
  s_add_u32 s27, s20, 1900544
  buffer_load_dword v7, v14, s[8:11], s27 offen sc1
  s_add_u32 s25, s24, 0
  buffer_load_dwordx4 v[160:163], v9, s[8:11], s25 offen sc1
  s_add_u32 s25, s24, 2048
  buffer_load_dwordx4 v[164:167], v9, s[8:11], s25 offen sc1
  s_add_u32 s25, s24, 4096
  buffer_load_dwordx4 v[168:171], v9, s[8:11], s25 offen sc1
  s_add_u32 s25, s24, 6144
  buffer_load_dwordx4 v[172:175], v9, s[8:11], s25 offen sc1
  s_add_u32 s25, s24, 8192
  buffer_load_dwordx4 v[176:179], v9, s[8:11], s25 offen sc1
  s_add_u32 s25, s24, 10240
  buffer_load_dwordx4 v[180:183], v9, s[8:11], s25 offen sc1
  s_add_u32 s25, s24, 12288
  buffer_load_dwordx4 v[184:187], v9, s[8:11], s25 offen sc1
  s_add_u32 s25, s24, 14336
  buffer_load_dwordx4 v[188:191], v9, s[8:11], s25 offen sc1
  s_add_u32 s25, s24, 16384
  buffer_load_dwordx4 v[192:195], v9, s[8:11], s25 offen sc1
  s_add_u32 s25, s24, 18432
  buffer_load_dwordx4 v[196:199], v9, s[8:11], s25 offen sc1
  s_add_u32 s25, s24, 20480
  buffer_load_dwordx4 v[200:203], v9, s[8:11], s25 offen sc1
  s_add_u32 s25, s24, 22528
  buffer_load_dwordx4 v[204:207], v9, s[8:11], s25 offen sc1
  s_add_u32 s25, s24, 24576
  buffer_load_dwordx4 v[208:211], v9, s[8:11], s25 offen sc1
  s_add_u32 s25, s24, 26624
  buffer_load_dwordx4 v[212:215], v9, s[8:11], s25 offen sc1
  s_add_u32 s25, s24, 28672
  buffer_load_dwordx4 v[216:219], v9, s[8:11], s25 offen sc1
  s_add_u32 s25, s24, 30720
  buffer_load_dwordx4 v[220:223], v9, s[8:11], s25 offen sc1
  s_add_u32 s25, s24, 32768
  buffer_load_dwordx4 v[224:227], v9, s[8:11], s25 offen sc1
  s_add_u32 s25, s24, 34816
  buffer_load_dwordx4 v[228:231], v9, s[8:11], s25 offen sc1
  s_add_u32 s25, s24, 36864
  buffer_load_dwordx4 v[232:235], v9, s[8:11], s25 offen sc1
  s_add_u32 s25, s24, 38912
  buffer_load_dwordx4 v[236:239], v9, s[8:11], s25 offen sc1
  s_add_u32 s25, s24, 40960
  buffer_load_dwordx4 v[240:243], v9, s[8:11], s25 offen sc1
  s_add_u32 s25, s24, 43008
  buffer_load_dwordx4 v[244:247], v9, s[8:11], s25 offen sc1
  s_add_u32 s25, s24, 45056
  buffer_load_dwordx4 v[248:251], v9, s[8:11], s25 offen sc1
  s_add_u32 s25, s24, 47104
  buffer_load_dwordx4 v[252:255], v9, s[8:11], s25 offen sc1
  s_add_u32 s25, s24, 49152
  buffer_load_dwordx4 v[32:35], v9, s[8:11], s25 offen sc1
  s_add_u32 s25, s24, 51200
  buffer_load_dwordx4 v[36:39], v9, s[8:11], s25 offen sc1
  s_add_u32 s25, s24, 53248
  buffer_load_dwordx4 v[40:43], v9, s[8:11], s25 offen sc1
  s_add_u32 s25, s24, 55296
  buffer_load_dwordx4 v[44:47], v9, s[8:11], s25 offen sc1
  s_add_u32 s25, s24, 57344
  buffer_load_dwordx4 v[48:51], v9, s[8:11], s25 offen sc1
  s_add_u32 s25, s24, 59392
  buffer_load_dwordx4 v[52:55], v9, s[8:11], s25 offen sc1
  s_add_u32 s25, s24, 61440
  buffer_load_dwordx4 v[56:59], v9, s[8:11], s25 offen sc1
  s_add_u32 s25, s24, 63488
  buffer_load_dwordx4 v[60:63], v9, s[8:11], s25 offen sc1
  s_add_u32 s25, s26, 0
  buffer_load_dwordx4 v[64:67], v9, s[8:11], s25 offen sc1
  s_add_u32 s25, s26, 2048
  buffer_load_dwordx4 v[68:71], v9, s[8:11], s25 offen sc1
  s_add_u32 s25, s26, 4096
  buffer_load_dwordx4 v[72:75], v9, s[8:11], s25 offen sc1
  s_add_u32 s25, s26, 6144
  buffer_load_dwordx4 v[76:79], v9, s[8:11], s25 offen sc1
  s_waitcnt vmcnt(35)
  v_mfma_f32_16x16x32_bf16 v[16:19], a[0:3], v[160:163], 0
  v_mfma_f32_16x16x32_bf16 v[20:23], a[4:7], v[160:163], 0
  s_waitcnt vmcnt(34)
  v_mfma_f32_16x16x32_bf16 v[16:19], a[8:11], v[164:167], v[16:19]
  v_mfma_f32_16x16x32_bf16 v[20:23], a[12:15], v[164:167], v[20:23]
  s_waitcnt vmcnt(33)
  v_mfma_f32_16x16x32_bf16 v[16:19], a[16:19], v[168:171], v[16:19]
  v_mfma_f32_16x16x32_bf16 v[20:23], a[20:23], v[168:171], v[20:23]
  s_waitcnt vmcnt(32)
  v_mfma_f32_16x16x32_bf16 v[16:19], a[24:27], v[172:175], v[16:19]
  v_mfma_f32_16x16x32_bf16 v[20:23], a[28:31], v[172:175], v[20:23]
  s_waitcnt vmcnt(31)
  v_mfma_f32_16x16x32_bf16 v[16:19], a[32:35], v[176:179], v[16:19]
  v_mfma_f32_16x16x32_bf16 v[20:23], a[36:39], v[176:179], v[20:23]
  s_waitcnt vmcnt(30)
  v_mfma_f32_16x16x32_bf16 v[16:19], a[40:43], v[180:183], v[16:19]
  v_mfma_f32_16x16x32_bf16 v[20:23], a[44:47], v[180:183], v[20:23]
  s_waitcnt vmcnt(29)
  v_mfma_f32_16x16x32_bf16 v[16:19], a[48:51], v[184:187], v[16:19]
  v_mfma_f32_16x16x32_bf16 v[20:23], a[52:55], v[184:187], v[20:23]
  s_waitcnt vmcnt(28)
  v_mfma_f32_16x16x32_bf16 v[16:19], a[56:59], v[188:191], v[16:19]
  v_mfma_f32_16x16x32_bf16 v[20:23], a[60:63], v[188:191], v[20:23]
  s_waitcnt vmcnt(27)
  v_mfma_f32_16x16x32_bf16 v[16:19], a[64:67], v[192:195], v[16:19]
  v_mfma_f32_16x16x32_bf16 v[20:23], a[68:71], v[192:195], v[20:23]
  s_waitcnt vmcnt(26)
  v_mfma_f32_16x16x32_bf16 v[16:19], a[72:75], v[196:199], v[16:19]
  v_mfma_f32_16x16x32_bf16 v[20:23], a[76:79], v[196:199], v[20:23]
  s_waitcnt vmcnt(25)
  v_mfma_f32_16x16x32_bf16 v[16:19], a[80:83], v[200:203], v[16:19]
  v_mfma_f32_16x16x32_bf16 v[20:23], a[84:87], v[200:203], v[20:23]
  s_waitcnt vmcnt(24)
  v_mfma_f32_16x16x32_bf16 v[16:19], a[88:91], v[204:207], v[16:19]
  v_mfma_f32_16x16x32_bf16 v[20:23], a[92:95], v[204:207], v[20:23]
  s_waitcnt vmcnt(23)
  v_mfma_f32_16x16x32_bf16 v[16:19], a[96:99], v[208:211], v[16:19]
  v_mfma_f32_16x16x32_bf16 v[20:23], a[100:103], v[208:211], v[20:23]
  s_waitcnt vmcnt(22)
  v_mfma_f32_16x16x32_bf16 v[16:19], a[104:107], v[212:215], v[16:19]
  v_mfma_f32_16x16x32_bf16 v[20:23], a[108:111], v[212:215], v[20:23]
  s_waitcnt vmcnt(21)
  v_mfma_f32_16x16x32_bf16 v[16:19], a[112:115], v[216:219], v[16:19]
  v_mfma_f32_16x16x32_bf16 v[20:23], a[116:119], v[216:219], v[20:23]
  s_waitcnt vmcnt(20)
  v_mfma_f32_16x16x32_bf16 v[16:19], a[120:123], v[220:223], v[16:19]
  v_mfma_f32_16x16x32_bf16 v[20:23], a[124:127], v[220:223], v[20:23]
  s_waitcnt vmcnt(19)
  v_mfma_f32_16x16x32_bf16 v[16:19], a[128:131], v[224:227], v[16:19]
  v_mfma_f32_16x16x32_bf16 v[20:23], a[132:135], v[224:227], v[20:23]
  s_waitcnt vmcnt(18)
  v_mfma_f32_16x16x32_bf16 v[16:19], a[136:139], v[228:231], v[16:19]
  v_mfma_f32_16x16x32_bf16 v[20:23], a[140:143], v[228:231], v[20:23]
  s_waitcnt vmcnt(17)
  v_mfma_f32_16x16x32_bf16 v[16:19], a[144:147], v[232:235], v[16:19]
  v_mfma_f32_16x16x32_bf16 v[20:23], a[148:151], v[232:235], v[20:23]
  s_waitcnt vmcnt(16)
  v_mfma_f32_16x16x32_bf16 v[16:19], a[152:155], v[236:239], v[16:19]
  v_mfma_f32_16x16x32_bf16 v[20:23], a[156:159], v[236:239], v[20:23]
  s_waitcnt vmcnt(15)
  v_mfma_f32_16x16x32_bf16 v[16:19], a[160:163], v[240:243], v[16:19]
  v_mfma_f32_16x16x32_bf16 v[20:23], a[164:167], v[240:243], v[20:23]
  s_waitcnt vmcnt(14)
  v_mfma_f32_16x16x32_bf16 v[16:19], a[168:171], v[244:247], v[16:19]
  v_mfma_f32_16x16x32_bf16 v[20:23], a[172:175], v[244:247], v[20:23]
  s_waitcnt vmcnt(13)
  v_mfma_f32_16x16x32_bf16 v[16:19], a[176:179], v[248:251], v[16:19]
  v_mfma_f32_16x16x32_bf16 v[20:23], a[180:183], v[248:251], v[20:23]
  s_waitcnt vmcnt(12)
  v_mfma_f32_16x16x32_bf16 v[16:19], a[184:187], v[252:255], v[16:19]
  v_mfma_f32_16x16x32_bf16 v[20:23], a[188:191], v[252:255], v[20:23]
  s_waitcnt vmcnt(11)
  v_mfma_f32_16x16x32_bf16 v[16:19], a[192:195], v[32:35], v[16:19]
  v_mfma_f32_16x16x32_bf16 v[20:23], a[196:199], v[32:35], v[20:23]
  s_waitcnt vmcnt(10)
  v_mfma_f32_16x16x32_bf16 v[16:19], a[200:203], v[36:39], v[16:19]
  v_mfma_f32_16x16x32_bf16 v[20:23], a[204:207], v[36:39], v[20:23]
  s_waitcnt vmcnt(9)
  v_mfma_f32_16x16x32_bf16 v[16:19], a[208:211], v[40:43], v[16:19]
  v_mfma_f32_16x16x32_bf16 v[20:23], a[212:215], v[40:43], v[20:23]
  s_waitcnt vmcnt(8)
  v_mfma_f32_16x16x32_bf16 v[16:19], a[216:219], v[44:47], v[16:19]
  v_mfma_f32_16x16x32_bf16 v[20:23], a[220:223], v[44:47], v[20:23]
  s_waitcnt vmcnt(7)
  v_mfma_f32_16x16x32_bf16 v[16:19], a[224:227], v[48:51], v[16:19]
  v_mfma_f32_16x16x32_bf16 v[20:23], a[228:231], v[48:51], v[20:23]
  s_waitcnt vmcnt(6)
  v_mfma_f32_16x16x32_bf16 v[16:19], a[232:235], v[52:55], v[16:19]
  v_mfma_f32_16x16x32_bf16 v[20:23], a[236:239], v[52:55], v[20:23]
  s_waitcnt vmcnt(5)
  v_mfma_f32_16x16x32_bf16 v[16:19], a[240:243], v[56:59], v[16:19]
  v_mfma_f32_16x16x32_bf16 v[20:23], a[244:247], v[56:59], v[20:23]
  s_waitcnt vmcnt(4)
  v_mfma_f32_16x16x32_bf16 v[16:19], a[248:251], v[60:63], v[16:19]
  v_mfma_f32_16x16x32_bf16 v[20:23], a[252:255], v[60:63], v[20:23]
  s_waitcnt vmcnt(3)
  v_mfma_f32_16x16x32_bf16 v[24:27], v[128:131], v[64:67], 0
  v_mfma_f32_16x16x32_bf16 v[28:31], v[132:135], v[64:67], 0
  s_waitcnt vmcnt(2)
  v_mfma_f32_16x16x32_bf16 v[24:27], v[136:139], v[68:71], v[24:27]
  v_mfma_f32_16x16x32_bf16 v[28:31], v[140:143], v[68:71], v[28:31]
  s_waitcnt vmcnt(1)
  v_mfma_f32_16x16x32_bf16 v[24:27], v[144:147], v[72:75], v[24:27]
  v_mfma_f32_16x16x32_bf16 v[28:31], v[148:151], v[72:75], v[28:31]
  s_waitcnt vmcnt(0)
  v_mfma_f32_16x16x32_bf16 v[24:27], v[152:155], v[76:79], v[24:27]
  v_mfma_f32_16x16x32_bf16 v[28:31], v[156:159], v[76:79], v[28:31]
  ds_write_b128 v12, v[16:19] offset:0
  s_nop 2
  ds_write_b128 v12, v[24:27] offset:2048
  ds_write_b128 v12, v[20:23] offset:1024
  s_nop 4
  ds_write_b128 v12, v[28:31] offset:3072
  s_waitcnt lgkmcnt(0)
  s_barrier
  s_cmp_eq_u32 s16, 0
  s_cbranch_scc0 L_t3b_skip
  ds_read_b128 v[48:51], v9 offset:0
  ds_read_b128 v[52:55], v9 offset:4096
  ds_read_b128 v[56:59], v9 offset:8192
  ds_read_b128 v[60:63], v9 offset:12288
  ds_read_b128 v[64:67], v9 offset:1024
  ds_read_b128 v[68:71], v9 offset:5120
  ds_read_b128 v[72:75], v9 offset:9216
  ds_read_b128 v[76:79], v9 offset:13312
  s_waitcnt lgkmcnt(0)
  v_add_f32 v48, v48, v52
  v_add_f32 v56, v56, v60
  v_add_f32 v48, v48, v56
  v_add_f32 v49, v49, v53
  v_add_f32 v57, v57, v61
  v_add_f32 v49, v49, v57
  v_add_f32 v50, v50, v54
  v_add_f32 v58, v58, v62
  v_add_f32 v50, v50, v58
  v_add_f32 v51, v51, v55
  v_add_f32 v59, v59, v63
  v_add_f32 v51, v51, v59
  v_add_f32 v64, v64, v68
  v_add_f32 v72, v72, v76
  v_add_f32 v64, v64, v72
  v_add_f32 v65, v65, v69
  v_add_f32 v73, v73, v77
  v_add_f32 v65, v65, v73
  v_add_f32 v66, v66, v70
  v_add_f32 v74, v74, v78
  v_add_f32 v66, v66, v74
  v_add_f32 v67, v67, v71
  v_add_f32 v75, v75, v79
  v_add_f32 v67, v67, v75
  ds_read_b128 v[80:83], v9 offset:2048
  ds_read_b128 v[84:87], v9 offset:6144
  ds_read_b128 v[88:91], v9 offset:10240
  ds_read_b128 v[92:95], v9 offset:14336
  ds_read_b128 v[96:99], v9 offset:3072
  ds_read_b128 v[100:103], v9 offset:7168
  ds_read_b128 v[104:107], v9 offset:11264
  ds_read_b128 v[108:111], v9 offset:15360
  s_waitcnt lgkmcnt(0)
  v_add_f32 v80, v80, v84
  v_add_f32 v88, v88, v92
  v_add_f32 v80, v80, v88
  v_add_f32 v81, v81, v85
  v_add_f32 v89, v89, v93
  v_add_f32 v81, v81, v89
  v_add_f32 v82, v82, v86
  v_add_f32 v90, v90, v94
  v_add_f32 v82, v82, v90
  v_add_f32 v83, v83, v87
  v_add_f32 v91, v91, v95
  v_add_f32 v83, v83, v91
  v_add_f32 v96, v96, v100
  v_add_f32 v104, v104, v108
  v_add_f32 v96, v96, v104
  v_add_f32 v97, v97, v101
  v_add_f32 v105, v105, v109
  v_add_f32 v97, v97, v105
  v_add_f32 v98, v98, v102
  v_add_f32 v106, v106, v110
  v_add_f32 v98, v98, v106
  v_add_f32 v99, v99, v103
  v_add_f32 v107, v107, v111
  v_add_f32 v99, v99, v107
  v_sub_f32 v48, v48, v80
  v_fma_f32 v48, v48, v7, v80
  v_sub_f32 v49, v49, v81
  v_fma_f32 v49, v49, v7, v81
  v_sub_f32 v50, v50, v82
  v_fma_f32 v50, v50, v7, v82
  v_sub_f32 v51, v51, v83
  v_fma_f32 v51, v51, v7, v83
  v_cvt_pk_bf16_f32 v112, v48, v49
  v_cvt_pk_bf16_f32 v113, v50, v51
  v_sub_f32 v64, v64, v96
  v_fma_f32 v64, v64, v7, v96
  v_sub_f32 v65, v65, v97
  v_fma_f32 v65, v65, v7, v97
  v_sub_f32 v66, v66, v98
  v_fma_f32 v66, v66, v7, v98
  v_sub_f32 v67, v67, v99
  v_fma_f32 v67, v67, v7, v99
  v_cvt_pk_bf16_f32 v114, v64, v65
  v_cvt_pk_bf16_f32 v115, v66, v67
  s_lshl_b32 s20, s31, 15
  s_lshl_b32 s21, s30, 6
  s_add_u32 s20, s20, s21
  buffer_store_dwordx4 v[112:115], v15, s[52:55], s20 offen sc1
L_t3b_skip:
  s_barrier
  s_add_u32 s31, s31, 5
  s_cmp_lt_u32 s31, 64
  s_cbranch_scc1 L_t3b_task
  s_waitcnt vmcnt(0)
  s_waitcnt vmcnt(0)
  s_endpgm
L_chain:
  v_mov_b32 v59, v0
  s_cmp_eq_u32 s16, 0
  s_cbranch_scc0 L_ld_1
  s_load_dwordx2 s[4:5], s[0:1], 16
  s_load_dwordx2 s[68:69], s[0:1], 24
  s_load_dwordx2 s[72:73], s[0:1], 32
  s_load_dwordx2 s[76:77], s[0:1], 40
  s_lshl_b32 s22, s16, 15
  s_add_u32 s22, s22, 32768
  v_lshrrev_b32 v28, 4, v59
  v_and_b32 v29, 1, v28
  v_lshlrev_b32 v29, 1, v29
  v_and_b32 v30, 15, v59
  v_xor_b32 v30, v30, v29
  v_lshlrev_b32 v30, 4, v30
  v_lshl_add_u32 v28, v28, 10, v30
  v_xor_b32 v29, 64, v28
  v_xor_b32 v30, 128, v28
  v_xor_b32 v31, 192, v28
  s_lshl_b32 s26, s17, 17
  s_lshl_b32 s27, s16, 8
  s_add_u32 s26, s26, s27
  v_lshrrev_b32 v32, 2, v59
  v_and_b32 v33, 3, v59
  v_lshrrev_b32 v34, 5, v59
  v_lshlrev_b32 v34, 1, v34
  v_xor_b32 v33, v33, v34
  v_lshlrev_b32 v32, 13, v32
  v_lshl_add_u32 v32, v33, 4, v32
  s_lshl_b32 s23, s17, 8
  s_lshl_b32 s24, s16, 6
  s_add_u32 s23, s23, s24
  s_mov_b32 s24, 0
  s_waitcnt lgkmcnt(0)
  s_mov_b32 s6, 4194304
  s_mov_b32 s7, 0x20000
  s_mov_b32 s70, 4194304
  s_mov_b32 s71, 0x20000
  s_mov_b32 s74, 4194304
  s_mov_b32 s75, 0x20000
  s_mov_b32 s78, 4194304
  s_mov_b32 s79, 0x20000
  s_add_u32 s25, s26, 0
  s_add_u32 m0, s22, 0
  s_nop 0
  buffer_load_dwordx4 v28, s[76:79], s25 offen lds
  s_add_u32 s25, s26, 4096
  s_add_u32 m0, s22, 1024
  s_nop 0
  buffer_load_dwordx4 v29, s[76:79], s25 offen lds
  s_add_u32 s25, s26, 8192
  s_add_u32 m0, s22, 2048
  s_nop 0
  buffer_load_dwordx4 v28, s[76:79], s25 offen lds
  s_add_u32 s25, s26, 12288
  s_add_u32 m0, s22, 3072
  s_nop 0
  buffer_load_dwordx4 v29, s[76:79], s25 offen lds
  s_add_u32 s25, s26, 16384
  s_add_u32 m0, s22, 4096
  s_nop 0
  buffer_load_dwordx4 v30, s[76:79], s25 offen lds
  s_add_u32 s25, s26, 20480
  s_add_u32 m0, s22, 5120
  s_nop 0
  buffer_load_dwordx4 v31, s[76:79], s25 offen lds
  s_add_u32 s25, s26, 24576
  s_add_u32 m0, s22, 6144
  s_nop 0
  buffer_load_dwordx4 v30, s[76:79], s25 offen lds
  s_add_u32 s25, s26, 28672
  s_add_u32 m0, s22, 7168
  s_nop 0
  buffer_load_dwordx4 v31, s[76:79], s25 offen lds
  s_add_u32 s25, s26, 32768
  s_add_u32 m0, s22, 8192
  s_nop 0
  buffer_load_dwordx4 v28, s[76:79], s25 offen lds
  s_add_u32 s25, s26, 36864
  s_add_u32 m0, s22, 9216
  s_nop 0
  buffer_load_dwordx4 v29, s[76:79], s25 offen lds
  s_add_u32 s25, s26, 40960
  s_add_u32 m0, s22, 10240
  s_nop 0
  buffer_load_dwordx4 v28, s[76:79], s25 offen lds
  s_add_u32 s25, s26, 45056
  s_add_u32 m0, s22, 11264
  s_nop 0
  buffer_load_dwordx4 v29, s[76:79], s25 offen lds
  s_add_u32 s25, s26, 49152
  s_add_u32 m0, s22, 12288
  s_nop 0
  buffer_load_dwordx4 v30, s[76:79], s25 offen lds
  s_add_u32 s25, s26, 53248
  s_add_u32 m0, s22, 13312
  s_nop 0
  buffer_load_dwordx4 v31, s[76:79], s25 offen lds
  s_add_u32 s25, s26, 57344
  s_add_u32 m0, s22, 14336
  s_nop 0
  buffer_load_dwordx4 v30, s[76:79], s25 offen lds
  s_add_u32 s25, s26, 61440
  s_add_u32 m0, s22, 15360
  s_nop 0
  buffer_load_dwordx4 v31, s[76:79], s25 offen lds
  s_add_u32 s25, s26, 65536
  s_add_u32 m0, s22, 16384
  s_nop 0
  buffer_load_dwordx4 v28, s[76:79], s25 offen lds
  s_add_u32 s25, s26, 69632
  s_add_u32 m0, s22, 17408
  s_nop 0
  buffer_load_dwordx4 v29, s[76:79], s25 offen lds
  s_add_u32 s25, s26, 73728
  s_add_u32 m0, s22, 18432
  s_nop 0
  buffer_load_dwordx4 v28, s[76:79], s25 offen lds
  s_add_u32 s25, s26, 77824
  s_add_u32 m0, s22, 19456
  s_nop 0
  buffer_load_dwordx4 v29, s[76:79], s25 offen lds
  s_add_u32 s25, s26, 81920
  s_add_u32 m0, s22, 20480
  s_nop 0
  buffer_load_dwordx4 v30, s[76:79], s25 offen lds
  s_add_u32 s25, s26, 86016
  s_add_u32 m0, s22, 21504
  s_nop 0
  buffer_load_dwordx4 v31, s[76:79], s25 offen lds
  s_add_u32 s25, s26, 90112
  s_add_u32 m0, s22, 22528
  s_nop 0
  buffer_load_dwordx4 v30, s[76:79], s25 offen lds
  s_add_u32 s25, s26, 94208
  s_add_u32 m0, s22, 23552
  s_nop 0
  buffer_load_dwordx4 v31, s[76:79], s25 offen lds
  s_add_u32 s25, s26, 98304
  s_add_u32 m0, s22, 24576
  s_nop 0
  buffer_load_dwordx4 v28, s[76:79], s25 offen lds
  s_add_u32 s25, s26, 102400
  s_add_u32 m0, s22, 25600
  s_nop 0
  buffer_load_dwordx4 v29, s[76:79], s25 offen lds
  s_add_u32 s25, s26, 106496
  s_add_u32 m0, s22, 26624
  s_nop 0
  buffer_load_dwordx4 v28, s[76:79], s25 offen lds
  s_add_u32 s25, s26, 110592
  s_add_u32 m0, s22, 27648
  s_nop 0
  buffer_load_dwordx4 v29, s[76:79], s25 offen lds
  s_add_u32 s25, s26, 114688
  s_add_u32 m0, s22, 28672
  s_nop 0
  buffer_load_dwordx4 v30, s[76:79], s25 offen lds
  s_add_u32 s25, s26, 118784
  s_add_u32 m0, s22, 29696
  s_nop 0
  buffer_load_dwordx4 v31, s[76:79], s25 offen lds
  s_add_u32 s25, s26, 122880
  s_add_u32 m0, s22, 30720
  s_nop 0
  buffer_load_dwordx4 v30, s[76:79], s25 offen lds
  s_add_u32 s25, s26, 126976
  s_add_u32 m0, s22, 31744
  s_nop 0
  buffer_load_dwordx4 v31, s[76:79], s25 offen lds
  v_mov_b32 v20, -1
  v_mov_b32 v21, -1
  v_mov_b32 v22, -1
  v_mov_b32 v23, -1
  v_and_b32 v60, 15, v0
  v_lshrrev_b32 v61, 4, v0
  v_lshrrev_b32 v62, 1, v60
  v_mov_b32 v63, 0x3f80
  v_mov_b32 v64, 0x3f800000
  v_mov_b32 v67, 0x3f803f80
  v_mov_b32 v1, 0x4444
  v_mov_b32 v65, 0xeeee
  v_and_b32 v66, 1, v60
  v_cmp_eq_u32 vcc, 0, v66
  s_nop 1
  v_cndmask_b32 v1, v65, v1, vcc
  v_lshlrev_b32 v65, 1, v61
  v_mov_b32 v2, 0
  v_mov_b32 v3, 0
  v_cmp_eq_u32 vcc, v65, v62
  s_nop 1
  v_cndmask_b32 v2, v2, v67, vcc
  v_add_u32 v65, 1, v65
  v_cmp_eq_u32 vcc, v65, v62
  s_nop 1
  v_cndmask_b32 v3, v3, v67, vcc
  v_and_b32 v62, 7, v0
  v_mov_b32 v4, 0
  v_cmp_eq_u32 vcc, 0, v62
  s_nop 1
  v_cndmask_b32 v4, v4, v63, vcc
  v_cmp_eq_u32 vcc, 1, v62
  s_nop 1
  v_cndmask_b32 v4, v4, v64, vcc
  v_mov_b32 v5, 0
  v_cmp_eq_u32 vcc, 2, v62
  s_nop 1
  v_cndmask_b32 v5, v5, v63, vcc
  v_cmp_eq_u32 vcc, 3, v62
  s_nop 1
  v_cndmask_b32 v5, v5, v64, vcc
  v_mov_b32 v6, 0
  v_cmp_eq_u32 vcc, 4, v62
  s_nop 1
  v_cndmask_b32 v6, v6, v63, vcc
  v_cmp_eq_u32 vcc, 5, v62
  s_nop 1
  v_cndmask_b32 v6, v6, v64, vcc
  v_mov_b32 v7, 0
  v_cmp_eq_u32 vcc, 6, v62
  s_nop 1
  v_cndmask_b32 v7, v7, v63, vcc
  v_cmp_eq_u32 vcc, 7, v62
  s_nop 1
  v_cndmask_b32 v7, v7, v64, vcc
  v_bfe_u32 v65, v60, 2, 1
  v_lshlrev_b32 v66, 3, v65
  v_bfe_u32 v65, v60, 1, 1
  v_lshl_add_u32 v66, v65, 2, v66
  v_lshrrev_b32 v65, 3, v60
  v_lshl_add_u32 v66, v65, 1, v66
  v_and_b32 v65, 1, v60
  v_add_u32 v66, v66, v65
  v_lshlrev_b32 v66, 4, v66
  v_lshl_add_u32 v66, v61, 13, v66
  s_lshr_b32 s20, s17, 3
  s_and_b32 s20, s20, 1
  s_lshl_b32 s20, s20, 2
  s_xor_b32 s20, s20, s17
  s_lshl_b32 s20, s20, 8
  v_add_u32 v16, s20, v66
  s_lshr_b32 s20, s17, 2
  s_lshl_b32 s20, s20, 10
  s_and_b32 s21, s17, 3
  s_lshl_b32 s21, s21, 6
  s_add_u32 s20, s20, s21
  v_lshrrev_b32 v65, 1, v62
  v_lshlrev_b32 v66, 8, v65
  v_and_b32 v65, 1, v62
  v_lshl_add_u32 v66, v65, 5, v66
  v_lshrrev_b32 v65, 1, v61
  v_lshl_add_u32 v66, v65, 4, v66
  v_and_b32 v65, 1, v61
  v_lshl_add_u32 v66, v65, 3, v66
  v_add_u32 v17, s20, v66
  v_lshrrev_b32 v65, 1, v61
  v_lshlrev_b32 v66, 8, v65
  v_lshrrev_b32 v65, 1, v60
  v_lshl_add_u32 v66, v65, 5, v66
  v_and_b32 v65, 1, v61
  v_lshl_add_u32 v66, v65, 4, v66
  s_lshl_b32 s20, s16, 9
  v_add_u32 v15, s20, v66
  v_lshlrev_b32 v66, 3, v0
  s_add_u32 s21, s20, 12288
  v_add_u32 v14, s21, v66
  v_and_b32 v65, 1, v0
  v_lshl_add_u32 v19, v65, 10, v66
  v_lshlrev_b32 v0, 4, v0
  s_lshl_b32 s20, s16, 11
  v_add_u32 v8, s20, v0
  s_lshl_b32 s20, s16, 10
  v_add_u32 v13, s20, v0
  s_lshl_b32 s20, s16, 15
  s_add_u32 s20, s20, 32768
  v_add_u32 v12, s20, v0
  s_add_u32 s20, s16, 1
  s_and_b32 s20, s20, 3
  s_lshl_b32 s20, s20, 11
  v_add_u32 v9, s20, v0
  s_add_u32 s20, s16, 2
  s_and_b32 s20, s20, 3
  s_lshl_b32 s20, s20, 11
  v_add_u32 v10, s20, v0
  s_add_u32 s20, s16, 3
  s_and_b32 s20, s20, 3
  s_lshl_b32 s20, s20, 11
  v_add_u32 v11, s20, v0
  s_mov_b32 s38, 0x00ff00ff
  s_mov_b32 s39, 0x00ff00ff
  s_mov_b32 s50, 0x55555555
  s_mov_b32 s51, 0x55555555
  s_mov_b32 s48, 0x3e0293ee
  s_cmp_eq_u32 s16, 1
  s_cselect_b32 s66, 3, 2
  s_cselect_b32 s67, 4096, 0
  s_mov_b32 s58, 0x3e0293ee
  s_mov_b32 s59, 0x3e0293ee
  s_lshl_b32 s49, s17, 7
  s_add_u32 s49, s49, 8192
  s_cmp_eq_u32 s16, 0
  s_cselect_b64 s[52:53], s[38:39], 0
  s_cmp_eq_u32 s16, 3
  s_cselect_b64 s[54:55], 1, 0
  s_lshl_b32 s21, s17, 13
  s_lshl_b32 s22, s16, 11
  s_add_u32 s21, s21, s22
  s_add_u32 s25, s21, 1048576
  s_and_b32 s22, s16, 1
  s_lshl_b32 s22, s22, 10
  s_add_u32 s56, s25, s22
  s_xor_b32 s22, s22, 1024
  s_add_u32 s57, s25, s22
  s_mov_b32 s40, 1048576
  s_mov_b32 s41, 1081344
  s_mov_b32 s42, 1114112
  s_mov_b32 s43, 1146880
  s_mov_b32 s44, 1179648
  s_mov_b32 s45, 1212416
  s_mov_b32 s46, 1245184
  s_mov_b32 s47, 1277952
  buffer_store_dwordx4 v[20:23], v0, s[8:11], s25 offen
  buffer_store_dwordx4 v[20:23], v0, s[8:11], s25 offen offset:1024
  s_mov_b64 exec, s[38:39]
  s_mov_b32 s20, 1835008
  buffer_store_dwordx2 v[20:21], v17, s[8:11], s20 offen
  s_mov_b32 s20, 1843200
  buffer_store_dwordx2 v[20:21], v17, s[8:11], s20 offen
  s_mov_b32 s20, 1851392
  buffer_store_dwordx2 v[20:21], v17, s[8:11], s20 offen
  s_mov_b64 exec, -1
  s_lshl_b32 s22, s16, 15
  s_add_u32 s22, s22, 32768
  v_lshrrev_b32 v33, 4, v59
  v_bfe_u32 v34, v59, 2, 2
  v_and_b32 v35, 1, v33
  v_lshlrev_b32 v36, 4, v35
  v_lshrrev_b32 v37, 1, v33
  v_lshl_add_u32 v36, v37, 3, v36
  v_lshrrev_b32 v37, 1, v34
  v_lshl_add_u32 v36, v37, 2, v36
  v_and_b32 v37, 1, v34
  v_add_u32 v36, v36, v37
  v_lshlrev_b32 v36, 8, v36
  v_lshl_add_u32 v37, v35, 2, v34
  v_lshl_add_u32 v36, v37, 5, v36
  v_and_b32 v37, 3, v59
  v_lshl_add_u32 v36, v37, 3, v36
  v_add_u32 v36, s22, v36
  v_xor_b32 v40, 0, v36
  v_xor_b32 v41, 32, v36
  v_xor_b32 v42, 64, v36
  v_xor_b32 v43, 96, v36
  v_xor_b32 v44, 128, v36
  v_xor_b32 v45, 160, v36
  v_xor_b32 v46, 192, v36
  v_xor_b32 v47, 224, v36
  v_bfe_u32 v34, v59, 2, 2
  v_lshl_add_u32 v34, v33, 3, v34
  v_lshlrev_b32 v34, 6, v34
  v_and_b32 v35, 1, v59
  v_lshl_add_u32 v34, v35, 3, v34
  v_bfe_u32 v35, v59, 1, 1
  v_and_b32 v33, 1, v33
  v_lshlrev_b32 v33, 1, v33
  v_xor_b32 v35, v35, v33
  v_lshl_add_u32 v38, v35, 4, v34
  v_xor_b32 v35, 2, v35
  v_lshl_add_u32 v39, v35, 4, v34
  v_add_u32 v38, s22, v38
  v_add_u32 v39, s22, v39
  v_lshlrev_b32 v48, 4, v59
  v_add_u32 v48, s22, v48
  s_waitcnt vmcnt(29)
  ds_read_b64_tr_b16 v[192:193], v40 offset:0
  ds_read_b64_tr_b16 v[194:195], v40 offset:512
  ds_read_b64_tr_b16 v[208:209], v41 offset:0
  ds_read_b64_tr_b16 v[210:211], v41 offset:512
  ds_read_b64_tr_b16 v[224:225], v42 offset:0
  ds_read_b64_tr_b16 v[226:227], v42 offset:512
  ds_read_b64_tr_b16 v[240:241], v43 offset:0
  ds_read_b64_tr_b16 v[242:243], v43 offset:512
  s_waitcnt lgkmcnt(4)
  ds_read_b64_tr_b16 v[60:61], v44 offset:0
  ds_read_b64_tr_b16 v[62:63], v44 offset:512
  ds_read_b64_tr_b16 v[76:77], v45 offset:0
  ds_read_b64_tr_b16 v[78:79], v45 offset:512
  ds_read_b64_tr_b16 v[92:93], v46 offset:0
  ds_read_b64_tr_b16 v[94:95], v46 offset:512
  ds_read_b64_tr_b16 v[108:109], v47 offset:0
  ds_read_b64_tr_b16 v[110:111], v47 offset:512
  s_waitcnt lgkmcnt(0)
  s_add_u32 s25, s23, 0
  s_add_u32 m0, s22, 0
  s_nop 0
  buffer_load_dwordx4 v32, s[4:7], s25 offen lds
  s_add_u32 s25, s23, 131072
  s_add_u32 m0, s22, 1024
  s_nop 0
  buffer_load_dwordx4 v32, s[4:7], s25 offen lds
  s_add_u32 s25, s23, 262144
  s_add_u32 m0, s22, 2048
  s_nop 0
  buffer_load_dwordx4 v32, s[4:7], s25 offen lds
  s_add_u32 s25, s23, 393216
  s_add_u32 m0, s22, 3072
  s_nop 0
  buffer_load_dwordx4 v32, s[4:7], s25 offen lds
  s_add_u32 s25, s23, 524288
  s_add_u32 m0, s22, 4096
  s_nop 0
  buffer_load_dwordx4 v32, s[4:7], s25 offen lds
  s_add_u32 s25, s23, 655360
  s_add_u32 m0, s22, 5120
  s_nop 0
  buffer_load_dwordx4 v32, s[4:7], s25 offen lds
  s_add_u32 s25, s23, 786432
  s_add_u32 m0, s22, 6144
  s_nop 0
  buffer_load_dwordx4 v32, s[4:7], s25 offen lds
  s_add_u32 s25, s23, 917504
  s_add_u32 m0, s22, 7168
  s_nop 0
  buffer_load_dwordx4 v32, s[4:7], s25 offen lds
  s_waitcnt vmcnt(29)
  ds_read_b64_tr_b16 v[196:197], v40 offset:8192
  ds_read_b64_tr_b16 v[198:199], v40 offset:8704
  ds_read_b64_tr_b16 v[212:213], v41 offset:8192
  ds_read_b64_tr_b16 v[214:215], v41 offset:8704
  ds_read_b64_tr_b16 v[228:229], v42 offset:8192
  ds_read_b64_tr_b16 v[230:231], v42 offset:8704
  ds_read_b64_tr_b16 v[244:245], v43 offset:8192
  ds_read_b64_tr_b16 v[246:247], v43 offset:8704
  s_waitcnt lgkmcnt(4)
  ds_read_b64_tr_b16 v[64:65], v44 offset:8192
  ds_read_b64_tr_b16 v[66:67], v44 offset:8704
  ds_read_b64_tr_b16 v[80:81], v45 offset:8192
  ds_read_b64_tr_b16 v[82:83], v45 offset:8704
  ds_read_b64_tr_b16 v[96:97], v46 offset:8192
  ds_read_b64_tr_b16 v[98:99], v46 offset:8704
  ds_read_b64_tr_b16 v[112:113], v47 offset:8192
  ds_read_b64_tr_b16 v[114:115], v47 offset:8704
  s_waitcnt lgkmcnt(0)
  s_add_u32 s25, s23, 1048576
  s_add_u32 m0, s22, 8192
  s_nop 0
  buffer_load_dwordx4 v32, s[4:7], s25 offen lds
  s_add_u32 s25, s23, 1179648
  s_add_u32 m0, s22, 9216
  s_nop 0
  buffer_load_dwordx4 v32, s[4:7], s25 offen lds
  s_add_u32 s25, s23, 1310720
  s_add_u32 m0, s22, 10240
  s_nop 0
  buffer_load_dwordx4 v32, s[4:7], s25 offen lds
  s_add_u32 s25, s23, 1441792
  s_add_u32 m0, s22, 11264
  s_nop 0
  buffer_load_dwordx4 v32, s[4:7], s25 offen lds
  s_add_u32 s25, s23, 1572864
  s_add_u32 m0, s22, 12288
  s_nop 0
  buffer_load_dwordx4 v32, s[4:7], s25 offen lds
  s_add_u32 s25, s23, 1703936
  s_add_u32 m0, s22, 13312
  s_nop 0
  buffer_load_dwordx4 v32, s[4:7], s25 offen lds
  s_add_u32 s25, s23, 1835008
  s_add_u32 m0, s22, 14336
  s_nop 0
  buffer_load_dwordx4 v32, s[4:7], s25 offen lds
  s_add_u32 s25, s23, 1966080
  s_add_u32 m0, s22, 15360
  s_nop 0
  buffer_load_dwordx4 v32, s[4:7], s25 offen lds
  s_waitcnt vmcnt(29)
  ds_read_b64_tr_b16 v[200:201], v40 offset:16384
  ds_read_b64_tr_b16 v[202:203], v40 offset:16896
  ds_read_b64_tr_b16 v[216:217], v41 offset:16384
  ds_read_b64_tr_b16 v[218:219], v41 offset:16896
  ds_read_b64_tr_b16 v[232:233], v42 offset:16384
  ds_read_b64_tr_b16 v[234:235], v42 offset:16896
  ds_read_b64_tr_b16 v[248:249], v43 offset:16384
  ds_read_b64_tr_b16 v[250:251], v43 offset:16896
  s_waitcnt lgkmcnt(4)
  ds_read_b64_tr_b16 v[68:69], v44 offset:16384
  ds_read_b64_tr_b16 v[70:71], v44 offset:16896
  ds_read_b64_tr_b16 v[84:85], v45 offset:16384
  ds_read_b64_tr_b16 v[86:87], v45 offset:16896
  ds_read_b64_tr_b16 v[100:101], v46 offset:16384
  ds_read_b64_tr_b16 v[102:103], v46 offset:16896
  ds_read_b64_tr_b16 v[116:117], v47 offset:16384
  ds_read_b64_tr_b16 v[118:119], v47 offset:16896
  s_waitcnt lgkmcnt(0)
  s_add_u32 s25, s23, 2097152
  s_add_u32 m0, s22, 16384
  s_nop 0
  buffer_load_dwordx4 v32, s[4:7], s25 offen lds
  s_add_u32 s25, s23, 2228224
  s_add_u32 m0, s22, 17408
  s_nop 0
  buffer_load_dwordx4 v32, s[4:7], s25 offen lds
  s_add_u32 s25, s23, 2359296
  s_add_u32 m0, s22, 18432
  s_nop 0
  buffer_load_dwordx4 v32, s[4:7], s25 offen lds
  s_add_u32 s25, s23, 2490368
  s_add_u32 m0, s22, 19456
  s_nop 0
  buffer_load_dwordx4 v32, s[4:7], s25 offen lds
  s_add_u32 s25, s23, 2621440
  s_add_u32 m0, s22, 20480
  s_nop 0
  buffer_load_dwordx4 v32, s[4:7], s25 offen lds
  s_add_u32 s25, s23, 2752512
  s_add_u32 m0, s22, 21504
  s_nop 0
  buffer_load_dwordx4 v32, s[4:7], s25 offen lds
  s_add_u32 s25, s23, 2883584
  s_add_u32 m0, s22, 22528
  s_nop 0
  buffer_load_dwordx4 v32, s[4:7], s25 offen lds
  s_add_u32 s25, s23, 3014656
  s_add_u32 m0, s22, 23552
  s_nop 0
  buffer_load_dwordx4 v32, s[4:7], s25 offen lds
  s_waitcnt vmcnt(29)
  ds_read_b64_tr_b16 v[204:205], v40 offset:24576
  ds_read_b64_tr_b16 v[206:207], v40 offset:25088
  ds_read_b64_tr_b16 v[220:221], v41 offset:24576
  ds_read_b64_tr_b16 v[222:223], v41 offset:25088
  ds_read_b64_tr_b16 v[236:237], v42 offset:24576
  ds_read_b64_tr_b16 v[238:239], v42 offset:25088
  ds_read_b64_tr_b16 v[252:253], v43 offset:24576
  ds_read_b64_tr_b16 v[254:255], v43 offset:25088
  s_waitcnt lgkmcnt(4)
  ds_read_b64_tr_b16 v[72:73], v44 offset:24576
  ds_read_b64_tr_b16 v[74:75], v44 offset:25088
  ds_read_b64_tr_b16 v[88:89], v45 offset:24576
  ds_read_b64_tr_b16 v[90:91], v45 offset:25088
  ds_read_b64_tr_b16 v[104:105], v46 offset:24576
  ds_read_b64_tr_b16 v[106:107], v46 offset:25088
  ds_read_b64_tr_b16 v[120:121], v47 offset:24576
  ds_read_b64_tr_b16 v[122:123], v47 offset:25088
  s_waitcnt lgkmcnt(0)
  s_add_u32 s25, s23, 3145728
  s_add_u32 m0, s22, 24576
  s_nop 0
  buffer_load_dwordx4 v32, s[4:7], s25 offen lds
  s_add_u32 s25, s23, 3276800
  s_add_u32 m0, s22, 25600
  s_nop 0
  buffer_load_dwordx4 v32, s[4:7], s25 offen lds
  s_add_u32 s25, s23, 3407872
  s_add_u32 m0, s22, 26624
  s_nop 0
  buffer_load_dwordx4 v32, s[4:7], s25 offen lds
  s_add_u32 s25, s23, 3538944
  s_add_u32 m0, s22, 27648
  s_nop 0
  buffer_load_dwordx4 v32, s[4:7], s25 offen lds
  s_add_u32 s25, s23, 3670016
  s_add_u32 m0, s22, 28672
  s_nop 0
  buffer_load_dwordx4 v32, s[4:7], s25 offen lds
  s_add_u32 s25, s23, 3801088
  s_add_u32 m0, s22, 29696
  s_nop 0
  buffer_load_dwordx4 v32, s[4:7], s25 offen lds
  s_add_u32 s25, s23, 3932160
  s_add_u32 m0, s22, 30720
  s_nop 0
  buffer_load_dwordx4 v32, s[4:7], s25 offen lds
  s_add_u32 s25, s23, 4063232
  s_add_u32 m0, s22, 31744
  s_nop 0
  buffer_load_dwordx4 v32, s[4:7], s25 offen lds
  s_waitcnt vmcnt(30)
  s_barrier
  v_mov_b32 v56, 132
  v_mov_b32 v57, 1
  s_cmp_eq_u32 s16, 0
  s_cselect_b64 exec, 1, 0
  buffer_atomic_add v57, v56, s[12:15], 0 offen
  s_mov_b64 exec, -1
  ds_read_b64_tr_b16 a[0:1], v38 offset:0
  ds_read_b64_tr_b16 a[2:3], v38 offset:256
  ds_read_b64_tr_b16 a[64:65], v39 offset:0
  ds_read_b64_tr_b16 a[66:67], v39 offset:256
  s_waitcnt lgkmcnt(0)
  s_add_u32 s25, s23, 0
  s_add_u32 m0, s22, 0
  s_nop 0
  buffer_load_dwordx4 v32, s[68:71], s25 offen lds
  s_add_u32 s25, s23, 131072
  s_add_u32 m0, s22, 1024
  s_nop 0
  buffer_load_dwordx4 v32, s[68:71], s25 offen lds
  s_waitcnt vmcnt(30)
  ds_read_b64_tr_b16 a[4:5], v38 offset:2048
  ds_read_b64_tr_b16 a[6:7], v38 offset:2304
  ds_read_b64_tr_b16 a[68:69], v39 offset:2048
  ds_read_b64_tr_b16 a[70:71], v39 offset:2304
  s_waitcnt lgkmcnt(0)
  s_add_u32 s25, s23, 262144
  s_add_u32 m0, s22, 2048
  s_nop 0
  buffer_load_dwordx4 v32, s[68:71], s25 offen lds
  s_add_u32 s25, s23, 393216
  s_add_u32 m0, s22, 3072
  s_nop 0
  buffer_load_dwordx4 v32, s[68:71], s25 offen lds
  s_waitcnt vmcnt(30)
  ds_read_b64_tr_b16 a[8:9], v38 offset:4096
  ds_read_b64_tr_b16 a[10:11], v38 offset:4352
  ds_read_b64_tr_b16 a[72:73], v39 offset:4096
  ds_read_b64_tr_b16 a[74:75], v39 offset:4352
  s_waitcnt lgkmcnt(0)
  s_add_u32 s25, s23, 524288
  s_add_u32 m0, s22, 4096
  s_nop 0
  buffer_load_dwordx4 v32, s[68:71], s25 offen lds
  s_add_u32 s25, s23, 655360
  s_add_u32 m0, s22, 5120
  s_nop 0
  buffer_load_dwordx4 v32, s[68:71], s25 offen lds
  s_waitcnt vmcnt(30)
  ds_read_b64_tr_b16 a[12:13], v38 offset:6144
  ds_read_b64_tr_b16 a[14:15], v38 offset:6400
  ds_read_b64_tr_b16 a[76:77], v39 offset:6144
  ds_read_b64_tr_b16 a[78:79], v39 offset:6400
  s_waitcnt lgkmcnt(0)
  s_add_u32 s25, s23, 786432
  s_add_u32 m0, s22, 6144
  s_nop 0
  buffer_load_dwordx4 v32, s[68:71], s25 offen lds
  s_add_u32 s25, s23, 917504
  s_add_u32 m0, s22, 7168
  s_nop 0
  buffer_load_dwordx4 v32, s[68:71], s25 offen lds
  s_waitcnt vmcnt(30)
  ds_read_b64_tr_b16 a[16:17], v38 offset:8192
  ds_read_b64_tr_b16 a[18:19], v38 offset:8448
  ds_read_b64_tr_b16 a[80:81], v39 offset:8192
  ds_read_b64_tr_b16 a[82:83], v39 offset:8448
  s_waitcnt lgkmcnt(0)
  s_add_u32 s25, s23, 1048576
  s_add_u32 m0, s22, 8192
  s_nop 0
  buffer_load_dwordx4 v32, s[68:71], s25 offen lds
  s_add_u32 s25, s23, 1179648
  s_add_u32 m0, s22, 9216
  s_nop 0
  buffer_load_dwordx4 v32, s[68:71], s25 offen lds
  s_waitcnt vmcnt(30)
  ds_read_b64_tr_b16 a[20:21], v38 offset:10240
  ds_read_b64_tr_b16 a[22:23], v38 offset:10496
  ds_read_b64_tr_b16 a[84:85], v39 offset:10240
  ds_read_b64_tr_b16 a[86:87], v39 offset:10496
  s_waitcnt lgkmcnt(0)
  s_add_u32 s25, s23, 1310720
  s_add_u32 m0, s22, 10240
  s_nop 0
  buffer_load_dwordx4 v32, s[68:71], s25 offen lds
  s_add_u32 s25, s23, 1441792
  s_add_u32 m0, s22, 11264
  s_nop 0
  buffer_load_dwordx4 v32, s[68:71], s25 offen lds
  s_waitcnt vmcnt(30)
  ds_read_b64_tr_b16 a[24:25], v38 offset:12288
  ds_read_b64_tr_b16 a[26:27], v38 offset:12544
  ds_read_b64_tr_b16 a[88:89], v39 offset:12288
  ds_read_b64_tr_b16 a[90:91], v39 offset:12544
  s_waitcnt lgkmcnt(0)
  s_add_u32 s25, s23, 1572864
  s_add_u32 m0, s22, 12288
  s_nop 0
  buffer_load_dwordx4 v32, s[68:71], s25 offen lds
  s_add_u32 s25, s23, 1703936
  s_add_u32 m0, s22, 13312
  s_nop 0
  buffer_load_dwordx4 v32, s[68:71], s25 offen lds
  s_waitcnt vmcnt(30)
  ds_read_b64_tr_b16 a[28:29], v38 offset:14336
  ds_read_b64_tr_b16 a[30:31], v38 offset:14592
  ds_read_b64_tr_b16 a[92:93], v39 offset:14336
  ds_read_b64_tr_b16 a[94:95], v39 offset:14592
  s_waitcnt lgkmcnt(0)
  s_add_u32 s25, s23, 1835008
  s_add_u32 m0, s22, 14336
  s_nop 0
  buffer_load_dwordx4 v32, s[68:71], s25 offen lds
  s_add_u32 s25, s23, 1966080
  s_add_u32 m0, s22, 15360
  s_nop 0
  buffer_load_dwordx4 v32, s[68:71], s25 offen lds
  s_waitcnt vmcnt(30)
  ds_read_b64_tr_b16 a[32:33], v38 offset:16384
  ds_read_b64_tr_b16 a[34:35], v38 offset:16640
  ds_read_b64_tr_b16 a[96:97], v39 offset:16384
  ds_read_b64_tr_b16 a[98:99], v39 offset:16640
  s_waitcnt lgkmcnt(0)
  s_add_u32 s25, s23, 2097152
  s_add_u32 m0, s22, 16384
  s_nop 0
  buffer_load_dwordx4 v32, s[68:71], s25 offen lds
  s_add_u32 s25, s23, 2228224
  s_add_u32 m0, s22, 17408
  s_nop 0
  buffer_load_dwordx4 v32, s[68:71], s25 offen lds
  s_waitcnt vmcnt(30)
  ds_read_b64_tr_b16 a[36:37], v38 offset:18432
  ds_read_b64_tr_b16 a[38:39], v38 offset:18688
  ds_read_b64_tr_b16 a[100:101], v39 offset:18432
  ds_read_b64_tr_b16 a[102:103], v39 offset:18688
  s_waitcnt lgkmcnt(0)
  s_add_u32 s25, s23, 2359296
  s_add_u32 m0, s22, 18432
  s_nop 0
  buffer_load_dwordx4 v32, s[68:71], s25 offen lds
  s_add_u32 s25, s23, 2490368
  s_add_u32 m0, s22, 19456
  s_nop 0
  buffer_load_dwordx4 v32, s[68:71], s25 offen lds
  s_waitcnt vmcnt(30)
  ds_read_b64_tr_b16 a[40:41], v38 offset:20480
  ds_read_b64_tr_b16 a[42:43], v38 offset:20736
  ds_read_b64_tr_b16 a[104:105], v39 offset:20480
  ds_read_b64_tr_b16 a[106:107], v39 offset:20736
  s_waitcnt lgkmcnt(0)
  s_add_u32 s25, s23, 2621440
  s_add_u32 m0, s22, 20480
  s_nop 0
  buffer_load_dwordx4 v32, s[68:71], s25 offen lds
  s_add_u32 s25, s23, 2752512
  s_add_u32 m0, s22, 21504
  s_nop 0
  buffer_load_dwordx4 v32, s[68:71], s25 offen lds
  s_waitcnt vmcnt(30)
  ds_read_b64_tr_b16 a[44:45], v38 offset:22528
  ds_read_b64_tr_b16 a[46:47], v38 offset:22784
  ds_read_b64_tr_b16 a[108:109], v39 offset:22528
  ds_read_b64_tr_b16 a[110:111], v39 offset:22784
  s_waitcnt lgkmcnt(0)
  s_add_u32 s25, s23, 2883584
  s_add_u32 m0, s22, 22528
  s_nop 0
  buffer_load_dwordx4 v32, s[68:71], s25 offen lds
  s_add_u32 s25, s23, 3014656
  s_add_u32 m0, s22, 23552
  s_nop 0
  buffer_load_dwordx4 v32, s[68:71], s25 offen lds
  s_waitcnt vmcnt(30)
  ds_read_b64_tr_b16 a[48:49], v38 offset:24576
  ds_read_b64_tr_b16 a[50:51], v38 offset:24832
  ds_read_b64_tr_b16 a[112:113], v39 offset:24576
  ds_read_b64_tr_b16 a[114:115], v39 offset:24832
  s_waitcnt lgkmcnt(0)
  s_add_u32 s25, s23, 3145728
  s_add_u32 m0, s22, 24576
  s_nop 0
  buffer_load_dwordx4 v32, s[68:71], s25 offen lds
  s_add_u32 s25, s23, 3276800
  s_add_u32 m0, s22, 25600
  s_nop 0
  buffer_load_dwordx4 v32, s[68:71], s25 offen lds
  s_waitcnt vmcnt(30)
  ds_read_b64_tr_b16 a[52:53], v38 offset:26624
  ds_read_b64_tr_b16 a[54:55], v38 offset:26880
  ds_read_b64_tr_b16 a[116:117], v39 offset:26624
  ds_read_b64_tr_b16 a[118:119], v39 offset:26880
  s_waitcnt lgkmcnt(0)
  s_add_u32 s25, s23, 3407872
  s_add_u32 m0, s22, 26624
  s_nop 0
  buffer_load_dwordx4 v32, s[68:71], s25 offen lds
  s_add_u32 s25, s23, 3538944
  s_add_u32 m0, s22, 27648
  s_nop 0
  buffer_load_dwordx4 v32, s[68:71], s25 offen lds
  s_waitcnt vmcnt(30)
  ds_read_b64_tr_b16 a[56:57], v38 offset:28672
  ds_read_b64_tr_b16 a[58:59], v38 offset:28928
  ds_read_b64_tr_b16 a[120:121], v39 offset:28672
  ds_read_b64_tr_b16 a[122:123], v39 offset:28928
  s_waitcnt lgkmcnt(0)
  s_add_u32 s25, s23, 3670016
  s_add_u32 m0, s22, 28672
  s_nop 0
  buffer_load_dwordx4 v32, s[68:71], s25 offen lds
  s_add_u32 s25, s23, 3801088
  s_add_u32 m0, s22, 29696
  s_nop 0
  buffer_load_dwordx4 v32, s[68:71], s25 offen lds
  s_waitcnt vmcnt(30)
  ds_read_b64_tr_b16 a[60:61], v38 offset:30720
  ds_read_b64_tr_b16 a[62:63], v38 offset:30976
  ds_read_b64_tr_b16 a[124:125], v39 offset:30720
  ds_read_b64_tr_b16 a[126:127], v39 offset:30976
  s_waitcnt lgkmcnt(0)
  s_add_u32 s25, s23, 3932160
  s_add_u32 m0, s22, 30720
  s_nop 0
  buffer_load_dwordx4 v32, s[68:71], s25 offen lds
  s_add_u32 s25, s23, 4063232
  s_add_u32 m0, s22, 31744
  s_nop 0
  buffer_load_dwordx4 v32, s[68:71], s25 offen lds
  v_mov_b32 v51, 64
  buffer_load_dword v51, v51, s[12:15], 0 offen sc1
  s_waitcnt vmcnt(31)
  ds_read_b64_tr_b16 a[128:129], v38 offset:0
  ds_read_b64_tr_b16 a[130:131], v38 offset:256
  ds_read_b64_tr_b16 a[192:193], v39 offset:0
  ds_read_b64_tr_b16 a[194:195], v39 offset:256
  s_waitcnt lgkmcnt(0)
  s_add_u32 s25, s23, 0
  s_add_u32 m0, s22, 0
  s_nop 0
  buffer_load_dwordx4 v32, s[72:75], s25 offen lds
  s_add_u32 s25, s23, 131072
  s_add_u32 m0, s22, 1024
  s_nop 0
  buffer_load_dwordx4 v32, s[72:75], s25 offen lds
  s_waitcnt vmcnt(31)
  ds_read_b64_tr_b16 a[132:133], v38 offset:2048
  ds_read_b64_tr_b16 a[134:135], v38 offset:2304
  ds_read_b64_tr_b16 a[196:197], v39 offset:2048
  ds_read_b64_tr_b16 a[198:199], v39 offset:2304
  s_waitcnt lgkmcnt(0)
  s_add_u32 s25, s23, 262144
  s_add_u32 m0, s22, 2048
  s_nop 0
  buffer_load_dwordx4 v32, s[72:75], s25 offen lds
  s_add_u32 s25, s23, 393216
  s_add_u32 m0, s22, 3072
  s_nop 0
  buffer_load_dwordx4 v32, s[72:75], s25 offen lds
  s_waitcnt vmcnt(31)
  ds_read_b64_tr_b16 a[136:137], v38 offset:4096
  ds_read_b64_tr_b16 a[138:139], v38 offset:4352
  ds_read_b64_tr_b16 a[200:201], v39 offset:4096
  ds_read_b64_tr_b16 a[202:203], v39 offset:4352
  s_waitcnt lgkmcnt(0)
  s_add_u32 s25, s23, 524288
  s_add_u32 m0, s22, 4096
  s_nop 0
  buffer_load_dwordx4 v32, s[72:75], s25 offen lds
  s_add_u32 s25, s23, 655360
  s_add_u32 m0, s22, 5120
  s_nop 0
  buffer_load_dwordx4 v32, s[72:75], s25 offen lds
  s_waitcnt vmcnt(31)
  ds_read_b64_tr_b16 a[140:141], v38 offset:6144
  ds_read_b64_tr_b16 a[142:143], v38 offset:6400
  ds_read_b64_tr_b16 a[204:205], v39 offset:6144
  ds_read_b64_tr_b16 a[206:207], v39 offset:6400
  s_waitcnt lgkmcnt(0)
  s_add_u32 s25, s23, 786432
  s_add_u32 m0, s22, 6144
  s_nop 0
  buffer_load_dwordx4 v32, s[72:75], s25 offen lds
  s_add_u32 s25, s23, 917504
  s_add_u32 m0, s22, 7168
  s_nop 0
  buffer_load_dwordx4 v32, s[72:75], s25 offen lds
  s_waitcnt vmcnt(31)
  ds_read_b64_tr_b16 a[144:145], v38 offset:8192
  ds_read_b64_tr_b16 a[146:147], v38 offset:8448
  ds_read_b64_tr_b16 a[208:209], v39 offset:8192
  ds_read_b64_tr_b16 a[210:211], v39 offset:8448
  s_waitcnt lgkmcnt(0)
  s_add_u32 s25, s23, 1048576
  s_add_u32 m0, s22, 8192
  s_nop 0
  buffer_load_dwordx4 v32, s[72:75], s25 offen lds
  s_add_u32 s25, s23, 1179648
  s_add_u32 m0, s22, 9216
  s_nop 0
  buffer_load_dwordx4 v32, s[72:75], s25 offen lds
  s_waitcnt vmcnt(31)
  ds_read_b64_tr_b16 a[148:149], v38 offset:10240
  ds_read_b64_tr_b16 a[150:151], v38 offset:10496
  ds_read_b64_tr_b16 a[212:213], v39 offset:10240
  ds_read_b64_tr_b16 a[214:215], v39 offset:10496
  s_waitcnt lgkmcnt(0)
  s_add_u32 s25, s23, 1310720
  s_add_u32 m0, s22, 10240
  s_nop 0
  buffer_load_dwordx4 v32, s[72:75], s25 offen lds
  s_add_u32 s25, s23, 1441792
  s_add_u32 m0, s22, 11264
  s_nop 0
  buffer_load_dwordx4 v32, s[72:75], s25 offen lds
  s_waitcnt vmcnt(31)
  ds_read_b64_tr_b16 a[152:153], v38 offset:12288
  ds_read_b64_tr_b16 a[154:155], v38 offset:12544
  ds_read_b64_tr_b16 a[216:217], v39 offset:12288
  ds_read_b64_tr_b16 a[218:219], v39 offset:12544
  s_waitcnt lgkmcnt(0)
  s_add_u32 s25, s23, 1572864
  s_add_u32 m0, s22, 12288
  s_nop 0
  buffer_load_dwordx4 v32, s[72:75], s25 offen lds
  s_add_u32 s25, s23, 1703936
  s_add_u32 m0, s22, 13312
  s_nop 0
  buffer_load_dwordx4 v32, s[72:75], s25 offen lds
  s_waitcnt vmcnt(31)
  ds_read_b64_tr_b16 a[156:157], v38 offset:14336
  ds_read_b64_tr_b16 a[158:159], v38 offset:14592
  ds_read_b64_tr_b16 a[220:221], v39 offset:14336
  ds_read_b64_tr_b16 a[222:223], v39 offset:14592
  s_waitcnt lgkmcnt(0)
  s_add_u32 s25, s23, 1835008
  s_add_u32 m0, s22, 14336
  s_nop 0
  buffer_load_dwordx4 v32, s[72:75], s25 offen lds
  s_add_u32 s25, s23, 1966080
  s_add_u32 m0, s22, 15360
  s_nop 0
  buffer_load_dwordx4 v32, s[72:75], s25 offen lds
  s_waitcnt vmcnt(31)
  ds_read_b64_tr_b16 a[160:161], v38 offset:16384
  ds_read_b64_tr_b16 a[162:163], v38 offset:16640
  ds_read_b64_tr_b16 a[224:225], v39 offset:16384
  ds_read_b64_tr_b16 a[226:227], v39 offset:16640
  s_waitcnt lgkmcnt(0)
  s_add_u32 s25, s23, 2097152
  s_add_u32 m0, s22, 16384
  s_nop 0
  buffer_load_dwordx4 v32, s[72:75], s25 offen lds
  s_add_u32 s25, s23, 2228224
  s_add_u32 m0, s22, 17408
  s_nop 0
  buffer_load_dwordx4 v32, s[72:75], s25 offen lds
  s_waitcnt vmcnt(31)
  ds_read_b64_tr_b16 a[164:165], v38 offset:18432
  ds_read_b64_tr_b16 a[166:167], v38 offset:18688
  ds_read_b64_tr_b16 a[228:229], v39 offset:18432
  ds_read_b64_tr_b16 a[230:231], v39 offset:18688
  s_waitcnt lgkmcnt(0)
  s_add_u32 s25, s23, 2359296
  s_add_u32 m0, s22, 18432
  s_nop 0
  buffer_load_dwordx4 v32, s[72:75], s25 offen lds
  s_add_u32 s25, s23, 2490368
  s_add_u32 m0, s22, 19456
  s_nop 0
  buffer_load_dwordx4 v32, s[72:75], s25 offen lds
  s_waitcnt vmcnt(31)
  ds_read_b64_tr_b16 a[168:169], v38 offset:20480
  ds_read_b64_tr_b16 a[170:171], v38 offset:20736
  ds_read_b64_tr_b16 a[232:233], v39 offset:20480
  ds_read_b64_tr_b16 a[234:235], v39 offset:20736
  s_waitcnt lgkmcnt(0)
  s_add_u32 s25, s23, 2621440
  s_add_u32 m0, s22, 20480
  s_nop 0
  buffer_load_dwordx4 v32, s[72:75], s25 offen lds
  s_add_u32 s25, s23, 2752512
  s_add_u32 m0, s22, 21504
  s_nop 0
  buffer_load_dwordx4 v32, s[72:75], s25 offen lds
  s_waitcnt vmcnt(31)
  ds_read_b64_tr_b16 a[172:173], v38 offset:22528
  ds_read_b64_tr_b16 a[174:175], v38 offset:22784
  ds_read_b64_tr_b16 a[236:237], v39 offset:22528
  ds_read_b64_tr_b16 a[238:239], v39 offset:22784
  s_waitcnt lgkmcnt(0)
  s_add_u32 s25, s23, 2883584
  s_add_u32 m0, s22, 22528
  s_nop 0
  buffer_load_dwordx4 v32, s[72:75], s25 offen lds
  s_add_u32 s25, s23, 3014656
  s_add_u32 m0, s22, 23552
  s_nop 0
  buffer_load_dwordx4 v32, s[72:75], s25 offen lds
  s_waitcnt vmcnt(31)
  ds_read_b64_tr_b16 a[176:177], v38 offset:24576
  ds_read_b64_tr_b16 a[178:179], v38 offset:24832
  ds_read_b64_tr_b16 a[240:241], v39 offset:24576
  ds_read_b64_tr_b16 a[242:243], v39 offset:24832
  s_waitcnt lgkmcnt(0)
  s_add_u32 s25, s23, 3145728
  s_add_u32 m0, s22, 24576
  s_nop 0
  buffer_load_dwordx4 v32, s[72:75], s25 offen lds
  s_add_u32 s25, s23, 3276800
  s_add_u32 m0, s22, 25600
  s_nop 0
  buffer_load_dwordx4 v32, s[72:75], s25 offen lds
  s_waitcnt vmcnt(31)
  ds_read_b64_tr_b16 a[180:181], v38 offset:26624
  ds_read_b64_tr_b16 a[182:183], v38 offset:26880
  ds_read_b64_tr_b16 a[244:245], v39 offset:26624
  ds_read_b64_tr_b16 a[246:247], v39 offset:26880
  s_waitcnt lgkmcnt(0)
  s_add_u32 s25, s23, 3407872
  s_add_u32 m0, s22, 26624
  s_nop 0
  buffer_load_dwordx4 v32, s[72:75], s25 offen lds
  s_add_u32 s25, s23, 3538944
  s_add_u32 m0, s22, 27648
  s_nop 0
  buffer_load_dwordx4 v32, s[72:75], s25 offen lds
  s_waitcnt vmcnt(31)
  ds_read_b64_tr_b16 a[184:185], v38 offset:28672
  ds_read_b64_tr_b16 a[186:187], v38 offset:28928
  ds_read_b64_tr_b16 a[248:249], v39 offset:28672
  ds_read_b64_tr_b16 a[250:251], v39 offset:28928
  s_waitcnt lgkmcnt(0)
  s_add_u32 s25, s23, 3670016
  s_add_u32 m0, s22, 28672
  s_nop 0
  buffer_load_dwordx4 v32, s[72:75], s25 offen lds
  s_add_u32 s25, s23, 3801088
  s_add_u32 m0, s22, 29696
  s_nop 0
  buffer_load_dwordx4 v32, s[72:75], s25 offen lds
  s_waitcnt vmcnt(31)
  ds_read_b64_tr_b16 a[188:189], v38 offset:30720
  ds_read_b64_tr_b16 a[190:191], v38 offset:30976
  ds_read_b64_tr_b16 a[252:253], v39 offset:30720
  ds_read_b64_tr_b16 a[254:255], v39 offset:30976
  s_waitcnt lgkmcnt(0)
  s_add_u32 s25, s23, 3932160
  s_add_u32 m0, s22, 30720
  s_nop 0
  buffer_load_dwordx4 v32, s[72:75], s25 offen lds
  s_add_u32 s25, s23, 4063232
  s_add_u32 m0, s22, 31744
  s_nop 0
  buffer_load_dwordx4 v32, s[72:75], s25 offen lds
  s_waitcnt vmcnt(32)
  s_load_dwordx2 s[4:5], s[0:1], 8
  s_waitcnt lgkmcnt(0)
  s_mov_b32 s6, 8192
  s_mov_b32 s7, 0x20000
  v_bfe_u32 v58, v59, 1, 3
  v_lshlrev_b32 v58, 10, v58
  v_lshrrev_b32 v56, 4, v59
  v_lshl_add_u32 v58, v56, 5, v58
  v_and_b32 v56, 1, v59
  v_lshl_add_u32 v58, v56, 2, v58
  s_lshl_b32 s20, s16, 8
  buffer_load_dword v20, v58, s[4:7], s20 offen offset:0
  buffer_load_dword v21, v58, s[4:7], s20 offen offset:8
  buffer_load_dword v22, v58, s[4:7], s20 offen offset:16
  buffer_load_dword v23, v58, s[4:7], s20 offen offset:24
  buffer_load_dword v24, v58, s[4:7], s20 offen offset:128
  buffer_load_dword v25, v58, s[4:7], s20 offen offset:136
  buffer_load_dword v26, v58, s[4:7], s20 offen offset:144
  buffer_load_dword v27, v58, s[4:7], s20 offen offset:152
  v_mov_b32 v57, 132
  buffer_load_dword v57, v57, s[12:15], 0 offen sc1
  s_lshl_b32 s20, s17, 8
  v_lshlrev_b32 v50, 2, v59
  buffer_load_dword v50, v50, s[8:11], s20 offen offset:0 sc1
  s_waitcnt vmcnt(40)
  ds_read_b64_tr_b16 v[128:129], v38 offset:0
  ds_read_b64_tr_b16 v[130:131], v38 offset:256
  ds_read_b64_tr_b16 v[52:53], v39 offset:0
  ds_read_b64_tr_b16 v[54:55], v39 offset:256
  s_waitcnt vmcnt(38)
  ds_read_b64_tr_b16 v[132:133], v38 offset:2048
  ds_read_b64_tr_b16 v[134:135], v38 offset:2304
  ds_read_b64_tr_b16 v[124:125], v39 offset:2048
  ds_read_b64_tr_b16 v[126:127], v39 offset:2304
  s_waitcnt lgkmcnt(4)
  ds_write_b128 v48, v[52:55] offset:0
  ds_write_b128 v48, v[60:63] offset:1024
  s_waitcnt vmcnt(36)
  ds_read_b64_tr_b16 v[136:137], v38 offset:4096
  ds_read_b64_tr_b16 v[138:139], v38 offset:4352
  ds_read_b64_tr_b16 v[52:53], v39 offset:4096
  ds_read_b64_tr_b16 v[54:55], v39 offset:4352
  s_waitcnt lgkmcnt(6)
  ds_write_b128 v48, v[124:127] offset:2048
  ds_write_b128 v48, v[64:67] offset:3072
  s_waitcnt vmcnt(34)
  ds_read_b64_tr_b16 v[140:141], v38 offset:6144
  ds_read_b64_tr_b16 v[142:143], v38 offset:6400
  ds_read_b64_tr_b16 v[124:125], v39 offset:6144
  ds_read_b64_tr_b16 v[126:127], v39 offset:6400
  s_waitcnt lgkmcnt(6)
  ds_write_b128 v48, v[52:55] offset:4096
  ds_write_b128 v48, v[68:71] offset:5120
  s_waitcnt vmcnt(32)
  ds_read_b64_tr_b16 v[144:145], v38 offset:8192
  ds_read_b64_tr_b16 v[146:147], v38 offset:8448
  ds_read_b64_tr_b16 v[52:53], v39 offset:8192
  ds_read_b64_tr_b16 v[54:55], v39 offset:8448
  s_waitcnt lgkmcnt(6)
  ds_write_b128 v48, v[124:127] offset:6144
  ds_write_b128 v48, v[72:75] offset:7168
  s_waitcnt vmcnt(30)
  ds_read_b64_tr_b16 v[148:149], v38 offset:10240
  ds_read_b64_tr_b16 v[150:151], v38 offset:10496
  ds_read_b64_tr_b16 v[124:125], v39 offset:10240
  ds_read_b64_tr_b16 v[126:127], v39 offset:10496
  s_waitcnt lgkmcnt(6)
  ds_write_b128 v48, v[52:55] offset:8192
  ds_write_b128 v48, v[76:79] offset:9216
  s_waitcnt vmcnt(28)
  ds_read_b64_tr_b16 v[152:153], v38 offset:12288
  ds_read_b64_tr_b16 v[154:155], v38 offset:12544
  ds_read_b64_tr_b16 v[52:53], v39 offset:12288
  ds_read_b64_tr_b16 v[54:55], v39 offset:12544
  s_waitcnt lgkmcnt(6)
  ds_write_b128 v48, v[124:127] offset:10240
  ds_write_b128 v48, v[80:83] offset:11264
  s_waitcnt vmcnt(26)
  ds_read_b64_tr_b16 v[156:157], v38 offset:14336
  ds_read_b64_tr_b16 v[158:159], v38 offset:14592
  ds_read_b64_tr_b16 v[124:125], v39 offset:14336
  ds_read_b64_tr_b16 v[126:127], v39 offset:14592
  s_waitcnt lgkmcnt(6)
  ds_write_b128 v48, v[52:55] offset:12288
  ds_write_b128 v48, v[84:87] offset:13312
  s_waitcnt vmcnt(24)
  ds_read_b64_tr_b16 v[160:161], v38 offset:16384
  ds_read_b64_tr_b16 v[162:163], v38 offset:16640
  ds_read_b64_tr_b16 v[52:53], v39 offset:16384
  ds_read_b64_tr_b16 v[54:55], v39 offset:16640
  s_waitcnt lgkmcnt(6)
  ds_write_b128 v48, v[124:127] offset:14336
  ds_write_b128 v48, v[88:91] offset:15360
  s_waitcnt vmcnt(22)
  ds_read_b64_tr_b16 v[164:165], v38 offset:18432
  ds_read_b64_tr_b16 v[166:167], v38 offset:18688
  ds_read_b64_tr_b16 v[124:125], v39 offset:18432
  ds_read_b64_tr_b16 v[126:127], v39 offset:18688
  s_waitcnt lgkmcnt(6)
  ds_write_b128 v48, v[52:55] offset:16384
  ds_write_b128 v48, v[92:95] offset:17408
  s_waitcnt vmcnt(20)
  ds_read_b64_tr_b16 v[168:169], v38 offset:20480
  ds_read_b64_tr_b16 v[170:171], v38 offset:20736
  ds_read_b64_tr_b16 v[52:53], v39 offset:20480
  ds_read_b64_tr_b16 v[54:55], v39 offset:20736
  s_waitcnt lgkmcnt(6)
  ds_write_b128 v48, v[124:127] offset:18432
  ds_write_b128 v48, v[96:99] offset:19456
  s_waitcnt vmcnt(18)
  ds_read_b64_tr_b16 v[172:173], v38 offset:22528
  ds_read_b64_tr_b16 v[174:175], v38 offset:22784
  ds_read_b64_tr_b16 v[124:125], v39 offset:22528
  ds_read_b64_tr_b16 v[126:127], v39 offset:22784
  s_waitcnt lgkmcnt(6)
  ds_write_b128 v48, v[52:55] offset:20480
  ds_write_b128 v48, v[100:103] offset:21504
  s_waitcnt vmcnt(16)
  ds_read_b64_tr_b16 v[176:177], v38 offset:24576
  ds_read_b64_tr_b16 v[178:179], v38 offset:24832
  ds_read_b64_tr_b16 v[52:53], v39 offset:24576
  ds_read_b64_tr_b16 v[54:55], v39 offset:24832
  s_waitcnt lgkmcnt(6)
  ds_write_b128 v48, v[124:127] offset:22528
  ds_write_b128 v48, v[104:107] offset:23552
  s_waitcnt vmcnt(14)
  ds_read_b64_tr_b16 v[180:181], v38 offset:26624
  ds_read_b64_tr_b16 v[182:183], v38 offset:26880
  ds_read_b64_tr_b16 v[124:125], v39 offset:26624
  ds_read_b64_tr_b16 v[126:127], v39 offset:26880
  s_waitcnt lgkmcnt(6)
  ds_write_b128 v48, v[52:55] offset:24576
  ds_write_b128 v48, v[108:111] offset:25600
  s_waitcnt vmcnt(12)
  ds_read_b64_tr_b16 v[184:185], v38 offset:28672
  ds_read_b64_tr_b16 v[186:187], v38 offset:28928
  ds_read_b64_tr_b16 v[52:53], v39 offset:28672
  ds_read_b64_tr_b16 v[54:55], v39 offset:28928
  s_waitcnt lgkmcnt(6)
  ds_write_b128 v48, v[124:127] offset:26624
  ds_write_b128 v48, v[112:115] offset:27648
  s_waitcnt vmcnt(10)
  ds_read_b64_tr_b16 v[188:189], v38 offset:30720
  ds_read_b64_tr_b16 v[190:191], v38 offset:30976
  ds_read_b64_tr_b16 v[124:125], v39 offset:30720
  ds_read_b64_tr_b16 v[126:127], v39 offset:30976
  s_waitcnt lgkmcnt(6)
  ds_write_b128 v48, v[52:55] offset:28672
  ds_write_b128 v48, v[116:119] offset:29696
  s_waitcnt lgkmcnt(2)
  ds_write_b128 v48, v[124:127] offset:30720
  ds_write_b128 v48, v[120:123] offset:31744
  s_waitcnt lgkmcnt(0)
  s_branch L_ld_done
L_ld_1:
  s_cmp_eq_u32 s16, 1
  s_cbranch_scc0 L_ld_2
  s_load_dwordx2 s[4:5], s[0:1], 16
  s_load_dwordx2 s[68:69], s[0:1], 24
  s_load_dwordx2 s[72:73], s[0:1], 32
  s_load_dwordx2 s[76:77], s[0:1], 40
  s_lshl_b32 s22, s16, 15
  s_add_u32 s22, s22, 32768
  v_lshrrev_b32 v28, 4, v59
  v_and_b32 v29, 1, v28
  v_lshlrev_b32 v29, 1, v29
  v_and_b32 v30, 15, v59
  v_xor_b32 v30, v30, v29
  v_lshlrev_b32 v30, 4, v30
  v_lshl_add_u32 v28, v28, 10, v30
  v_xor_b32 v29, 64, v28
  v_xor_b32 v30, 128, v28
  v_xor_b32 v31, 192, v28
  s_lshl_b32 s26, s17, 17
  s_lshl_b32 s27, s16, 8
  s_add_u32 s26, s26, s27
  v_lshrrev_b32 v32, 2, v59
  v_and_b32 v33, 3, v59
  v_lshrrev_b32 v34, 5, v59
  v_lshlrev_b32 v34, 1, v34
  v_xor_b32 v33, v33, v34
  v_lshlrev_b32 v32, 13, v32
  v_lshl_add_u32 v32, v33, 4, v32
  s_lshl_b32 s23, s17, 8
  s_lshl_b32 s24, s16, 6
  s_add_u32 s23, s23, s24
  s_mov_b32 s24, 0
  s_waitcnt lgkmcnt(0)
  s_mov_b32 s6, 4194304
  s_mov_b32 s7, 0x20000
  s_mov_b32 s70, 4194304
  s_mov_b32 s71, 0x20000
  s_mov_b32 s74, 4194304
  s_mov_b32 s75, 0x20000
  s_mov_b32 s78, 4194304
  s_mov_b32 s79, 0x20000
  s_add_u32 s25, s26, 0
  s_add_u32 m0, s22, 0
  s_nop 0
  buffer_load_dwordx4 v28, s[76:79], s25 offen lds
  s_add_u32 s25, s26, 4096
  s_add_u32 m0, s22, 1024
  s_nop 0
  buffer_load_dwordx4 v29, s[76:79], s25 offen lds
  s_add_u32 s25, s26, 8192
  s_add_u32 m0, s22, 2048
  s_nop 0
  buffer_load_dwordx4 v28, s[76:79], s25 offen lds
  s_add_u32 s25, s26, 12288
  s_add_u32 m0, s22, 3072
  s_nop 0
  buffer_load_dwordx4 v29, s[76:79], s25 offen lds
  s_add_u32 s25, s26, 16384
  s_add_u32 m0, s22, 4096
  s_nop 0
  buffer_load_dwordx4 v30, s[76:79], s25 offen lds
  s_add_u32 s25, s26, 20480
  s_add_u32 m0, s22, 5120
  s_nop 0
  buffer_load_dwordx4 v31, s[76:79], s25 offen lds
  s_add_u32 s25, s26, 24576
  s_add_u32 m0, s22, 6144
  s_nop 0
  buffer_load_dwordx4 v30, s[76:79], s25 offen lds
  s_add_u32 s25, s26, 28672
  s_add_u32 m0, s22, 7168
  s_nop 0
  buffer_load_dwordx4 v31, s[76:79], s25 offen lds
  s_add_u32 s25, s26, 32768
  s_add_u32 m0, s22, 8192
  s_nop 0
  buffer_load_dwordx4 v28, s[76:79], s25 offen lds
  s_add_u32 s25, s26, 36864
  s_add_u32 m0, s22, 9216
  s_nop 0
  buffer_load_dwordx4 v29, s[76:79], s25 offen lds
  s_add_u32 s25, s26, 40960
  s_add_u32 m0, s22, 10240
  s_nop 0
  buffer_load_dwordx4 v28, s[76:79], s25 offen lds
  s_add_u32 s25, s26, 45056
  s_add_u32 m0, s22, 11264
  s_nop 0
  buffer_load_dwordx4 v29, s[76:79], s25 offen lds
  s_add_u32 s25, s26, 49152
  s_add_u32 m0, s22, 12288
  s_nop 0
  buffer_load_dwordx4 v30, s[76:79], s25 offen lds
  s_add_u32 s25, s26, 53248
  s_add_u32 m0, s22, 13312
  s_nop 0
  buffer_load_dwordx4 v31, s[76:79], s25 offen lds
  s_add_u32 s25, s26, 57344
  s_add_u32 m0, s22, 14336
  s_nop 0
  buffer_load_dwordx4 v30, s[76:79], s25 offen lds
  s_add_u32 s25, s26, 61440
  s_add_u32 m0, s22, 15360
  s_nop 0
  buffer_load_dwordx4 v31, s[76:79], s25 offen lds
  s_add_u32 s25, s26, 65536
  s_add_u32 m0, s22, 16384
  s_nop 0
  buffer_load_dwordx4 v28, s[76:79], s25 offen lds
  s_add_u32 s25, s26, 69632
  s_add_u32 m0, s22, 17408
  s_nop 0
  buffer_load_dwordx4 v29, s[76:79], s25 offen lds
  s_add_u32 s25, s26, 73728
  s_add_u32 m0, s22, 18432
  s_nop 0
  buffer_load_dwordx4 v28, s[76:79], s25 offen lds
  s_add_u32 s25, s26, 77824
  s_add_u32 m0, s22, 19456
  s_nop 0
  buffer_load_dwordx4 v29, s[76:79], s25 offen lds
  s_add_u32 s25, s26, 81920
  s_add_u32 m0, s22, 20480
  s_nop 0
  buffer_load_dwordx4 v30, s[76:79], s25 offen lds
  s_add_u32 s25, s26, 86016
  s_add_u32 m0, s22, 21504
  s_nop 0
  buffer_load_dwordx4 v31, s[76:79], s25 offen lds
  s_add_u32 s25, s26, 90112
  s_add_u32 m0, s22, 22528
  s_nop 0
  buffer_load_dwordx4 v30, s[76:79], s25 offen lds
  s_add_u32 s25, s26, 94208
  s_add_u32 m0, s22, 23552
  s_nop 0
  buffer_load_dwordx4 v31, s[76:79], s25 offen lds
  s_add_u32 s25, s26, 98304
  s_add_u32 m0, s22, 24576
  s_nop 0
  buffer_load_dwordx4 v28, s[76:79], s25 offen lds
  s_add_u32 s25, s26, 102400
  s_add_u32 m0, s22, 25600
  s_nop 0
  buffer_load_dwordx4 v29, s[76:79], s25 offen lds
  s_add_u32 s25, s26, 106496
  s_add_u32 m0, s22, 26624
  s_nop 0
  buffer_load_dwordx4 v28, s[76:79], s25 offen lds
  s_add_u32 s25, s26, 110592
  s_add_u32 m0, s22, 27648
  s_nop 0
  buffer_load_dwordx4 v29, s[76:79], s25 offen lds
  s_add_u32 s25, s26, 114688
  s_add_u32 m0, s22, 28672
  s_nop 0
  buffer_load_dwordx4 v30, s[76:79], s25 offen lds
  s_add_u32 s25, s26, 118784
  s_add_u32 m0, s22, 29696
  s_nop 0
  buffer_load_dwordx4 v31, s[76:79], s25 offen lds
  s_add_u32 s25, s26, 122880
  s_add_u32 m0, s22, 30720
  s_nop 0
  buffer_load_dwordx4 v30, s[76:79], s25 offen lds
  s_add_u32 s25, s26, 126976
  s_add_u32 m0, s22, 31744
  s_nop 0
  buffer_load_dwordx4 v31, s[76:79], s25 offen lds
  v_mov_b32 v20, -1
  v_mov_b32 v21, -1
  v_mov_b32 v22, -1
  v_mov_b32 v23, -1
  v_and_b32 v60, 15, v0
  v_lshrrev_b32 v61, 4, v0
  v_lshrrev_b32 v62, 1, v60
  v_mov_b32 v63, 0x3f80
  v_mov_b32 v64, 0x3f800000
  v_mov_b32 v67, 0x3f803f80
  v_mov_b32 v1, 0x4444
  v_mov_b32 v65, 0xeeee
  v_and_b32 v66, 1, v60
  v_cmp_eq_u32 vcc, 0, v66
  s_nop 1
  v_cndmask_b32 v1, v65, v1, vcc
  v_lshlrev_b32 v65, 1, v61
  v_mov_b32 v2, 0
  v_mov_b32 v3, 0
  v_cmp_eq_u32 vcc, v65, v62
  s_nop 1
  v_cndmask_b32 v2, v2, v67, vcc
  v_add_u32 v65, 1, v65
  v_cmp_eq_u32 vcc, v65, v62
  s_nop 1
  v_cndmask_b32 v3, v3, v67, vcc
  v_and_b32 v62, 7, v0
  v_mov_b32 v4, 0
  v_cmp_eq_u32 vcc, 0, v62
  s_nop 1
  v_cndmask_b32 v4, v4, v63, vcc
  v_cmp_eq_u32 vcc, 1, v62
  s_nop 1
  v_cndmask_b32 v4, v4, v64, vcc
  v_mov_b32 v5, 0
  v_cmp_eq_u32 vcc, 2, v62
  s_nop 1
  v_cndmask_b32 v5, v5, v63, vcc
  v_cmp_eq_u32 vcc, 3, v62
  s_nop 1
  v_cndmask_b32 v5, v5, v64, vcc
  v_mov_b32 v6, 0
  v_cmp_eq_u32 vcc, 4, v62
  s_nop 1
  v_cndmask_b32 v6, v6, v63, vcc
  v_cmp_eq_u32 vcc, 5, v62
  s_nop 1
  v_cndmask_b32 v6, v6, v64, vcc
  v_mov_b32 v7, 0
  v_cmp_eq_u32 vcc, 6, v62
  s_nop 1
  v_cndmask_b32 v7, v7, v63, vcc
  v_cmp_eq_u32 vcc, 7, v62
  s_nop 1
  v_cndmask_b32 v7, v7, v64, vcc
  v_bfe_u32 v65, v60, 2, 1
  v_lshlrev_b32 v66, 3, v65
  v_bfe_u32 v65, v60, 1, 1
  v_lshl_add_u32 v66, v65, 2, v66
  v_lshrrev_b32 v65, 3, v60
  v_lshl_add_u32 v66, v65, 1, v66
  v_and_b32 v65, 1, v60
  v_add_u32 v66, v66, v65
  v_lshlrev_b32 v66, 4, v66
  v_lshl_add_u32 v66, v61, 13, v66
  s_lshr_b32 s20, s17, 3
  s_and_b32 s20, s20, 1
  s_lshl_b32 s20, s20, 2
  s_xor_b32 s20, s20, s17
  s_lshl_b32 s20, s20, 8
  v_add_u32 v16, s20, v66
  s_lshr_b32 s20, s17, 2
  s_lshl_b32 s20, s20, 10
  s_and_b32 s21, s17, 3
  s_lshl_b32 s21, s21, 6
  s_add_u32 s20, s20, s21
  v_lshrrev_b32 v65, 1, v62
  v_lshlrev_b32 v66, 8, v65
  v_and_b32 v65, 1, v62
  v_lshl_add_u32 v66, v65, 5, v66
  v_lshrrev_b32 v65, 1, v61
  v_lshl_add_u32 v66, v65, 4, v66
  v_and_b32 v65, 1, v61
  v_lshl_add_u32 v66, v65, 3, v66
  v_add_u32 v17, s20, v66
  v_lshrrev_b32 v65, 1, v61
  v_lshlrev_b32 v66, 8, v65
  v_lshrrev_b32 v65, 1, v60
  v_lshl_add_u32 v66, v65, 5, v66
  v_and_b32 v65, 1, v61
  v_lshl_add_u32 v66, v65, 4, v66
  s_lshl_b32 s20, s16, 9
  v_add_u32 v15, s20, v66
  v_lshlrev_b32 v66, 3, v0
  s_add_u32 s21, s20, 12288
  v_add_u32 v14, s21, v66
  v_and_b32 v65, 1, v0
  v_lshl_add_u32 v19, v65, 10, v66
  v_lshlrev_b32 v0, 4, v0
  s_lshl_b32 s20, s16, 11
  v_add_u32 v8, s20, v0
  s_lshl_b32 s20, s16, 10
  v_add_u32 v13, s20, v0
  s_lshl_b32 s20, s16, 15
  s_add_u32 s20, s20, 32768
  v_add_u32 v12, s20, v0
  s_add_u32 s20, s16, 1
  s_and_b32 s20, s20, 3
  s_lshl_b32 s20, s20, 11
  v_add_u32 v9, s20, v0
  s_add_u32 s20, s16, 2
  s_and_b32 s20, s20, 3
  s_lshl_b32 s20, s20, 11
  v_add_u32 v10, s20, v0
  s_add_u32 s20, s16, 3
  s_and_b32 s20, s20, 3
  s_lshl_b32 s20, s20, 11
  v_add_u32 v11, s20, v0
  s_mov_b32 s38, 0x00ff00ff
  s_mov_b32 s39, 0x00ff00ff
  s_mov_b32 s50, 0x55555555
  s_mov_b32 s51, 0x55555555
  s_mov_b32 s48, 0x3e0293ee
  s_cmp_eq_u32 s16, 1
  s_cselect_b32 s66, 3, 2
  s_cselect_b32 s67, 4096, 0
  s_mov_b32 s58, 0x3e0293ee
  s_mov_b32 s59, 0x3e0293ee
  s_lshl_b32 s49, s17, 7
  s_add_u32 s49, s49, 8192
  s_cmp_eq_u32 s16, 0
  s_cselect_b64 s[52:53], s[38:39], 0
  s_cmp_eq_u32 s16, 3
  s_cselect_b64 s[54:55], 1, 0
  s_lshl_b32 s21, s17, 13
  s_lshl_b32 s22, s16, 11
  s_add_u32 s21, s21, s22
  s_add_u32 s25, s21, 1048576
  s_and_b32 s22, s16, 1
  s_lshl_b32 s22, s22, 10
  s_add_u32 s56, s25, s22
  s_xor_b32 s22, s22, 1024
  s_add_u32 s57, s25, s22
  s_mov_b32 s40, 1048576
  s_mov_b32 s41, 1081344
  s_mov_b32 s42, 1114112
  s_mov_b32 s43, 1146880
  s_mov_b32 s44, 1179648
  s_mov_b32 s45, 1212416
  s_mov_b32 s46, 1245184
  s_mov_b32 s47, 1277952
  buffer_store_dwordx4 v[20:23], v0, s[8:11], s25 offen
  buffer_store_dwordx4 v[20:23], v0, s[8:11], s25 offen offset:1024
  s_mov_b64 exec, s[38:39]
  s_mov_b32 s20, 1835008
  buffer_store_dwordx2 v[20:21], v17, s[8:11], s20 offen
  s_mov_b32 s20, 1843200
  buffer_store_dwordx2 v[20:21], v17, s[8:11], s20 offen
  s_mov_b32 s20, 1851392
  buffer_store_dwordx2 v[20:21], v17, s[8:11], s20 offen
  s_mov_b64 exec, -1
  s_lshl_b32 s22, s16, 15
  s_add_u32 s22, s22, 32768
  v_lshrrev_b32 v33, 4, v59
  v_bfe_u32 v34, v59, 2, 2
  v_and_b32 v35, 1, v33
  v_lshlrev_b32 v36, 4, v35
  v_lshrrev_b32 v37, 1, v33
  v_lshl_add_u32 v36, v37, 3, v36
  v_lshrrev_b32 v37, 1, v34
  v_lshl_add_u32 v36, v37, 2, v36
  v_and_b32 v37, 1, v34
  v_add_u32 v36, v36, v37
  v_lshlrev_b32 v36, 8, v36
  v_lshl_add_u32 v37, v35, 2, v34
  v_lshl_add_u32 v36, v37, 5, v36
  v_and_b32 v37, 3, v59
  v_lshl_add_u32 v36, v37, 3, v36
  v_add_u32 v36, s22, v36
  v_xor_b32 v40, 0, v36
  v_xor_b32 v41, 32, v36
  v_xor_b32 v42, 64, v36
  v_xor_b32 v43, 96, v36
  v_xor_b32 v44, 128, v36
  v_xor_b32 v45, 160, v36
  v_xor_b32 v46, 192, v36
  v_xor_b32 v47, 224, v36
  v_bfe_u32 v34, v59, 2, 2
  v_lshl_add_u32 v34, v33, 3, v34
  v_lshlrev_b32 v34, 6, v34
  v_and_b32 v35, 1, v59
  v_lshl_add_u32 v34, v35, 3, v34
  v_bfe_u32 v35, v59, 1, 1
  v_and_b32 v33, 1, v33
  v_lshlrev_b32 v33, 1, v33
  v_xor_b32 v35, v35, v33
  v_lshl_add_u32 v38, v35, 4, v34
  v_xor_b32 v35, 2, v35
  v_lshl_add_u32 v39, v35, 4, v34
  v_add_u32 v38, s22, v38
  v_add_u32 v39, s22, v39
  v_lshlrev_b32 v48, 4, v59
  v_add_u32 v48, s22, v48
  s_waitcnt vmcnt(29)
  ds_read_b64_tr_b16 v[192:193], v40 offset:0
  ds_read_b64_tr_b16 v[194:195], v40 offset:512
  ds_read_b64_tr_b16 v[208:209], v41 offset:0
  ds_read_b64_tr_b16 v[210:211], v41 offset:512
  ds_read_b64_tr_b16 v[224:225], v42 offset:0
  ds_read_b64_tr_b16 v[226:227], v42 offset:512
  ds_read_b64_tr_b16 v[240:241], v43 offset:0
  ds_read_b64_tr_b16 v[242:243], v43 offset:512
  s_waitcnt lgkmcnt(4)
  ds_read_b64_tr_b16 v[60:61], v44 offset:0
  ds_read_b64_tr_b16 v[62:63], v44 offset:512
  ds_read_b64_tr_b16 v[76:77], v45 offset:0
  ds_read_b64_tr_b16 v[78:79], v45 offset:512
  ds_read_b64_tr_b16 v[92:93], v46 offset:0
  ds_read_b64_tr_b16 v[94:95], v46 offset:512
  ds_read_b64_tr_b16 v[108:109], v47 offset:0
  ds_read_b64_tr_b16 v[110:111], v47 offset:512
  s_waitcnt lgkmcnt(0)
  s_waitcnt vmcnt(21)
  ds_read_b64_tr_b16 v[196:197], v40 offset:8192
  ds_read_b64_tr_b16 v[198:199], v40 offset:8704
  ds_read_b64_tr_b16 v[212:213], v41 offset:8192
  ds_read_b64_tr_b16 v[214:215], v41 offset:8704
  ds_read_b64_tr_b16 v[228:229], v42 offset:8192
  ds_read_b64_tr_b16 v[230:231], v42 offset:8704
  ds_read_b64_tr_b16 v[244:245], v43 offset:8192
  ds_read_b64_tr_b16 v[246:247], v43 offset:8704
  s_waitcnt lgkmcnt(4)
  ds_read_b64_tr_b16 v[64:65], v44 offset:8192
  ds_read_b64_tr_b16 v[66:67], v44 offset:8704
  ds_read_b64_tr_b16 v[80:81], v45 offset:8192
  ds_read_b64_tr_b16 v[82:83], v45 offset:8704
  ds_read_b64_tr_b16 v[96:97], v46 offset:8192
  ds_read_b64_tr_b16 v[98:99], v46 offset:8704
  ds_read_b64_tr_b16 v[112:113], v47 offset:8192
  ds_read_b64_tr_b16 v[114:115], v47 offset:8704
  s_waitcnt lgkmcnt(0)
  s_waitcnt vmcnt(13)
  ds_read_b64_tr_b16 v[200:201], v40 offset:16384
  ds_read_b64_tr_b16 v[202:203], v40 offset:16896
  ds_read_b64_tr_b16 v[216:217], v41 offset:16384
  ds_read_b64_tr_b16 v[218:219], v41 offset:16896
  ds_read_b64_tr_b16 v[232:233], v42 offset:16384
  ds_read_b64_tr_b16 v[234:235], v42 offset:16896
  ds_read_b64_tr_b16 v[248:249], v43 offset:16384
  ds_read_b64_tr_b16 v[250:251], v43 offset:16896
  s_waitcnt lgkmcnt(4)
  ds_read_b64_tr_b16 v[68:69], v44 offset:16384
  ds_read_b64_tr_b16 v[70:71], v44 offset:16896
  ds_read_b64_tr_b16 v[84:85], v45 offset:16384
  ds_read_b64_tr_b16 v[86:87], v45 offset:16896
  ds_read_b64_tr_b16 v[100:101], v46 offset:16384
  ds_read_b64_tr_b16 v[102:103], v46 offset:16896
  ds_read_b64_tr_b16 v[116:117], v47 offset:16384
  ds_read_b64_tr_b16 v[118:119], v47 offset:16896
  s_waitcnt lgkmcnt(0)
  s_waitcnt vmcnt(5)
  ds_read_b64_tr_b16 v[204:205], v40 offset:24576
  ds_read_b64_tr_b16 v[206:207], v40 offset:25088
  ds_read_b64_tr_b16 v[220:221], v41 offset:24576
  ds_read_b64_tr_b16 v[222:223], v41 offset:25088
  ds_read_b64_tr_b16 v[236:237], v42 offset:24576
  ds_read_b64_tr_b16 v[238:239], v42 offset:25088
  ds_read_b64_tr_b16 v[252:253], v43 offset:24576
  ds_read_b64_tr_b16 v[254:255], v43 offset:25088
  s_waitcnt lgkmcnt(4)
  ds_read_b64_tr_b16 v[72:73], v44 offset:24576
  ds_read_b64_tr_b16 v[74:75], v44 offset:25088
  ds_read_b64_tr_b16 v[88:89], v45 offset:24576
  ds_read_b64_tr_b16 v[90:91], v45 offset:25088
  ds_read_b64_tr_b16 v[104:105], v46 offset:24576
  ds_read_b64_tr_b16 v[106:107], v46 offset:25088
  ds_read_b64_tr_b16 v[120:121], v47 offset:24576
  ds_read_b64_tr_b16 v[122:123], v47 offset:25088
  s_waitcnt lgkmcnt(0)
  s_add_u32 s25, s23, 0
  s_add_u32 m0, s22, 24576
  s_nop 0
  buffer_load_dwordx4 v32, s[4:7], s25 offen lds
  s_add_u32 s25, s23, 131072
  s_add_u32 m0, s22, 25600
  s_nop 0
  buffer_load_dwordx4 v32, s[4:7], s25 offen lds
  s_add_u32 s25, s23, 262144
  s_add_u32 m0, s22, 26624
  s_nop 0
  buffer_load_dwordx4 v32, s[4:7], s25 offen lds
  s_add_u32 s25, s23, 393216
  s_add_u32 m0, s22, 27648
  s_nop 0
  buffer_load_dwordx4 v32, s[4:7], s25 offen lds
  s_add_u32 s25, s23, 524288
  s_add_u32 m0, s22, 28672
  s_nop 0
  buffer_load_dwordx4 v32, s[4:7], s25 offen lds
  s_add_u32 s25, s23, 655360
  s_add_u32 m0, s22, 29696
  s_nop 0
  buffer_load_dwordx4 v32, s[4:7], s25 offen lds
  s_add_u32 s25, s23, 786432
  s_add_u32 m0, s22, 30720
  s_nop 0
  buffer_load_dwordx4 v32, s[4:7], s25 offen lds
  s_add_u32 s25, s23, 917504
  s_add_u32 m0, s22, 31744
  s_nop 0
  buffer_load_dwordx4 v32, s[4:7], s25 offen lds
  s_add_u32 s25, s23, 1048576
  s_add_u32 m0, s22, 0
  s_nop 0
  buffer_load_dwordx4 v32, s[4:7], s25 offen lds
  s_add_u32 s25, s23, 1179648
  s_add_u32 m0, s22, 1024
  s_nop 0
  buffer_load_dwordx4 v32, s[4:7], s25 offen lds
  s_add_u32 s25, s23, 1310720
  s_add_u32 m0, s22, 2048
  s_nop 0
  buffer_load_dwordx4 v32, s[4:7], s25 offen lds
  s_add_u32 s25, s23, 1441792
  s_add_u32 m0, s22, 3072
  s_nop 0
  buffer_load_dwordx4 v32, s[4:7], s25 offen lds
  s_add_u32 s25, s23, 1572864
  s_add_u32 m0, s22, 4096
  s_nop 0
  buffer_load_dwordx4 v32, s[4:7], s25 offen lds
  s_add_u32 s25, s23, 1703936
  s_add_u32 m0, s22, 5120
  s_nop 0
  buffer_load_dwordx4 v32, s[4:7], s25 offen lds
  s_add_u32 s25, s23, 1835008
  s_add_u32 m0, s22, 6144
  s_nop 0
  buffer_load_dwordx4 v32, s[4:7], s25 offen lds
  s_add_u32 s25, s23, 1966080
  s_add_u32 m0, s22, 7168
  s_nop 0
  buffer_load_dwordx4 v32, s[4:7], s25 offen lds
  s_add_u32 s25, s23, 2097152
  s_add_u32 m0, s22, 8192
  s_nop 0
  buffer_load_dwordx4 v32, s[4:7], s25 offen lds
  s_add_u32 s25, s23, 2228224
  s_add_u32 m0, s22, 9216
  s_nop 0
  buffer_load_dwordx4 v32, s[4:7], s25 offen lds
  s_add_u32 s25, s23, 2359296
  s_add_u32 m0, s22, 10240
  s_nop 0
  buffer_load_dwordx4 v32, s[4:7], s25 offen lds
  s_add_u32 s25, s23, 2490368
  s_add_u32 m0, s22, 11264
  s_nop 0
  buffer_load_dwordx4 v32, s[4:7], s25 offen lds
  s_add_u32 s25, s23, 2621440
  s_add_u32 m0, s22, 12288
  s_nop 0
  buffer_load_dwordx4 v32, s[4:7], s25 offen lds
  s_add_u32 s25, s23, 2752512
  s_add_u32 m0, s22, 13312
  s_nop 0
  buffer_load_dwordx4 v32, s[4:7], s25 offen lds
  s_add_u32 s25, s23, 2883584
  s_add_u32 m0, s22, 14336
  s_nop 0
  buffer_load_dwordx4 v32, s[4:7], s25 offen lds
  s_add_u32 s25, s23, 3014656
  s_add_u32 m0, s22, 15360
  s_nop 0
  buffer_load_dwordx4 v32, s[4:7], s25 offen lds
  s_add_u32 s25, s23, 3145728
  s_add_u32 m0, s22, 16384
  s_nop 0
  buffer_load_dwordx4 v32, s[4:7], s25 offen lds
  s_add_u32 s25, s23, 3276800
  s_add_u32 m0, s22, 17408
  s_nop 0
  buffer_load_dwordx4 v32, s[4:7], s25 offen lds
  s_add_u32 s25, s23, 3407872
  s_add_u32 m0, s22, 18432
  s_nop 0
  buffer_load_dwordx4 v32, s[4:7], s25 offen lds
  s_add_u32 s25, s23, 3538944
  s_add_u32 m0, s22, 19456
  s_nop 0
  buffer_load_dwordx4 v32, s[4:7], s25 offen lds
  s_add_u32 s25, s23, 3670016
  s_add_u32 m0, s22, 20480
  s_nop 0
  buffer_load_dwordx4 v32, s[4:7], s25 offen lds
  s_add_u32 s25, s23, 3801088
  s_add_u32 m0, s22, 21504
  s_nop 0
  buffer_load_dwordx4 v32, s[4:7], s25 offen lds
  s_add_u32 s25, s23, 3932160
  s_add_u32 m0, s22, 22528
  s_nop 0
  buffer_load_dwordx4 v32, s[4:7], s25 offen lds
  s_add_u32 s25, s23, 4063232
  s_add_u32 m0, s22, 23552
  s_nop 0
  buffer_load_dwordx4 v32, s[4:7], s25 offen lds
  s_waitcnt vmcnt(30)
  s_barrier
  v_mov_b32 v56, 132
  v_mov_b32 v57, 1
  s_cmp_eq_u32 s16, 0
  s_cselect_b64 exec, 1, 0
  buffer_atomic_add v57, v56, s[12:15], 0 offen
  s_mov_b64 exec, -1
  ds_read_b64_tr_b16 a[48:49], v38 offset:24576
  ds_read_b64_tr_b16 a[50:51], v38 offset:24832
  ds_read_b64_tr_b16 a[112:113], v39 offset:24576
  ds_read_b64_tr_b16 a[114:115], v39 offset:24832
  s_waitcnt lgkmcnt(0)
  s_add_u32 s25, s23, 0
  s_add_u32 m0, s22, 24576
  s_nop 0
  buffer_load_dwordx4 v32, s[68:71], s25 offen lds
  s_add_u32 s25, s23, 131072
  s_add_u32 m0, s22, 25600
  s_nop 0
  buffer_load_dwordx4 v32, s[68:71], s25 offen lds
  s_waitcnt vmcnt(30)
  ds_read_b64_tr_b16 a[52:53], v38 offset:26624
  ds_read_b64_tr_b16 a[54:55], v38 offset:26880
  ds_read_b64_tr_b16 a[116:117], v39 offset:26624
  ds_read_b64_tr_b16 a[118:119], v39 offset:26880
  s_waitcnt lgkmcnt(0)
  s_add_u32 s25, s23, 262144
  s_add_u32 m0, s22, 26624
  s_nop 0
  buffer_load_dwordx4 v32, s[68:71], s25 offen lds
  s_add_u32 s25, s23, 393216
  s_add_u32 m0, s22, 27648
  s_nop 0
  buffer_load_dwordx4 v32, s[68:71], s25 offen lds
  s_waitcnt vmcnt(30)
  ds_read_b64_tr_b16 a[56:57], v38 offset:28672
  ds_read_b64_tr_b16 a[58:59], v38 offset:28928
  ds_read_b64_tr_b16 a[120:121], v39 offset:28672
  ds_read_b64_tr_b16 a[122:123], v39 offset:28928
  s_waitcnt lgkmcnt(0)
  s_add_u32 s25, s23, 524288
  s_add_u32 m0, s22, 28672
  s_nop 0
  buffer_load_dwordx4 v32, s[68:71], s25 offen lds
  s_add_u32 s25, s23, 655360
  s_add_u32 m0, s22, 29696
  s_nop 0
  buffer_load_dwordx4 v32, s[68:71], s25 offen lds
  s_waitcnt vmcnt(30)
  ds_read_b64_tr_b16 a[60:61], v38 offset:30720
  ds_read_b64_tr_b16 a[62:63], v38 offset:30976
  ds_read_b64_tr_b16 a[124:125], v39 offset:30720
  ds_read_b64_tr_b16 a[126:127], v39 offset:30976
  s_waitcnt lgkmcnt(0)
  s_add_u32 s25, s23, 786432
  s_add_u32 m0, s22, 30720
  s_nop 0
  buffer_load_dwordx4 v32, s[68:71], s25 offen lds
  s_add_u32 s25, s23, 917504
  s_add_u32 m0, s22, 31744
  s_nop 0
  buffer_load_dwordx4 v32, s[68:71], s25 offen lds
  s_waitcnt vmcnt(30)
  ds_read_b64_tr_b16 a[0:1], v38 offset:0
  ds_read_b64_tr_b16 a[2:3], v38 offset:256
  ds_read_b64_tr_b16 a[64:65], v39 offset:0
  ds_read_b64_tr_b16 a[66:67], v39 offset:256
  s_waitcnt lgkmcnt(0)
  s_add_u32 s25, s23, 1048576
  s_add_u32 m0, s22, 0
  s_nop 0
  buffer_load_dwordx4 v32, s[68:71], s25 offen lds
  s_add_u32 s25, s23, 1179648
  s_add_u32 m0, s22, 1024
  s_nop 0
  buffer_load_dwordx4 v32, s[68:71], s25 offen lds
  s_waitcnt vmcnt(30)
  ds_read_b64_tr_b16 a[4:5], v38 offset:2048
  ds_read_b64_tr_b16 a[6:7], v38 offset:2304
  ds_read_b64_tr_b16 a[68:69], v39 offset:2048
  ds_read_b64_tr_b16 a[70:71], v39 offset:2304
  s_waitcnt lgkmcnt(0)
  s_add_u32 s25, s23, 1310720
  s_add_u32 m0, s22, 2048
  s_nop 0
  buffer_load_dwordx4 v32, s[68:71], s25 offen lds
  s_add_u32 s25, s23, 1441792
  s_add_u32 m0, s22, 3072
  s_nop 0
  buffer_load_dwordx4 v32, s[68:71], s25 offen lds
  s_waitcnt vmcnt(30)
  ds_read_b64_tr_b16 a[8:9], v38 offset:4096
  ds_read_b64_tr_b16 a[10:11], v38 offset:4352
  ds_read_b64_tr_b16 a[72:73], v39 offset:4096
  ds_read_b64_tr_b16 a[74:75], v39 offset:4352
  s_waitcnt lgkmcnt(0)
  s_add_u32 s25, s23, 1572864
  s_add_u32 m0, s22, 4096
  s_nop 0
  buffer_load_dwordx4 v32, s[68:71], s25 offen lds
  s_add_u32 s25, s23, 1703936
  s_add_u32 m0, s22, 5120
  s_nop 0
  buffer_load_dwordx4 v32, s[68:71], s25 offen lds
  s_waitcnt vmcnt(30)
  ds_read_b64_tr_b16 a[12:13], v38 offset:6144
  ds_read_b64_tr_b16 a[14:15], v38 offset:6400
  ds_read_b64_tr_b16 a[76:77], v39 offset:6144
  ds_read_b64_tr_b16 a[78:79], v39 offset:6400
  s_waitcnt lgkmcnt(0)
  s_add_u32 s25, s23, 1835008
  s_add_u32 m0, s22, 6144
  s_nop 0
  buffer_load_dwordx4 v32, s[68:71], s25 offen lds
  s_add_u32 s25, s23, 1966080
  s_add_u32 m0, s22, 7168
  s_nop 0
  buffer_load_dwordx4 v32, s[68:71], s25 offen lds
  s_waitcnt vmcnt(30)
  ds_read_b64_tr_b16 a[16:17], v38 offset:8192
  ds_read_b64_tr_b16 a[18:19], v38 offset:8448
  ds_read_b64_tr_b16 a[80:81], v39 offset:8192
  ds_read_b64_tr_b16 a[82:83], v39 offset:8448
  s_waitcnt lgkmcnt(0)
  s_add_u32 s25, s23, 2097152
  s_add_u32 m0, s22, 8192
  s_nop 0
  buffer_load_dwordx4 v32, s[68:71], s25 offen lds
  s_add_u32 s25, s23, 2228224
  s_add_u32 m0, s22, 9216
  s_nop 0
  buffer_load_dwordx4 v32, s[68:71], s25 offen lds
  s_waitcnt vmcnt(30)
  ds_read_b64_tr_b16 a[20:21], v38 offset:10240
  ds_read_b64_tr_b16 a[22:23], v38 offset:10496
  ds_read_b64_tr_b16 a[84:85], v39 offset:10240
  ds_read_b64_tr_b16 a[86:87], v39 offset:10496
  s_waitcnt lgkmcnt(0)
  s_add_u32 s25, s23, 2359296
  s_add_u32 m0, s22, 10240
  s_nop 0
  buffer_load_dwordx4 v32, s[68:71], s25 offen lds
  s_add_u32 s25, s23, 2490368
  s_add_u32 m0, s22, 11264
  s_nop 0
  buffer_load_dwordx4 v32, s[68:71], s25 offen lds
  s_waitcnt vmcnt(30)
  ds_read_b64_tr_b16 a[24:25], v38 offset:12288
  ds_read_b64_tr_b16 a[26:27], v38 offset:12544
  ds_read_b64_tr_b16 a[88:89], v39 offset:12288
  ds_read_b64_tr_b16 a[90:91], v39 offset:12544
  s_waitcnt lgkmcnt(0)
  s_add_u32 s25, s23, 2621440
  s_add_u32 m0, s22, 12288
  s_nop 0
  buffer_load_dwordx4 v32, s[68:71], s25 offen lds
  s_add_u32 s25, s23, 2752512
  s_add_u32 m0, s22, 13312
  s_nop 0
  buffer_load_dwordx4 v32, s[68:71], s25 offen lds
  s_waitcnt vmcnt(30)
  ds_read_b64_tr_b16 a[28:29], v38 offset:14336
  ds_read_b64_tr_b16 a[30:31], v38 offset:14592
  ds_read_b64_tr_b16 a[92:93], v39 offset:14336
  ds_read_b64_tr_b16 a[94:95], v39 offset:14592
  s_waitcnt lgkmcnt(0)
  s_add_u32 s25, s23, 2883584
  s_add_u32 m0, s22, 14336
  s_nop 0
  buffer_load_dwordx4 v32, s[68:71], s25 offen lds
  s_add_u32 s25, s23, 3014656
  s_add_u32 m0, s22, 15360
  s_nop 0
  buffer_load_dwordx4 v32, s[68:71], s25 offen lds
  s_waitcnt vmcnt(30)
  ds_read_b64_tr_b16 a[32:33], v38 offset:16384
  ds_read_b64_tr_b16 a[34:35], v38 offset:16640
  ds_read_b64_tr_b16 a[96:97], v39 offset:16384
  ds_read_b64_tr_b16 a[98:99], v39 offset:16640
  s_waitcnt lgkmcnt(0)
  s_add_u32 s25, s23, 3145728
  s_add_u32 m0, s22, 16384
  s_nop 0
  buffer_load_dwordx4 v32, s[68:71], s25 offen lds
  s_add_u32 s25, s23, 3276800
  s_add_u32 m0, s22, 17408
  s_nop 0
  buffer_load_dwordx4 v32, s[68:71], s25 offen lds
  s_waitcnt vmcnt(30)
  ds_read_b64_tr_b16 a[36:37], v38 offset:18432
  ds_read_b64_tr_b16 a[38:39], v38 offset:18688
  ds_read_b64_tr_b16 a[100:101], v39 offset:18432
  ds_read_b64_tr_b16 a[102:103], v39 offset:18688
  s_waitcnt lgkmcnt(0)
  s_add_u32 s25, s23, 3407872
  s_add_u32 m0, s22, 18432
  s_nop 0
  buffer_load_dwordx4 v32, s[68:71], s25 offen lds
  s_add_u32 s25, s23, 3538944
  s_add_u32 m0, s22, 19456
  s_nop 0
  buffer_load_dwordx4 v32, s[68:71], s25 offen lds
  s_waitcnt vmcnt(30)
  ds_read_b64_tr_b16 a[40:41], v38 offset:20480
  ds_read_b64_tr_b16 a[42:43], v38 offset:20736
  ds_read_b64_tr_b16 a[104:105], v39 offset:20480
  ds_read_b64_tr_b16 a[106:107], v39 offset:20736
  s_waitcnt lgkmcnt(0)
  s_add_u32 s25, s23, 3670016
  s_add_u32 m0, s22, 20480
  s_nop 0
  buffer_load_dwordx4 v32, s[68:71], s25 offen lds
  s_add_u32 s25, s23, 3801088
  s_add_u32 m0, s22, 21504
  s_nop 0
  buffer_load_dwordx4 v32, s[68:71], s25 offen lds
  s_waitcnt vmcnt(30)
  ds_read_b64_tr_b16 a[44:45], v38 offset:22528
  ds_read_b64_tr_b16 a[46:47], v38 offset:22784
  ds_read_b64_tr_b16 a[108:109], v39 offset:22528
  ds_read_b64_tr_b16 a[110:111], v39 offset:22784
  s_waitcnt lgkmcnt(0)
  s_add_u32 s25, s23, 3932160
  s_add_u32 m0, s22, 22528
  s_nop 0
  buffer_load_dwordx4 v32, s[68:71], s25 offen lds
  s_add_u32 s25, s23, 4063232
  s_add_u32 m0, s22, 23552
  s_nop 0
  buffer_load_dwordx4 v32, s[68:71], s25 offen lds
  v_mov_b32 v51, 64
  buffer_load_dword v51, v51, s[12:15], 0 offen sc1
  s_waitcnt vmcnt(31)
  ds_read_b64_tr_b16 a[176:177], v38 offset:24576
  ds_read_b64_tr_b16 a[178:179], v38 offset:24832
  ds_read_b64_tr_b16 a[240:241], v39 offset:24576
  ds_read_b64_tr_b16 a[242:243], v39 offset:24832
  s_waitcnt lgkmcnt(0)
  s_add_u32 s25, s23, 0
  s_add_u32 m0, s22, 24576
  s_nop 0
  buffer_load_dwordx4 v32, s[72:75], s25 offen lds
  s_add_u32 s25, s23, 131072
  s_add_u32 m0, s22, 25600
  s_nop 0
  buffer_load_dwordx4 v32, s[72:75], s25 offen lds
  s_waitcnt vmcnt(31)
  ds_read_b64_tr_b16 a[180:181], v38 offset:26624
  ds_read_b64_tr_b16 a[182:183], v38 offset:26880
  ds_read_b64_tr_b16 a[244:245], v39 offset:26624
  ds_read_b64_tr_b16 a[246:247], v39 offset:26880
  s_waitcnt lgkmcnt(0)
  s_add_u32 s25, s23, 262144
  s_add_u32 m0, s22, 26624
  s_nop 0
  buffer_load_dwordx4 v32, s[72:75], s25 offen lds
  s_add_u32 s25, s23, 393216
  s_add_u32 m0, s22, 27648
  s_nop 0
  buffer_load_dwordx4 v32, s[72:75], s25 offen lds
  s_waitcnt vmcnt(31)
  ds_read_b64_tr_b16 a[184:185], v38 offset:28672
  ds_read_b64_tr_b16 a[186:187], v38 offset:28928
  ds_read_b64_tr_b16 a[248:249], v39 offset:28672
  ds_read_b64_tr_b16 a[250:251], v39 offset:28928
  s_waitcnt lgkmcnt(0)
  s_add_u32 s25, s23, 524288
  s_add_u32 m0, s22, 28672
  s_nop 0
  buffer_load_dwordx4 v32, s[72:75], s25 offen lds
  s_add_u32 s25, s23, 655360
  s_add_u32 m0, s22, 29696
  s_nop 0
  buffer_load_dwordx4 v32, s[72:75], s25 offen lds
  s_waitcnt vmcnt(31)
  ds_read_b64_tr_b16 a[188:189], v38 offset:30720
  ds_read_b64_tr_b16 a[190:191], v38 offset:30976
  ds_read_b64_tr_b16 a[252:253], v39 offset:30720
  ds_read_b64_tr_b16 a[254:255], v39 offset:30976
  s_waitcnt lgkmcnt(0)
  s_add_u32 s25, s23, 786432
  s_add_u32 m0, s22, 30720
  s_nop 0
  buffer_load_dwordx4 v32, s[72:75], s25 offen lds
  s_add_u32 s25, s23, 917504
  s_add_u32 m0, s22, 31744
  s_nop 0
  buffer_load_dwordx4 v32, s[72:75], s25 offen lds
  s_waitcnt vmcnt(31)
  ds_read_b64_tr_b16 a[128:129], v38 offset:0
  ds_read_b64_tr_b16 a[130:131], v38 offset:256
  ds_read_b64_tr_b16 a[192:193], v39 offset:0
  ds_read_b64_tr_b16 a[194:195], v39 offset:256
  s_waitcnt lgkmcnt(0)
  s_add_u32 s25, s23, 1048576
  s_add_u32 m0, s22, 0
  s_nop 0
  buffer_load_dwordx4 v32, s[72:75], s25 offen lds
  s_add_u32 s25, s23, 1179648
  s_add_u32 m0, s22, 1024
  s_nop 0
  buffer_load_dwordx4 v32, s[72:75], s25 offen lds
  s_waitcnt vmcnt(31)
  ds_read_b64_tr_b16 a[132:133], v38 offset:2048
  ds_read_b64_tr_b16 a[134:135], v38 offset:2304
  ds_read_b64_tr_b16 a[196:197], v39 offset:2048
  ds_read_b64_tr_b16 a[198:199], v39 offset:2304
  s_waitcnt lgkmcnt(0)
  s_add_u32 s25, s23, 1310720
  s_add_u32 m0, s22, 2048
  s_nop 0
  buffer_load_dwordx4 v32, s[72:75], s25 offen lds
  s_add_u32 s25, s23, 1441792
  s_add_u32 m0, s22, 3072
  s_nop 0
  buffer_load_dwordx4 v32, s[72:75], s25 offen lds
  s_waitcnt vmcnt(31)
  ds_read_b64_tr_b16 a[136:137], v38 offset:4096
  ds_read_b64_tr_b16 a[138:139], v38 offset:4352
  ds_read_b64_tr_b16 a[200:201], v39 offset:4096
  ds_read_b64_tr_b16 a[202:203], v39 offset:4352
  s_waitcnt lgkmcnt(0)
  s_add_u32 s25, s23, 1572864
  s_add_u32 m0, s22, 4096
  s_nop 0
  buffer_load_dwordx4 v32, s[72:75], s25 offen lds
  s_add_u32 s25, s23, 1703936
  s_add_u32 m0, s22, 5120
  s_nop 0
  buffer_load_dwordx4 v32, s[72:75], s25 offen lds
  s_waitcnt vmcnt(31)
  ds_read_b64_tr_b16 a[140:141], v38 offset:6144
  ds_read_b64_tr_b16 a[142:143], v38 offset:6400
  ds_read_b64_tr_b16 a[204:205], v39 offset:6144
  ds_read_b64_tr_b16 a[206:207], v39 offset:6400
  s_waitcnt lgkmcnt(0)
  s_add_u32 s25, s23, 1835008
  s_add_u32 m0, s22, 6144
  s_nop 0
  buffer_load_dwordx4 v32, s[72:75], s25 offen lds
  s_add_u32 s25, s23, 1966080
  s_add_u32 m0, s22, 7168
  s_nop 0
  buffer_load_dwordx4 v32, s[72:75], s25 offen lds
  s_waitcnt vmcnt(31)
  ds_read_b64_tr_b16 a[144:145], v38 offset:8192
  ds_read_b64_tr_b16 a[146:147], v38 offset:8448
  ds_read_b64_tr_b16 a[208:209], v39 offset:8192
  ds_read_b64_tr_b16 a[210:211], v39 offset:8448
  s_waitcnt lgkmcnt(0)
  s_add_u32 s25, s23, 2097152
  s_add_u32 m0, s22, 8192
  s_nop 0
  buffer_load_dwordx4 v32, s[72:75], s25 offen lds
  s_add_u32 s25, s23, 2228224
  s_add_u32 m0, s22, 9216
  s_nop 0
  buffer_load_dwordx4 v32, s[72:75], s25 offen lds
  s_waitcnt vmcnt(31)
  ds_read_b64_tr_b16 a[148:149], v38 offset:10240
  ds_read_b64_tr_b16 a[150:151], v38 offset:10496
  ds_read_b64_tr_b16 a[212:213], v39 offset:10240
  ds_read_b64_tr_b16 a[214:215], v39 offset:10496
  s_waitcnt lgkmcnt(0)
  s_add_u32 s25, s23, 2359296
  s_add_u32 m0, s22, 10240
  s_nop 0
  buffer_load_dwordx4 v32, s[72:75], s25 offen lds
  s_add_u32 s25, s23, 2490368
  s_add_u32 m0, s22, 11264
  s_nop 0
  buffer_load_dwordx4 v32, s[72:75], s25 offen lds
  s_waitcnt vmcnt(31)
  ds_read_b64_tr_b16 a[152:153], v38 offset:12288
  ds_read_b64_tr_b16 a[154:155], v38 offset:12544
  ds_read_b64_tr_b16 a[216:217], v39 offset:12288
  ds_read_b64_tr_b16 a[218:219], v39 offset:12544
  s_waitcnt lgkmcnt(0)
  s_add_u32 s25, s23, 2621440
  s_add_u32 m0, s22, 12288
  s_nop 0
  buffer_load_dwordx4 v32, s[72:75], s25 offen lds
  s_add_u32 s25, s23, 2752512
  s_add_u32 m0, s22, 13312
  s_nop 0
  buffer_load_dwordx4 v32, s[72:75], s25 offen lds
  s_waitcnt vmcnt(31)
  ds_read_b64_tr_b16 a[156:157], v38 offset:14336
  ds_read_b64_tr_b16 a[158:159], v38 offset:14592
  ds_read_b64_tr_b16 a[220:221], v39 offset:14336
  ds_read_b64_tr_b16 a[222:223], v39 offset:14592
  s_waitcnt lgkmcnt(0)
  s_add_u32 s25, s23, 2883584
  s_add_u32 m0, s22, 14336
  s_nop 0
  buffer_load_dwordx4 v32, s[72:75], s25 offen lds
  s_add_u32 s25, s23, 3014656
  s_add_u32 m0, s22, 15360
  s_nop 0
  buffer_load_dwordx4 v32, s[72:75], s25 offen lds
  s_waitcnt vmcnt(31)
  ds_read_b64_tr_b16 a[160:161], v38 offset:16384
  ds_read_b64_tr_b16 a[162:163], v38 offset:16640
  ds_read_b64_tr_b16 a[224:225], v39 offset:16384
  ds_read_b64_tr_b16 a[226:227], v39 offset:16640
  s_waitcnt lgkmcnt(0)
  s_add_u32 s25, s23, 3145728
  s_add_u32 m0, s22, 16384
  s_nop 0
  buffer_load_dwordx4 v32, s[72:75], s25 offen lds
  s_add_u32 s25, s23, 3276800
  s_add_u32 m0, s22, 17408
  s_nop 0
  buffer_load_dwordx4 v32, s[72:75], s25 offen lds
  s_waitcnt vmcnt(31)
  ds_read_b64_tr_b16 a[164:165], v38 offset:18432
  ds_read_b64_tr_b16 a[166:167], v38 offset:18688
  ds_read_b64_tr_b16 a[228:229], v39 offset:18432
  ds_read_b64_tr_b16 a[230:231], v39 offset:18688
  s_waitcnt lgkmcnt(0)
  s_add_u32 s25, s23, 3407872
  s_add_u32 m0, s22, 18432
  s_nop 0
  buffer_load_dwordx4 v32, s[72:75], s25 offen lds
  s_add_u32 s25, s23, 3538944
  s_add_u32 m0, s22, 19456
  s_nop 0
  buffer_load_dwordx4 v32, s[72:75], s25 offen lds
  s_waitcnt vmcnt(31)
  ds_read_b64_tr_b16 a[168:169], v38 offset:20480
  ds_read_b64_tr_b16 a[170:171], v38 offset:20736
  ds_read_b64_tr_b16 a[232:233], v39 offset:20480
  ds_read_b64_tr_b16 a[234:235], v39 offset:20736
  s_waitcnt lgkmcnt(0)
  s_add_u32 s25, s23, 3670016
  s_add_u32 m0, s22, 20480
  s_nop 0
  buffer_load_dwordx4 v32, s[72:75], s25 offen lds
  s_add_u32 s25, s23, 3801088
  s_add_u32 m0, s22, 21504
  s_nop 0
  buffer_load_dwordx4 v32, s[72:75], s25 offen lds
  s_waitcnt vmcnt(31)
  ds_read_b64_tr_b16 a[172:173], v38 offset:22528
  ds_read_b64_tr_b16 a[174:175], v38 offset:22784
  ds_read_b64_tr_b16 a[236:237], v39 offset:22528
  ds_read_b64_tr_b16 a[238:239], v39 offset:22784
  s_waitcnt lgkmcnt(0)
  s_add_u32 s25, s23, 3932160
  s_add_u32 m0, s22, 22528
  s_nop 0
  buffer_load_dwordx4 v32, s[72:75], s25 offen lds
  s_add_u32 s25, s23, 4063232
  s_add_u32 m0, s22, 23552
  s_nop 0
  buffer_load_dwordx4 v32, s[72:75], s25 offen lds
  s_waitcnt vmcnt(32)
  s_load_dwordx2 s[4:5], s[0:1], 8
  s_waitcnt lgkmcnt(0)
  s_mov_b32 s6, 8192
  s_mov_b32 s7, 0x20000
  v_bfe_u32 v58, v59, 1, 3
  v_lshlrev_b32 v58, 10, v58
  v_lshrrev_b32 v56, 4, v59
  v_lshl_add_u32 v58, v56, 5, v58
  v_and_b32 v56, 1, v59
  v_lshl_add_u32 v58, v56, 2, v58
  s_lshl_b32 s20, s16, 8
  buffer_load_dword v20, v58, s[4:7], s20 offen offset:0
  buffer_load_dword v21, v58, s[4:7], s20 offen offset:8
  buffer_load_dword v22, v58, s[4:7], s20 offen offset:16
  buffer_load_dword v23, v58, s[4:7], s20 offen offset:24
  buffer_load_dword v24, v58, s[4:7], s20 offen offset:128
  buffer_load_dword v25, v58, s[4:7], s20 offen offset:136
  buffer_load_dword v26, v58, s[4:7], s20 offen offset:144
  buffer_load_dword v27, v58, s[4:7], s20 offen offset:152
  v_mov_b32 v57, 132
  buffer_load_dword v57, v57, s[12:15], 0 offen sc1
  s_lshl_b32 s20, s17, 8
  v_lshlrev_b32 v50, 2, v59
  buffer_load_dword v50, v50, s[8:11], s20 offen offset:0 sc1
  s_waitcnt vmcnt(40)
  ds_read_b64_tr_b16 v[176:177], v38 offset:24576
  ds_read_b64_tr_b16 v[178:179], v38 offset:24832
  ds_read_b64_tr_b16 v[52:53], v39 offset:24576
  ds_read_b64_tr_b16 v[54:55], v39 offset:24832
  s_waitcnt vmcnt(38)
  ds_read_b64_tr_b16 v[180:181], v38 offset:26624
  ds_read_b64_tr_b16 v[182:183], v38 offset:26880
  ds_read_b64_tr_b16 v[124:125], v39 offset:26624
  ds_read_b64_tr_b16 v[126:127], v39 offset:26880
  s_waitcnt lgkmcnt(4)
  ds_write_b128 v48, v[52:55] offset:24576
  ds_write_b128 v48, v[108:111] offset:25600
  s_waitcnt vmcnt(36)
  ds_read_b64_tr_b16 v[184:185], v38 offset:28672
  ds_read_b64_tr_b16 v[186:187], v38 offset:28928
  ds_read_b64_tr_b16 v[52:53], v39 offset:28672
  ds_read_b64_tr_b16 v[54:55], v39 offset:28928
  s_waitcnt lgkmcnt(6)
  ds_write_b128 v48, v[124:127] offset:26624
  ds_write_b128 v48, v[112:115] offset:27648
  s_waitcnt vmcnt(34)
  ds_read_b64_tr_b16 v[188:189], v38 offset:30720
  ds_read_b64_tr_b16 v[190:191], v38 offset:30976
  ds_read_b64_tr_b16 v[124:125], v39 offset:30720
  ds_read_b64_tr_b16 v[126:127], v39 offset:30976
  s_waitcnt lgkmcnt(6)
  ds_write_b128 v48, v[52:55] offset:28672
  ds_write_b128 v48, v[116:119] offset:29696
  s_waitcnt vmcnt(32)
  ds_read_b64_tr_b16 v[128:129], v38 offset:0
  ds_read_b64_tr_b16 v[130:131], v38 offset:256
  ds_read_b64_tr_b16 v[52:53], v39 offset:0
  ds_read_b64_tr_b16 v[54:55], v39 offset:256
  s_waitcnt lgkmcnt(6)
  ds_write_b128 v48, v[124:127] offset:30720
  ds_write_b128 v48, v[120:123] offset:31744
  s_waitcnt vmcnt(30)
  ds_read_b64_tr_b16 v[132:133], v38 offset:2048
  ds_read_b64_tr_b16 v[134:135], v38 offset:2304
  ds_read_b64_tr_b16 v[124:125], v39 offset:2048
  ds_read_b64_tr_b16 v[126:127], v39 offset:2304
  s_waitcnt lgkmcnt(6)
  ds_write_b128 v48, v[52:55] offset:0
  ds_write_b128 v48, v[60:63] offset:1024
  s_waitcnt vmcnt(28)
  ds_read_b64_tr_b16 v[136:137], v38 offset:4096
  ds_read_b64_tr_b16 v[138:139], v38 offset:4352
  ds_read_b64_tr_b16 v[52:53], v39 offset:4096
  ds_read_b64_tr_b16 v[54:55], v39 offset:4352
  s_waitcnt lgkmcnt(6)
  ds_write_b128 v48, v[124:127] offset:2048
  ds_write_b128 v48, v[64:67] offset:3072
  s_waitcnt vmcnt(26)
  ds_read_b64_tr_b16 v[140:141], v38 offset:6144
  ds_read_b64_tr_b16 v[142:143], v38 offset:6400
  ds_read_b64_tr_b16 v[124:125], v39 offset:6144
  ds_read_b64_tr_b16 v[126:127], v39 offset:6400
  s_waitcnt lgkmcnt(6)
  ds_write_b128 v48, v[52:55] offset:4096
  ds_write_b128 v48, v[68:71] offset:5120
  s_waitcnt vmcnt(24)
  ds_read_b64_tr_b16 v[144:145], v38 offset:8192
  ds_read_b64_tr_b16 v[146:147], v38 offset:8448
  ds_read_b64_tr_b16 v[52:53], v39 offset:8192
  ds_read_b64_tr_b16 v[54:55], v39 offset:8448
  s_waitcnt lgkmcnt(6)
  ds_write_b128 v48, v[124:127] offset:6144
  ds_write_b128 v48, v[72:75] offset:7168
  s_waitcnt vmcnt(22)
  ds_read_b64_tr_b16 v[148:149], v38 offset:10240
  ds_read_b64_tr_b16 v[150:151], v38 offset:10496
  ds_read_b64_tr_b16 v[124:125], v39 offset:10240
  ds_read_b64_tr_b16 v[126:127], v39 offset:10496
  s_waitcnt lgkmcnt(6)
  ds_write_b128 v48, v[52:55] offset:8192
  ds_write_b128 v48, v[76:79] offset:9216
  s_waitcnt vmcnt(20)
  ds_read_b64_tr_b16 v[152:153], v38 offset:12288
  ds_read_b64_tr_b16 v[154:155], v38 offset:12544
  ds_read_b64_tr_b16 v[52:53], v39 offset:12288
  ds_read_b64_tr_b16 v[54:55], v39 offset:12544
  s_waitcnt lgkmcnt(6)
  ds_write_b128 v48, v[124:127] offset:10240
  ds_write_b128 v48, v[80:83] offset:11264
  s_waitcnt vmcnt(18)
  ds_read_b64_tr_b16 v[156:157], v38 offset:14336
  ds_read_b64_tr_b16 v[158:159], v38 offset:14592
  ds_read_b64_tr_b16 v[124:125], v39 offset:14336
  ds_read_b64_tr_b16 v[126:127], v39 offset:14592
  s_waitcnt lgkmcnt(6)
  ds_write_b128 v48, v[52:55] offset:12288
  ds_write_b128 v48, v[84:87] offset:13312
  s_waitcnt vmcnt(16)
  ds_read_b64_tr_b16 v[160:161], v38 offset:16384
  ds_read_b64_tr_b16 v[162:163], v38 offset:16640
  ds_read_b64_tr_b16 v[52:53], v39 offset:16384
  ds_read_b64_tr_b16 v[54:55], v39 offset:16640
  s_waitcnt lgkmcnt(6)
  ds_write_b128 v48, v[124:127] offset:14336
  ds_write_b128 v48, v[88:91] offset:15360
  s_waitcnt vmcnt(14)
  ds_read_b64_tr_b16 v[164:165], v38 offset:18432
  ds_read_b64_tr_b16 v[166:167], v38 offset:18688
  ds_read_b64_tr_b16 v[124:125], v39 offset:18432
  ds_read_b64_tr_b16 v[126:127], v39 offset:18688
  s_waitcnt lgkmcnt(6)
  ds_write_b128 v48, v[52:55] offset:16384
  ds_write_b128 v48, v[92:95] offset:17408
  s_waitcnt vmcnt(12)
  ds_read_b64_tr_b16 v[168:169], v38 offset:20480
  ds_read_b64_tr_b16 v[170:171], v38 offset:20736
  ds_read_b64_tr_b16 v[52:53], v39 offset:20480
  ds_read_b64_tr_b16 v[54:55], v39 offset:20736
  s_waitcnt lgkmcnt(6)
  ds_write_b128 v48, v[124:127] offset:18432
  ds_write_b128 v48, v[96:99] offset:19456
  s_waitcnt vmcnt(10)
  ds_read_b64_tr_b16 v[172:173], v38 offset:22528
  ds_read_b64_tr_b16 v[174:175], v38 offset:22784
  ds_read_b64_tr_b16 v[124:125], v39 offset:22528
  ds_read_b64_tr_b16 v[126:127], v39 offset:22784
  s_waitcnt lgkmcnt(6)
  ds_write_b128 v48, v[52:55] offset:20480
  ds_write_b128 v48, v[100:103] offset:21504
  s_waitcnt lgkmcnt(2)
  ds_write_b128 v48, v[124:127] offset:22528
  ds_write_b128 v48, v[104:107] offset:23552
  s_waitcnt lgkmcnt(0)
  s_branch L_ld_done
L_ld_2:
  s_cmp_eq_u32 s16, 2
  s_cbranch_scc0 L_ld_3
  s_load_dwordx2 s[4:5], s[0:1], 16
  s_load_dwordx2 s[68:69], s[0:1], 24
  s_load_dwordx2 s[72:73], s[0:1], 32
  s_load_dwordx2 s[76:77], s[0:1], 40
  s_lshl_b32 s22, s16, 15
  s_add_u32 s22, s22, 32768
  v_lshrrev_b32 v28, 4, v59
  v_and_b32 v29, 1, v28
  v_lshlrev_b32 v29, 1, v29
  v_and_b32 v30, 15, v59
  v_xor_b32 v30, v30, v29
  v_lshlrev_b32 v30, 4, v30
  v_lshl_add_u32 v28, v28, 10, v30
  v_xor_b32 v29, 64, v28
  v_xor_b32 v30, 128, v28
  v_xor_b32 v31, 192, v28
  s_lshl_b32 s26, s17, 17
  s_lshl_b32 s27, s16, 8
  s_add_u32 s26, s26, s27
  v_lshrrev_b32 v32, 2, v59
  v_and_b32 v33, 3, v59
  v_lshrrev_b32 v34, 5, v59
  v_lshlrev_b32 v34, 1, v34
  v_xor_b32 v33, v33, v34
  v_lshlrev_b32 v32, 13, v32
  v_lshl_add_u32 v32, v33, 4, v32
  s_lshl_b32 s23, s17, 8
  s_lshl_b32 s24, s16, 6
  s_add_u32 s23, s23, s24
  s_mov_b32 s24, 0
  s_waitcnt lgkmcnt(0)
  s_mov_b32 s6, 4194304
  s_mov_b32 s7, 0x20000
  s_mov_b32 s70, 4194304
  s_mov_b32 s71, 0x20000
  s_mov_b32 s74, 4194304
  s_mov_b32 s75, 0x20000
  s_mov_b32 s78, 4194304
  s_mov_b32 s79, 0x20000
  s_add_u32 s25, s26, 0
  s_add_u32 m0, s22, 0
  s_nop 0
  buffer_load_dwordx4 v28, s[76:79], s25 offen lds
  s_add_u32 s25, s26, 4096
  s_add_u32 m0, s22, 1024
  s_nop 0
  buffer_load_dwordx4 v29, s[76:79], s25 offen lds
  s_add_u32 s25, s26, 8192
  s_add_u32 m0, s22, 2048
  s_nop 0
  buffer_load_dwordx4 v28, s[76:79], s25 offen lds
  s_add_u32 s25, s26, 12288
  s_add_u32 m0, s22, 3072
  s_nop 0
  buffer_load_dwordx4 v29, s[76:79], s25 offen lds
  s_add_u32 s25, s26, 16384
  s_add_u32 m0, s22, 4096
  s_nop 0
  buffer_load_dwordx4 v30, s[76:79], s25 offen lds
  s_add_u32 s25, s26, 20480
  s_add_u32 m0, s22, 5120
  s_nop 0
  buffer_load_dwordx4 v31, s[76:79], s25 offen lds
  s_add_u32 s25, s26, 24576
  s_add_u32 m0, s22, 6144
  s_nop 0
  buffer_load_dwordx4 v30, s[76:79], s25 offen lds
  s_add_u32 s25, s26, 28672
  s_add_u32 m0, s22, 7168
  s_nop 0
  buffer_load_dwordx4 v31, s[76:79], s25 offen lds
  s_add_u32 s25, s26, 32768
  s_add_u32 m0, s22, 8192
  s_nop 0
  buffer_load_dwordx4 v28, s[76:79], s25 offen lds
  s_add_u32 s25, s26, 36864
  s_add_u32 m0, s22, 9216
  s_nop 0
  buffer_load_dwordx4 v29, s[76:79], s25 offen lds
  s_add_u32 s25, s26, 40960
  s_add_u32 m0, s22, 10240
  s_nop 0
  buffer_load_dwordx4 v28, s[76:79], s25 offen lds
  s_add_u32 s25, s26, 45056
  s_add_u32 m0, s22, 11264
  s_nop 0
  buffer_load_dwordx4 v29, s[76:79], s25 offen lds
  s_add_u32 s25, s26, 49152
  s_add_u32 m0, s22, 12288
  s_nop 0
  buffer_load_dwordx4 v30, s[76:79], s25 offen lds
  s_add_u32 s25, s26, 53248
  s_add_u32 m0, s22, 13312
  s_nop 0
  buffer_load_dwordx4 v31, s[76:79], s25 offen lds
  s_add_u32 s25, s26, 57344
  s_add_u32 m0, s22, 14336
  s_nop 0
  buffer_load_dwordx4 v30, s[76:79], s25 offen lds
  s_add_u32 s25, s26, 61440
  s_add_u32 m0, s22, 15360
  s_nop 0
  buffer_load_dwordx4 v31, s[76:79], s25 offen lds
  s_add_u32 s25, s26, 65536
  s_add_u32 m0, s22, 16384
  s_nop 0
  buffer_load_dwordx4 v28, s[76:79], s25 offen lds
  s_add_u32 s25, s26, 69632
  s_add_u32 m0, s22, 17408
  s_nop 0
  buffer_load_dwordx4 v29, s[76:79], s25 offen lds
  s_add_u32 s25, s26, 73728
  s_add_u32 m0, s22, 18432
  s_nop 0
  buffer_load_dwordx4 v28, s[76:79], s25 offen lds
  s_add_u32 s25, s26, 77824
  s_add_u32 m0, s22, 19456
  s_nop 0
  buffer_load_dwordx4 v29, s[76:79], s25 offen lds
  s_add_u32 s25, s26, 81920
  s_add_u32 m0, s22, 20480
  s_nop 0
  buffer_load_dwordx4 v30, s[76:79], s25 offen lds
  s_add_u32 s25, s26, 86016
  s_add_u32 m0, s22, 21504
  s_nop 0
  buffer_load_dwordx4 v31, s[76:79], s25 offen lds
  s_add_u32 s25, s26, 90112
  s_add_u32 m0, s22, 22528
  s_nop 0
  buffer_load_dwordx4 v30, s[76:79], s25 offen lds
  s_add_u32 s25, s26, 94208
  s_add_u32 m0, s22, 23552
  s_nop 0
  buffer_load_dwordx4 v31, s[76:79], s25 offen lds
  s_add_u32 s25, s26, 98304
  s_add_u32 m0, s22, 24576
  s_nop 0
  buffer_load_dwordx4 v28, s[76:79], s25 offen lds
  s_add_u32 s25, s26, 102400
  s_add_u32 m0, s22, 25600
  s_nop 0
  buffer_load_dwordx4 v29, s[76:79], s25 offen lds
  s_add_u32 s25, s26, 106496
  s_add_u32 m0, s22, 26624
  s_nop 0
  buffer_load_dwordx4 v28, s[76:79], s25 offen lds
  s_add_u32 s25, s26, 110592
  s_add_u32 m0, s22, 27648
  s_nop 0
  buffer_load_dwordx4 v29, s[76:79], s25 offen lds
  s_add_u32 s25, s26, 114688
  s_add_u32 m0, s22, 28672
  s_nop 0
  buffer_load_dwordx4 v30, s[76:79], s25 offen lds
  s_add_u32 s25, s26, 118784
  s_add_u32 m0, s22, 29696
  s_nop 0
  buffer_load_dwordx4 v31, s[76:79], s25 offen lds
  s_add_u32 s25, s26, 122880
  s_add_u32 m0, s22, 30720
  s_nop 0
  buffer_load_dwordx4 v30, s[76:79], s25 offen lds
  s_add_u32 s25, s26, 126976
  s_add_u32 m0, s22, 31744
  s_nop 0
  buffer_load_dwordx4 v31, s[76:79], s25 offen lds
  v_mov_b32 v20, -1
  v_mov_b32 v21, -1
  v_mov_b32 v22, -1
  v_mov_b32 v23, -1
  v_and_b32 v60, 15, v0
  v_lshrrev_b32 v61, 4, v0
  v_lshrrev_b32 v62, 1, v60
  v_mov_b32 v63, 0x3f80
  v_mov_b32 v64, 0x3f800000
  v_mov_b32 v67, 0x3f803f80
  v_mov_b32 v1, 0x4444
  v_mov_b32 v65, 0xeeee
  v_and_b32 v66, 1, v60
  v_cmp_eq_u32 vcc, 0, v66
  s_nop 1
  v_cndmask_b32 v1, v65, v1, vcc
  v_lshlrev_b32 v65, 1, v61
  v_mov_b32 v2, 0
  v_mov_b32 v3, 0
  v_cmp_eq_u32 vcc, v65, v62
  s_nop 1
  v_cndmask_b32 v2, v2, v67, vcc
  v_add_u32 v65, 1, v65
  v_cmp_eq_u32 vcc, v65, v62
  s_nop 1
  v_cndmask_b32 v3, v3, v67, vcc
  v_and_b32 v62, 7, v0
  v_mov_b32 v4, 0
  v_cmp_eq_u32 vcc, 0, v62
  s_nop 1
  v_cndmask_b32 v4, v4, v63, vcc
  v_cmp_eq_u32 vcc, 1, v62
  s_nop 1
  v_cndmask_b32 v4, v4, v64, vcc
  v_mov_b32 v5, 0
  v_cmp_eq_u32 vcc, 2, v62
  s_nop 1
  v_cndmask_b32 v5, v5, v63, vcc
  v_cmp_eq_u32 vcc, 3, v62
  s_nop 1
  v_cndmask_b32 v5, v5, v64, vcc
  v_mov_b32 v6, 0
  v_cmp_eq_u32 vcc, 4, v62
  s_nop 1
  v_cndmask_b32 v6, v6, v63, vcc
  v_cmp_eq_u32 vcc, 5, v62
  s_nop 1
  v_cndmask_b32 v6, v6, v64, vcc
  v_mov_b32 v7, 0
  v_cmp_eq_u32 vcc, 6, v62
  s_nop 1
  v_cndmask_b32 v7, v7, v63, vcc
  v_cmp_eq_u32 vcc, 7, v62
  s_nop 1
  v_cndmask_b32 v7, v7, v64, vcc
  v_bfe_u32 v65, v60, 2, 1
  v_lshlrev_b32 v66, 3, v65
  v_bfe_u32 v65, v60, 1, 1
  v_lshl_add_u32 v66, v65, 2, v66
  v_lshrrev_b32 v65, 3, v60
  v_lshl_add_u32 v66, v65, 1, v66
  v_and_b32 v65, 1, v60
  v_add_u32 v66, v66, v65
  v_lshlrev_b32 v66, 4, v66
  v_lshl_add_u32 v66, v61, 13, v66
  s_lshr_b32 s20, s17, 3
  s_and_b32 s20, s20, 1
  s_lshl_b32 s20, s20, 2
  s_xor_b32 s20, s20, s17
  s_lshl_b32 s20, s20, 8
  v_add_u32 v16, s20, v66
  s_lshr_b32 s20, s17, 2
  s_lshl_b32 s20, s20, 10
  s_and_b32 s21, s17, 3
  s_lshl_b32 s21, s21, 6
  s_add_u32 s20, s20, s21
  v_lshrrev_b32 v65, 1, v62
  v_lshlrev_b32 v66, 8, v65
  v_and_b32 v65, 1, v62
  v_lshl_add_u32 v66, v65, 5, v66
  v_lshrrev_b32 v65, 1, v61
  v_lshl_add_u32 v66, v65, 4, v66
  v_and_b32 v65, 1, v61
  v_lshl_add_u32 v66, v65, 3, v66
  v_add_u32 v17, s20, v66
  v_lshrrev_b32 v65, 1, v61
  v_lshlrev_b32 v66, 8, v65
  v_lshrrev_b32 v65, 1, v60
  v_lshl_add_u32 v66, v65, 5, v66
  v_and_b32 v65, 1, v61
  v_lshl_add_u32 v66, v65, 4, v66
  s_lshl_b32 s20, s16, 9
  v_add_u32 v15, s20, v66
  v_lshlrev_b32 v66, 3, v0
  s_add_u32 s21, s20, 12288
  v_add_u32 v14, s21, v66
  v_and_b32 v65, 1, v0
  v_lshl_add_u32 v19, v65, 10, v66
  v_lshlrev_b32 v0, 4, v0
  s_lshl_b32 s20, s16, 11
  v_add_u32 v8, s20, v0
  s_lshl_b32 s20, s16, 10
  v_add_u32 v13, s20, v0
  s_lshl_b32 s20, s16, 15
  s_add_u32 s20, s20, 32768
  v_add_u32 v12, s20, v0
  s_add_u32 s20, s16, 1
  s_and_b32 s20, s20, 3
  s_lshl_b32 s20, s20, 11
  v_add_u32 v9, s20, v0
  s_add_u32 s20, s16, 2
  s_and_b32 s20, s20, 3
  s_lshl_b32 s20, s20, 11
  v_add_u32 v10, s20, v0
  s_add_u32 s20, s16, 3
  s_and_b32 s20, s20, 3
  s_lshl_b32 s20, s20, 11
  v_add_u32 v11, s20, v0
  s_mov_b32 s38, 0x00ff00ff
  s_mov_b32 s39, 0x00ff00ff
  s_mov_b32 s50, 0x55555555
  s_mov_b32 s51, 0x55555555
  s_mov_b32 s48, 0x3e0293ee
  s_cmp_eq_u32 s16, 1
  s_cselect_b32 s66, 3, 2
  s_cselect_b32 s67, 4096, 0
  s_mov_b32 s58, 0x3e0293ee
  s_mov_b32 s59, 0x3e0293ee
  s_lshl_b32 s49, s17, 7
  s_add_u32 s49, s49, 8192
  s_cmp_eq_u32 s16, 0
  s_cselect_b64 s[52:53], s[38:39], 0
  s_cmp_eq_u32 s16, 3
  s_cselect_b64 s[54:55], 1, 0
  s_lshl_b32 s21, s17, 13
  s_lshl_b32 s22, s16, 11
  s_add_u32 s21, s21, s22
  s_add_u32 s25, s21, 1048576
  s_and_b32 s22, s16, 1
  s_lshl_b32 s22, s22, 10
  s_add_u32 s56, s25, s22
  s_xor_b32 s22, s22, 1024
  s_add_u32 s57, s25, s22
  s_mov_b32 s40, 1048576
  s_mov_b32 s41, 1081344
  s_mov_b32 s42, 1114112
  s_mov_b32 s43, 1146880
  s_mov_b32 s44, 1179648
  s_mov_b32 s45, 1212416
  s_mov_b32 s46, 1245184
  s_mov_b32 s47, 1277952
  buffer_store_dwordx4 v[20:23], v0, s[8:11], s25 offen
  buffer_store_dwordx4 v[20:23], v0, s[8:11], s25 offen offset:1024
  s_mov_b64 exec, s[38:39]
  s_mov_b32 s20, 1835008
  buffer_store_dwordx2 v[20:21], v17, s[8:11], s20 offen
  s_mov_b32 s20, 1843200
  buffer_store_dwordx2 v[20:21], v17, s[8:11], s20 offen
  s_mov_b32 s20, 1851392
  buffer_store_dwordx2 v[20:21], v17, s[8:11], s20 offen
  s_mov_b64 exec, -1
  s_lshl_b32 s22, s16, 15
  s_add_u32 s22, s22, 32768
  v_lshrrev_b32 v33, 4, v59
  v_bfe_u32 v34, v59, 2, 2
  v_and_b32 v35, 1, v33
  v_lshlrev_b32 v36, 4, v35
  v_lshrrev_b32 v37, 1, v33
  v_lshl_add_u32 v36, v37, 3, v36
  v_lshrrev_b32 v37, 1, v34
  v_lshl_add_u32 v36, v37, 2, v36
  v_and_b32 v37, 1, v34
  v_add_u32 v36, v36, v37
  v_lshlrev_b32 v36, 8, v36
  v_lshl_add_u32 v37, v35, 2, v34
  v_lshl_add_u32 v36, v37, 5, v36
  v_and_b32 v37, 3, v59
  v_lshl_add_u32 v36, v37, 3, v36
  v_add_u32 v36, s22, v36
  v_xor_b32 v40, 0, v36
  v_xor_b32 v41, 32, v36
  v_xor_b32 v42, 64, v36
  v_xor_b32 v43, 96, v36
  v_xor_b32 v44, 128, v36
  v_xor_b32 v45, 160, v36
  v_xor_b32 v46, 192, v36
  v_xor_b32 v47, 224, v36
  v_bfe_u32 v34, v59, 2, 2
  v_lshl_add_u32 v34, v33, 3, v34
  v_lshlrev_b32 v34, 6, v34
  v_and_b32 v35, 1, v59
  v_lshl_add_u32 v34, v35, 3, v34
  v_bfe_u32 v35, v59, 1, 1
  v_and_b32 v33, 1, v33
  v_lshlrev_b32 v33, 1, v33
  v_xor_b32 v35, v35, v33
  v_lshl_add_u32 v38, v35, 4, v34
  v_xor_b32 v35, 2, v35
  v_lshl_add_u32 v39, v35, 4, v34
  v_add_u32 v38, s22, v38
  v_add_u32 v39, s22, v39
  v_lshlrev_b32 v48, 4, v59
  v_add_u32 v48, s22, v48
  s_waitcnt vmcnt(29)
  ds_read_b64_tr_b16 v[192:193], v40 offset:0
  ds_read_b64_tr_b16 v[194:195], v40 offset:512
  ds_read_b64_tr_b16 v[208:209], v41 offset:0
  ds_read_b64_tr_b16 v[210:211], v41 offset:512
  ds_read_b64_tr_b16 v[224:225], v42 offset:0
  ds_read_b64_tr_b16 v[226:227], v42 offset:512
  ds_read_b64_tr_b16 v[240:241], v43 offset:0
  ds_read_b64_tr_b16 v[242:243], v43 offset:512
  s_waitcnt lgkmcnt(4)
  ds_read_b64_tr_b16 v[60:61], v44 offset:0
  ds_read_b64_tr_b16 v[62:63], v44 offset:512
  ds_read_b64_tr_b16 v[76:77], v45 offset:0
  ds_read_b64_tr_b16 v[78:79], v45 offset:512
  ds_read_b64_tr_b16 v[92:93], v46 offset:0
  ds_read_b64_tr_b16 v[94:95], v46 offset:512
  ds_read_b64_tr_b16 v[108:109], v47 offset:0
  ds_read_b64_tr_b16 v[110:111], v47 offset:512
  s_waitcnt lgkmcnt(0)
  s_waitcnt vmcnt(21)
  ds_read_b64_tr_b16 v[196:197], v40 offset:8192
  ds_read_b64_tr_b16 v[198:199], v40 offset:8704
  ds_read_b64_tr_b16 v[212:213], v41 offset:8192
  ds_read_b64_tr_b16 v[214:215], v41 offset:8704
  ds_read_b64_tr_b16 v[228:229], v42 offset:8192
  ds_read_b64_tr_b16 v[230:231], v42 offset:8704
  ds_read_b64_tr_b16 v[244:245], v43 offset:8192
  ds_read_b64_tr_b16 v[246:247], v43 offset:8704
  s_waitcnt lgkmcnt(4)
  ds_read_b64_tr_b16 v[64:65], v44 offset:8192
  ds_read_b64_tr_b16 v[66:67], v44 offset:8704
  ds_read_b64_tr_b16 v[80:81], v45 offset:8192
  ds_read_b64_tr_b16 v[82:83], v45 offset:8704
  ds_read_b64_tr_b16 v[96:97], v46 offset:8192
  ds_read_b64_tr_b16 v[98:99], v46 offset:8704
  ds_read_b64_tr_b16 v[112:113], v47 offset:8192
  ds_read_b64_tr_b16 v[114:115], v47 offset:8704
  s_waitcnt lgkmcnt(0)
  s_waitcnt vmcnt(13)
  ds_read_b64_tr_b16 v[200:201], v40 offset:16384
  ds_read_b64_tr_b16 v[202:203], v40 offset:16896
  ds_read_b64_tr_b16 v[216:217], v41 offset:16384
  ds_read_b64_tr_b16 v[218:219], v41 offset:16896
  ds_read_b64_tr_b16 v[232:233], v42 offset:16384
  ds_read_b64_tr_b16 v[234:235], v42 offset:16896
  ds_read_b64_tr_b16 v[248:249], v43 offset:16384
  ds_read_b64_tr_b16 v[250:251], v43 offset:16896
  s_waitcnt lgkmcnt(4)
  ds_read_b64_tr_b16 v[68:69], v44 offset:16384
  ds_read_b64_tr_b16 v[70:71], v44 offset:16896
  ds_read_b64_tr_b16 v[84:85], v45 offset:16384
  ds_read_b64_tr_b16 v[86:87], v45 offset:16896
  ds_read_b64_tr_b16 v[100:101], v46 offset:16384
  ds_read_b64_tr_b16 v[102:103], v46 offset:16896
  ds_read_b64_tr_b16 v[116:117], v47 offset:16384
  ds_read_b64_tr_b16 v[118:119], v47 offset:16896
  s_waitcnt lgkmcnt(0)
  s_add_u32 s25, s23, 0
  s_add_u32 m0, s22, 16384
  s_nop 0
  buffer_load_dwordx4 v32, s[4:7], s25 offen lds
  s_add_u32 s25, s23, 131072
  s_add_u32 m0, s22, 17408
  s_nop 0
  buffer_load_dwordx4 v32, s[4:7], s25 offen lds
  s_add_u32 s25, s23, 262144
  s_add_u32 m0, s22, 18432
  s_nop 0
  buffer_load_dwordx4 v32, s[4:7], s25 offen lds
  s_add_u32 s25, s23, 393216
  s_add_u32 m0, s22, 19456
  s_nop 0
  buffer_load_dwordx4 v32, s[4:7], s25 offen lds
  s_add_u32 s25, s23, 524288
  s_add_u32 m0, s22, 20480
  s_nop 0
  buffer_load_dwordx4 v32, s[4:7], s25 offen lds
  s_add_u32 s25, s23, 655360
  s_add_u32 m0, s22, 21504
  s_nop 0
  buffer_load_dwordx4 v32, s[4:7], s25 offen lds
  s_add_u32 s25, s23, 786432
  s_add_u32 m0, s22, 22528
  s_nop 0
  buffer_load_dwordx4 v32, s[4:7], s25 offen lds
  s_add_u32 s25, s23, 917504
  s_add_u32 m0, s22, 23552
  s_nop 0
  buffer_load_dwordx4 v32, s[4:7], s25 offen lds
  s_waitcnt vmcnt(13)
  ds_read_b64_tr_b16 v[204:205], v40 offset:24576
  ds_read_b64_tr_b16 v[206:207], v40 offset:25088
  ds_read_b64_tr_b16 v[220:221], v41 offset:24576
  ds_read_b64_tr_b16 v[222:223], v41 offset:25088
  ds_read_b64_tr_b16 v[236:237], v42 offset:24576
  ds_read_b64_tr_b16 v[238:239], v42 offset:25088
  ds_read_b64_tr_b16 v[252:253], v43 offset:24576
  ds_read_b64_tr_b16 v[254:255], v43 offset:25088
  s_waitcnt lgkmcnt(4)
  ds_read_b64_tr_b16 v[72:73], v44 offset:24576
  ds_read_b64_tr_b16 v[74:75], v44 offset:25088
  ds_read_b64_tr_b16 v[88:89], v45 offset:24576
  ds_read_b64_tr_b16 v[90:91], v45 offset:25088
  ds_read_b64_tr_b16 v[104:105], v46 offset:24576
  ds_read_b64_tr_b16 v[106:107], v46 offset:25088
  ds_read_b64_tr_b16 v[120:121], v47 offset:24576
  ds_read_b64_tr_b16 v[122:123], v47 offset:25088
  s_waitcnt lgkmcnt(0)
  s_add_u32 s25, s23, 1048576
  s_add_u32 m0, s22, 24576
  s_nop 0
  buffer_load_dwordx4 v32, s[4:7], s25 offen lds
  s_add_u32 s25, s23, 1179648
  s_add_u32 m0, s22, 25600
  s_nop 0
  buffer_load_dwordx4 v32, s[4:7], s25 offen lds
  s_add_u32 s25, s23, 1310720
  s_add_u32 m0, s22, 26624
  s_nop 0
  buffer_load_dwordx4 v32, s[4:7], s25 offen lds
  s_add_u32 s25, s23, 1441792
  s_add_u32 m0, s22, 27648
  s_nop 0
  buffer_load_dwordx4 v32, s[4:7], s25 offen lds
  s_add_u32 s25, s23, 1572864
  s_add_u32 m0, s22, 28672
  s_nop 0
  buffer_load_dwordx4 v32, s[4:7], s25 offen lds
  s_add_u32 s25, s23, 1703936
  s_add_u32 m0, s22, 29696
  s_nop 0
  buffer_load_dwordx4 v32, s[4:7], s25 offen lds
  s_add_u32 s25, s23, 1835008
  s_add_u32 m0, s22, 30720
  s_nop 0
  buffer_load_dwordx4 v32, s[4:7], s25 offen lds
  s_add_u32 s25, s23, 1966080
  s_add_u32 m0, s22, 31744
  s_nop 0
  buffer_load_dwordx4 v32, s[4:7], s25 offen lds
  s_add_u32 s25, s23, 2097152
  s_add_u32 m0, s22, 0
  s_nop 0
  buffer_load_dwordx4 v32, s[4:7], s25 offen lds
  s_add_u32 s25, s23, 2228224
  s_add_u32 m0, s22, 1024
  s_nop 0
  buffer_load_dwordx4 v32, s[4:7], s25 offen lds
  s_add_u32 s25, s23, 2359296
  s_add_u32 m0, s22, 2048
  s_nop 0
  buffer_load_dwordx4 v32, s[4:7], s25 offen lds
  s_add_u32 s25, s23, 2490368
  s_add_u32 m0, s22, 3072
  s_nop 0
  buffer_load_dwordx4 v32, s[4:7], s25 offen lds
  s_add_u32 s25, s23, 2621440
  s_add_u32 m0, s22, 4096
  s_nop 0
  buffer_load_dwordx4 v32, s[4:7], s25 offen lds
  s_add_u32 s25, s23, 2752512
  s_add_u32 m0, s22, 5120
  s_nop 0
  buffer_load_dwordx4 v32, s[4:7], s25 offen lds
  s_add_u32 s25, s23, 2883584
  s_add_u32 m0, s22, 6144
  s_nop 0
  buffer_load_dwordx4 v32, s[4:7], s25 offen lds
  s_add_u32 s25, s23, 3014656
  s_add_u32 m0, s22, 7168
  s_nop 0
  buffer_load_dwordx4 v32, s[4:7], s25 offen lds
  s_add_u32 s25, s23, 3145728
  s_add_u32 m0, s22, 8192
  s_nop 0
  buffer_load_dwordx4 v32, s[4:7], s25 offen lds
  s_add_u32 s25, s23, 3276800
  s_add_u32 m0, s22, 9216
  s_nop 0
  buffer_load_dwordx4 v32, s[4:7], s25 offen lds
  s_add_u32 s25, s23, 3407872
  s_add_u32 m0, s22, 10240
  s_nop 0
  buffer_load_dwordx4 v32, s[4:7], s25 offen lds
  s_add_u32 s25, s23, 3538944
  s_add_u32 m0, s22, 11264
  s_nop 0
  buffer_load_dwordx4 v32, s[4:7], s25 offen lds
  s_add_u32 s25, s23, 3670016
  s_add_u32 m0, s22, 12288
  s_nop 0
  buffer_load_dwordx4 v32, s[4:7], s25 offen lds
  s_add_u32 s25, s23, 3801088
  s_add_u32 m0, s22, 13312
  s_nop 0
  buffer_load_dwordx4 v32, s[4:7], s25 offen lds
  s_add_u32 s25, s23, 3932160
  s_add_u32 m0, s22, 14336
  s_nop 0
  buffer_load_dwordx4 v32, s[4:7], s25 offen lds
  s_add_u32 s25, s23, 4063232
  s_add_u32 m0, s22, 15360
  s_nop 0
  buffer_load_dwordx4 v32, s[4:7], s25 offen lds
  s_waitcnt vmcnt(30)
  s_barrier
  v_mov_b32 v56, 132
  v_mov_b32 v57, 1
  s_cmp_eq_u32 s16, 0
  s_cselect_b64 exec, 1, 0
  buffer_atomic_add v57, v56, s[12:15], 0 offen
  s_mov_b64 exec, -1
  ds_read_b64_tr_b16 a[32:33], v38 offset:16384
  ds_read_b64_tr_b16 a[34:35], v38 offset:16640
  ds_read_b64_tr_b16 a[96:97], v39 offset:16384
  ds_read_b64_tr_b16 a[98:99], v39 offset:16640
  s_waitcnt lgkmcnt(0)
  s_add_u32 s25, s23, 0
  s_add_u32 m0, s22, 16384
  s_nop 0
  buffer_load_dwordx4 v32, s[68:71], s25 offen lds
  s_add_u32 s25, s23, 131072
  s_add_u32 m0, s22, 17408
  s_nop 0
  buffer_load_dwordx4 v32, s[68:71], s25 offen lds
  s_waitcnt vmcnt(30)
  ds_read_b64_tr_b16 a[36:37], v38 offset:18432
  ds_read_b64_tr_b16 a[38:39], v38 offset:18688
  ds_read_b64_tr_b16 a[100:101], v39 offset:18432
  ds_read_b64_tr_b16 a[102:103], v39 offset:18688
  s_waitcnt lgkmcnt(0)
  s_add_u32 s25, s23, 262144
  s_add_u32 m0, s22, 18432
  s_nop 0
  buffer_load_dwordx4 v32, s[68:71], s25 offen lds
  s_add_u32 s25, s23, 393216
  s_add_u32 m0, s22, 19456
  s_nop 0
  buffer_load_dwordx4 v32, s[68:71], s25 offen lds
  s_waitcnt vmcnt(30)
  ds_read_b64_tr_b16 a[40:41], v38 offset:20480
  ds_read_b64_tr_b16 a[42:43], v38 offset:20736
  ds_read_b64_tr_b16 a[104:105], v39 offset:20480
  ds_read_b64_tr_b16 a[106:107], v39 offset:20736
  s_waitcnt lgkmcnt(0)
  s_add_u32 s25, s23, 524288
  s_add_u32 m0, s22, 20480
  s_nop 0
  buffer_load_dwordx4 v32, s[68:71], s25 offen lds
  s_add_u32 s25, s23, 655360
  s_add_u32 m0, s22, 21504
  s_nop 0
  buffer_load_dwordx4 v32, s[68:71], s25 offen lds
  s_waitcnt vmcnt(30)
  ds_read_b64_tr_b16 a[44:45], v38 offset:22528
  ds_read_b64_tr_b16 a[46:47], v38 offset:22784
  ds_read_b64_tr_b16 a[108:109], v39 offset:22528
  ds_read_b64_tr_b16 a[110:111], v39 offset:22784
  s_waitcnt lgkmcnt(0)
  s_add_u32 s25, s23, 786432
  s_add_u32 m0, s22, 22528
  s_nop 0
  buffer_load_dwordx4 v32, s[68:71], s25 offen lds
  s_add_u32 s25, s23, 917504
  s_add_u32 m0, s22, 23552
  s_nop 0
  buffer_load_dwordx4 v32, s[68:71], s25 offen lds
  s_waitcnt vmcnt(30)
  ds_read_b64_tr_b16 a[48:49], v38 offset:24576
  ds_read_b64_tr_b16 a[50:51], v38 offset:24832
  ds_read_b64_tr_b16 a[112:113], v39 offset:24576
  ds_read_b64_tr_b16 a[114:115], v39 offset:24832
  s_waitcnt lgkmcnt(0)
  s_add_u32 s25, s23, 1048576
  s_add_u32 m0, s22, 24576
  s_nop 0
  buffer_load_dwordx4 v32, s[68:71], s25 offen lds
  s_add_u32 s25, s23, 1179648
  s_add_u32 m0, s22, 25600
  s_nop 0
  buffer_load_dwordx4 v32, s[68:71], s25 offen lds
  s_waitcnt vmcnt(30)
  ds_read_b64_tr_b16 a[52:53], v38 offset:26624
  ds_read_b64_tr_b16 a[54:55], v38 offset:26880
  ds_read_b64_tr_b16 a[116:117], v39 offset:26624
  ds_read_b64_tr_b16 a[118:119], v39 offset:26880
  s_waitcnt lgkmcnt(0)
  s_add_u32 s25, s23, 1310720
  s_add_u32 m0, s22, 26624
  s_nop 0
  buffer_load_dwordx4 v32, s[68:71], s25 offen lds
  s_add_u32 s25, s23, 1441792
  s_add_u32 m0, s22, 27648
  s_nop 0
  buffer_load_dwordx4 v32, s[68:71], s25 offen lds
  s_waitcnt vmcnt(30)
  ds_read_b64_tr_b16 a[56:57], v38 offset:28672
  ds_read_b64_tr_b16 a[58:59], v38 offset:28928
  ds_read_b64_tr_b16 a[120:121], v39 offset:28672
  ds_read_b64_tr_b16 a[122:123], v39 offset:28928
  s_waitcnt lgkmcnt(0)
  s_add_u32 s25, s23, 1572864
  s_add_u32 m0, s22, 28672
  s_nop 0
  buffer_load_dwordx4 v32, s[68:71], s25 offen lds
  s_add_u32 s25, s23, 1703936
  s_add_u32 m0, s22, 29696
  s_nop 0
  buffer_load_dwordx4 v32, s[68:71], s25 offen lds
  s_waitcnt vmcnt(30)
  ds_read_b64_tr_b16 a[60:61], v38 offset:30720
  ds_read_b64_tr_b16 a[62:63], v38 offset:30976
  ds_read_b64_tr_b16 a[124:125], v39 offset:30720
  ds_read_b64_tr_b16 a[126:127], v39 offset:30976
  s_waitcnt lgkmcnt(0)
  s_add_u32 s25, s23, 1835008
  s_add_u32 m0, s22, 30720
  s_nop 0
  buffer_load_dwordx4 v32, s[68:71], s25 offen lds
  s_add_u32 s25, s23, 1966080
  s_add_u32 m0, s22, 31744
  s_nop 0
  buffer_load_dwordx4 v32, s[68:71], s25 offen lds
  s_waitcnt vmcnt(30)
  ds_read_b64_tr_b16 a[0:1], v38 offset:0
  ds_read_b64_tr_b16 a[2:3], v38 offset:256
  ds_read_b64_tr_b16 a[64:65], v39 offset:0
  ds_read_b64_tr_b16 a[66:67], v39 offset:256
  s_waitcnt lgkmcnt(0)
  s_add_u32 s25, s23, 2097152
  s_add_u32 m0, s22, 0
  s_nop 0
  buffer_load_dwordx4 v32, s[68:71], s25 offen lds
  s_add_u32 s25, s23, 2228224
  s_add_u32 m0, s22, 1024
  s_nop 0
  buffer_load_dwordx4 v32, s[68:71], s25 offen lds
  s_waitcnt vmcnt(30)
  ds_read_b64_tr_b16 a[4:5], v38 offset:2048
  ds_read_b64_tr_b16 a[6:7], v38 offset:2304
  ds_read_b64_tr_b16 a[68:69], v39 offset:2048
  ds_read_b64_tr_b16 a[70:71], v39 offset:2304
  s_waitcnt lgkmcnt(0)
  s_add_u32 s25, s23, 2359296
  s_add_u32 m0, s22, 2048
  s_nop 0
  buffer_load_dwordx4 v32, s[68:71], s25 offen lds
  s_add_u32 s25, s23, 2490368
  s_add_u32 m0, s22, 3072
  s_nop 0
  buffer_load_dwordx4 v32, s[68:71], s25 offen lds
  s_waitcnt vmcnt(30)
  ds_read_b64_tr_b16 a[8:9], v38 offset:4096
  ds_read_b64_tr_b16 a[10:11], v38 offset:4352
  ds_read_b64_tr_b16 a[72:73], v39 offset:4096
  ds_read_b64_tr_b16 a[74:75], v39 offset:4352
  s_waitcnt lgkmcnt(0)
  s_add_u32 s25, s23, 2621440
  s_add_u32 m0, s22, 4096
  s_nop 0
  buffer_load_dwordx4 v32, s[68:71], s25 offen lds
  s_add_u32 s25, s23, 2752512
  s_add_u32 m0, s22, 5120
  s_nop 0
  buffer_load_dwordx4 v32, s[68:71], s25 offen lds
  s_waitcnt vmcnt(30)
  ds_read_b64_tr_b16 a[12:13], v38 offset:6144
  ds_read_b64_tr_b16 a[14:15], v38 offset:6400
  ds_read_b64_tr_b16 a[76:77], v39 offset:6144
  ds_read_b64_tr_b16 a[78:79], v39 offset:6400
  s_waitcnt lgkmcnt(0)
  s_add_u32 s25, s23, 2883584
  s_add_u32 m0, s22, 6144
  s_nop 0
  buffer_load_dwordx4 v32, s[68:71], s25 offen lds
  s_add_u32 s25, s23, 3014656
  s_add_u32 m0, s22, 7168
  s_nop 0
  buffer_load_dwordx4 v32, s[68:71], s25 offen lds
  s_waitcnt vmcnt(30)
  ds_read_b64_tr_b16 a[16:17], v38 offset:8192
  ds_read_b64_tr_b16 a[18:19], v38 offset:8448
  ds_read_b64_tr_b16 a[80:81], v39 offset:8192
  ds_read_b64_tr_b16 a[82:83], v39 offset:8448
  s_waitcnt lgkmcnt(0)
  s_add_u32 s25, s23, 3145728
  s_add_u32 m0, s22, 8192
  s_nop 0
  buffer_load_dwordx4 v32, s[68:71], s25 offen lds
  s_add_u32 s25, s23, 3276800
  s_add_u32 m0, s22, 9216
  s_nop 0
  buffer_load_dwordx4 v32, s[68:71], s25 offen lds
  s_waitcnt vmcnt(30)
  ds_read_b64_tr_b16 a[20:21], v38 offset:10240
  ds_read_b64_tr_b16 a[22:23], v38 offset:10496
  ds_read_b64_tr_b16 a[84:85], v39 offset:10240
  ds_read_b64_tr_b16 a[86:87], v39 offset:10496
  s_waitcnt lgkmcnt(0)
  s_add_u32 s25, s23, 3407872
  s_add_u32 m0, s22, 10240
  s_nop 0
  buffer_load_dwordx4 v32, s[68:71], s25 offen lds
  s_add_u32 s25, s23, 3538944
  s_add_u32 m0, s22, 11264
  s_nop 0
  buffer_load_dwordx4 v32, s[68:71], s25 offen lds
  s_waitcnt vmcnt(30)
  ds_read_b64_tr_b16 a[24:25], v38 offset:12288
  ds_read_b64_tr_b16 a[26:27], v38 offset:12544
  ds_read_b64_tr_b16 a[88:89], v39 offset:12288
  ds_read_b64_tr_b16 a[90:91], v39 offset:12544
  s_waitcnt lgkmcnt(0)
  s_add_u32 s25, s23, 3670016
  s_add_u32 m0, s22, 12288
  s_nop 0
  buffer_load_dwordx4 v32, s[68:71], s25 offen lds
  s_add_u32 s25, s23, 3801088
  s_add_u32 m0, s22, 13312
  s_nop 0
  buffer_load_dwordx4 v32, s[68:71], s25 offen lds
  s_waitcnt vmcnt(30)
  ds_read_b64_tr_b16 a[28:29], v38 offset:14336
  ds_read_b64_tr_b16 a[30:31], v38 offset:14592
  ds_read_b64_tr_b16 a[92:93], v39 offset:14336
  ds_read_b64_tr_b16 a[94:95], v39 offset:14592
  s_waitcnt lgkmcnt(0)
  s_add_u32 s25, s23, 3932160
  s_add_u32 m0, s22, 14336
  s_nop 0
  buffer_load_dwordx4 v32, s[68:71], s25 offen lds
  s_add_u32 s25, s23, 4063232
  s_add_u32 m0, s22, 15360
  s_nop 0
  buffer_load_dwordx4 v32, s[68:71], s25 offen lds
  v_mov_b32 v51, 64
  buffer_load_dword v51, v51, s[12:15], 0 offen sc1
  s_waitcnt vmcnt(31)
  ds_read_b64_tr_b16 a[160:161], v38 offset:16384
  ds_read_b64_tr_b16 a[162:163], v38 offset:16640
  ds_read_b64_tr_b16 a[224:225], v39 offset:16384
  ds_read_b64_tr_b16 a[226:227], v39 offset:16640
  s_waitcnt lgkmcnt(0)
  s_add_u32 s25, s23, 0
  s_add_u32 m0, s22, 16384
  s_nop 0
  buffer_load_dwordx4 v32, s[72:75], s25 offen lds
  s_add_u32 s25, s23, 131072
  s_add_u32 m0, s22, 17408
  s_nop 0
  buffer_load_dwordx4 v32, s[72:75], s25 offen lds
  s_waitcnt vmcnt(31)
  ds_read_b64_tr_b16 a[164:165], v38 offset:18432
  ds_read_b64_tr_b16 a[166:167], v38 offset:18688
  ds_read_b64_tr_b16 a[228:229], v39 offset:18432
  ds_read_b64_tr_b16 a[230:231], v39 offset:18688
  s_waitcnt lgkmcnt(0)
  s_add_u32 s25, s23, 262144
  s_add_u32 m0, s22, 18432
  s_nop 0
  buffer_load_dwordx4 v32, s[72:75], s25 offen lds
  s_add_u32 s25, s23, 393216
  s_add_u32 m0, s22, 19456
  s_nop 0
  buffer_load_dwordx4 v32, s[72:75], s25 offen lds
  s_waitcnt vmcnt(31)
  ds_read_b64_tr_b16 a[168:169], v38 offset:20480
  ds_read_b64_tr_b16 a[170:171], v38 offset:20736
  ds_read_b64_tr_b16 a[232:233], v39 offset:20480
  ds_read_b64_tr_b16 a[234:235], v39 offset:20736
  s_waitcnt lgkmcnt(0)
  s_add_u32 s25, s23, 524288
  s_add_u32 m0, s22, 20480
  s_nop 0
  buffer_load_dwordx4 v32, s[72:75], s25 offen lds
  s_add_u32 s25, s23, 655360
  s_add_u32 m0, s22, 21504
  s_nop 0
  buffer_load_dwordx4 v32, s[72:75], s25 offen lds
  s_waitcnt vmcnt(31)
  ds_read_b64_tr_b16 a[172:173], v38 offset:22528
  ds_read_b64_tr_b16 a[174:175], v38 offset:22784
  ds_read_b64_tr_b16 a[236:237], v39 offset:22528
  ds_read_b64_tr_b16 a[238:239], v39 offset:22784
  s_waitcnt lgkmcnt(0)
  s_add_u32 s25, s23, 786432
  s_add_u32 m0, s22, 22528
  s_nop 0
  buffer_load_dwordx4 v32, s[72:75], s25 offen lds
  s_add_u32 s25, s23, 917504
  s_add_u32 m0, s22, 23552
  s_nop 0
  buffer_load_dwordx4 v32, s[72:75], s25 offen lds
  s_waitcnt vmcnt(31)
  ds_read_b64_tr_b16 a[176:177], v38 offset:24576
  ds_read_b64_tr_b16 a[178:179], v38 offset:24832
  ds_read_b64_tr_b16 a[240:241], v39 offset:24576
  ds_read_b64_tr_b16 a[242:243], v39 offset:24832
  s_waitcnt lgkmcnt(0)
  s_add_u32 s25, s23, 1048576
  s_add_u32 m0, s22, 24576
  s_nop 0
  buffer_load_dwordx4 v32, s[72:75], s25 offen lds
  s_add_u32 s25, s23, 1179648
  s_add_u32 m0, s22, 25600
  s_nop 0
  buffer_load_dwordx4 v32, s[72:75], s25 offen lds
  s_waitcnt vmcnt(31)
  ds_read_b64_tr_b16 a[180:181], v38 offset:26624
  ds_read_b64_tr_b16 a[182:183], v38 offset:26880
  ds_read_b64_tr_b16 a[244:245], v39 offset:26624
  ds_read_b64_tr_b16 a[246:247], v39 offset:26880
  s_waitcnt lgkmcnt(0)
  s_add_u32 s25, s23, 1310720
  s_add_u32 m0, s22, 26624
  s_nop 0
  buffer_load_dwordx4 v32, s[72:75], s25 offen lds
  s_add_u32 s25, s23, 1441792
  s_add_u32 m0, s22, 27648
  s_nop 0
  buffer_load_dwordx4 v32, s[72:75], s25 offen lds
  s_waitcnt vmcnt(31)
  ds_read_b64_tr_b16 a[184:185], v38 offset:28672
  ds_read_b64_tr_b16 a[186:187], v38 offset:28928
  ds_read_b64_tr_b16 a[248:249], v39 offset:28672
  ds_read_b64_tr_b16 a[250:251], v39 offset:28928
  s_waitcnt lgkmcnt(0)
  s_add_u32 s25, s23, 1572864
  s_add_u32 m0, s22, 28672
  s_nop 0
  buffer_load_dwordx4 v32, s[72:75], s25 offen lds
  s_add_u32 s25, s23, 1703936
  s_add_u32 m0, s22, 29696
  s_nop 0
  buffer_load_dwordx4 v32, s[72:75], s25 offen lds
  s_waitcnt vmcnt(31)
  ds_read_b64_tr_b16 a[188:189], v38 offset:30720
  ds_read_b64_tr_b16 a[190:191], v38 offset:30976
  ds_read_b64_tr_b16 a[252:253], v39 offset:30720
  ds_read_b64_tr_b16 a[254:255], v39 offset:30976
  s_waitcnt lgkmcnt(0)
  s_add_u32 s25, s23, 1835008
  s_add_u32 m0, s22, 30720
  s_nop 0
  buffer_load_dwordx4 v32, s[72:75], s25 offen lds
  s_add_u32 s25, s23, 1966080
  s_add_u32 m0, s22, 31744
  s_nop 0
  buffer_load_dwordx4 v32, s[72:75], s25 offen lds
  s_waitcnt vmcnt(31)
  ds_read_b64_tr_b16 a[128:129], v38 offset:0
  ds_read_b64_tr_b16 a[130:131], v38 offset:256
  ds_read_b64_tr_b16 a[192:193], v39 offset:0
  ds_read_b64_tr_b16 a[194:195], v39 offset:256
  s_waitcnt lgkmcnt(0)
  s_add_u32 s25, s23, 2097152
  s_add_u32 m0, s22, 0
  s_nop 0
  buffer_load_dwordx4 v32, s[72:75], s25 offen lds
  s_add_u32 s25, s23, 2228224
  s_add_u32 m0, s22, 1024
  s_nop 0
  buffer_load_dwordx4 v32, s[72:75], s25 offen lds
  s_waitcnt vmcnt(31)
  ds_read_b64_tr_b16 a[132:133], v38 offset:2048
  ds_read_b64_tr_b16 a[134:135], v38 offset:2304
  ds_read_b64_tr_b16 a[196:197], v39 offset:2048
  ds_read_b64_tr_b16 a[198:199], v39 offset:2304
  s_waitcnt lgkmcnt(0)
  s_add_u32 s25, s23, 2359296
  s_add_u32 m0, s22, 2048
  s_nop 0
  buffer_load_dwordx4 v32, s[72:75], s25 offen lds
  s_add_u32 s25, s23, 2490368
  s_add_u32 m0, s22, 3072
  s_nop 0
  buffer_load_dwordx4 v32, s[72:75], s25 offen lds
  s_waitcnt vmcnt(31)
  ds_read_b64_tr_b16 a[136:137], v38 offset:4096
  ds_read_b64_tr_b16 a[138:139], v38 offset:4352
  ds_read_b64_tr_b16 a[200:201], v39 offset:4096
  ds_read_b64_tr_b16 a[202:203], v39 offset:4352
  s_waitcnt lgkmcnt(0)
  s_add_u32 s25, s23, 2621440
  s_add_u32 m0, s22, 4096
  s_nop 0
  buffer_load_dwordx4 v32, s[72:75], s25 offen lds
  s_add_u32 s25, s23, 2752512
  s_add_u32 m0, s22, 5120
  s_nop 0
  buffer_load_dwordx4 v32, s[72:75], s25 offen lds
  s_waitcnt vmcnt(31)
  ds_read_b64_tr_b16 a[140:141], v38 offset:6144
  ds_read_b64_tr_b16 a[142:143], v38 offset:6400
  ds_read_b64_tr_b16 a[204:205], v39 offset:6144
  ds_read_b64_tr_b16 a[206:207], v39 offset:6400
  s_waitcnt lgkmcnt(0)
  s_add_u32 s25, s23, 2883584
  s_add_u32 m0, s22, 6144
  s_nop 0
  buffer_load_dwordx4 v32, s[72:75], s25 offen lds
  s_add_u32 s25, s23, 3014656
  s_add_u32 m0, s22, 7168
  s_nop 0
  buffer_load_dwordx4 v32, s[72:75], s25 offen lds
  s_waitcnt vmcnt(31)
  ds_read_b64_tr_b16 a[144:145], v38 offset:8192
  ds_read_b64_tr_b16 a[146:147], v38 offset:8448
  ds_read_b64_tr_b16 a[208:209], v39 offset:8192
  ds_read_b64_tr_b16 a[210:211], v39 offset:8448
  s_waitcnt lgkmcnt(0)
  s_add_u32 s25, s23, 3145728
  s_add_u32 m0, s22, 8192
  s_nop 0
  buffer_load_dwordx4 v32, s[72:75], s25 offen lds
  s_add_u32 s25, s23, 3276800
  s_add_u32 m0, s22, 9216
  s_nop 0
  buffer_load_dwordx4 v32, s[72:75], s25 offen lds
  s_waitcnt vmcnt(31)
  ds_read_b64_tr_b16 a[148:149], v38 offset:10240
  ds_read_b64_tr_b16 a[150:151], v38 offset:10496
  ds_read_b64_tr_b16 a[212:213], v39 offset:10240
  ds_read_b64_tr_b16 a[214:215], v39 offset:10496
  s_waitcnt lgkmcnt(0)
  s_add_u32 s25, s23, 3407872
  s_add_u32 m0, s22, 10240
  s_nop 0
  buffer_load_dwordx4 v32, s[72:75], s25 offen lds
  s_add_u32 s25, s23, 3538944
  s_add_u32 m0, s22, 11264
  s_nop 0
  buffer_load_dwordx4 v32, s[72:75], s25 offen lds
  s_waitcnt vmcnt(31)
  ds_read_b64_tr_b16 a[152:153], v38 offset:12288
  ds_read_b64_tr_b16 a[154:155], v38 offset:12544
  ds_read_b64_tr_b16 a[216:217], v39 offset:12288
  ds_read_b64_tr_b16 a[218:219], v39 offset:12544
  s_waitcnt lgkmcnt(0)
  s_add_u32 s25, s23, 3670016
  s_add_u32 m0, s22, 12288
  s_nop 0
  buffer_load_dwordx4 v32, s[72:75], s25 offen lds
  s_add_u32 s25, s23, 3801088
  s_add_u32 m0, s22, 13312
  s_nop 0
  buffer_load_dwordx4 v32, s[72:75], s25 offen lds
  s_waitcnt vmcnt(31)
  ds_read_b64_tr_b16 a[156:157], v38 offset:14336
  ds_read_b64_tr_b16 a[158:159], v38 offset:14592
  ds_read_b64_tr_b16 a[220:221], v39 offset:14336
  ds_read_b64_tr_b16 a[222:223], v39 offset:14592
  s_waitcnt lgkmcnt(0)
  s_add_u32 s25, s23, 3932160
  s_add_u32 m0, s22, 14336
  s_nop 0
  buffer_load_dwordx4 v32, s[72:75], s25 offen lds
  s_add_u32 s25, s23, 4063232
  s_add_u32 m0, s22, 15360
  s_nop 0
  buffer_load_dwordx4 v32, s[72:75], s25 offen lds
  s_waitcnt vmcnt(32)
  s_load_dwordx2 s[4:5], s[0:1], 8
  s_waitcnt lgkmcnt(0)
  s_mov_b32 s6, 8192
  s_mov_b32 s7, 0x20000
  v_bfe_u32 v58, v59, 1, 3
  v_lshlrev_b32 v58, 10, v58
  v_lshrrev_b32 v56, 4, v59
  v_lshl_add_u32 v58, v56, 5, v58
  v_and_b32 v56, 1, v59
  v_lshl_add_u32 v58, v56, 2, v58
  s_lshl_b32 s20, s16, 8
  buffer_load_dword v20, v58, s[4:7], s20 offen offset:0
  buffer_load_dword v21, v58, s[4:7], s20 offen offset:8
  buffer_load_dword v22, v58, s[4:7], s20 offen offset:16
  buffer_load_dword v23, v58, s[4:7], s20 offen offset:24
  buffer_load_dword v24, v58, s[4:7], s20 offen offset:128
  buffer_load_dword v25, v58, s[4:7], s20 offen offset:136
  buffer_load_dword v26, v58, s[4:7], s20 offen offset:144
  buffer_load_dword v27, v58, s[4:7], s20 offen offset:152
  v_mov_b32 v57, 132
  buffer_load_dword v57, v57, s[12:15], 0 offen sc1
  s_lshl_b32 s20, s17, 8
  v_lshlrev_b32 v50, 2, v59
  buffer_load_dword v50, v50, s[8:11], s20 offen offset:0 sc1
  s_waitcnt vmcnt(40)
  ds_read_b64_tr_b16 v[160:161], v38 offset:16384
  ds_read_b64_tr_b16 v[162:163], v38 offset:16640
  ds_read_b64_tr_b16 v[52:53], v39 offset:16384
  ds_read_b64_tr_b16 v[54:55], v39 offset:16640
  s_waitcnt vmcnt(38)
  ds_read_b64_tr_b16 v[164:165], v38 offset:18432
  ds_read_b64_tr_b16 v[166:167], v38 offset:18688
  ds_read_b64_tr_b16 v[124:125], v39 offset:18432
  ds_read_b64_tr_b16 v[126:127], v39 offset:18688
  s_waitcnt lgkmcnt(4)
  ds_write_b128 v48, v[52:55] offset:16384
  ds_write_b128 v48, v[92:95] offset:17408
  s_waitcnt vmcnt(36)
  ds_read_b64_tr_b16 v[168:169], v38 offset:20480
  ds_read_b64_tr_b16 v[170:171], v38 offset:20736
  ds_read_b64_tr_b16 v[52:53], v39 offset:20480
  ds_read_b64_tr_b16 v[54:55], v39 offset:20736
  s_waitcnt lgkmcnt(6)
  ds_write_b128 v48, v[124:127] offset:18432
  ds_write_b128 v48, v[96:99] offset:19456
  s_waitcnt vmcnt(34)
  ds_read_b64_tr_b16 v[172:173], v38 offset:22528
  ds_read_b64_tr_b16 v[174:175], v38 offset:22784
  ds_read_b64_tr_b16 v[124:125], v39 offset:22528
  ds_read_b64_tr_b16 v[126:127], v39 offset:22784
  s_waitcnt lgkmcnt(6)
  ds_write_b128 v48, v[52:55] offset:20480
  ds_write_b128 v48, v[100:103] offset:21504
  s_waitcnt vmcnt(32)
  ds_read_b64_tr_b16 v[176:177], v38 offset:24576
  ds_read_b64_tr_b16 v[178:179], v38 offset:24832
  ds_read_b64_tr_b16 v[52:53], v39 offset:24576
  ds_read_b64_tr_b16 v[54:55], v39 offset:24832
  s_waitcnt lgkmcnt(6)
  ds_write_b128 v48, v[124:127] offset:22528
  ds_write_b128 v48, v[104:107] offset:23552
  s_waitcnt vmcnt(30)
  ds_read_b64_tr_b16 v[180:181], v38 offset:26624
  ds_read_b64_tr_b16 v[182:183], v38 offset:26880
  ds_read_b64_tr_b16 v[124:125], v39 offset:26624
  ds_read_b64_tr_b16 v[126:127], v39 offset:26880
  s_waitcnt lgkmcnt(6)
  ds_write_b128 v48, v[52:55] offset:24576
  ds_write_b128 v48, v[108:111] offset:25600
  s_waitcnt vmcnt(28)
  ds_read_b64_tr_b16 v[184:185], v38 offset:28672
  ds_read_b64_tr_b16 v[186:187], v38 offset:28928
  ds_read_b64_tr_b16 v[52:53], v39 offset:28672
  ds_read_b64_tr_b16 v[54:55], v39 offset:28928
  s_waitcnt lgkmcnt(6)
  ds_write_b128 v48, v[124:127] offset:26624
  ds_write_b128 v48, v[112:115] offset:27648
  s_waitcnt vmcnt(26)
  ds_read_b64_tr_b16 v[188:189], v38 offset:30720
  ds_read_b64_tr_b16 v[190:191], v38 offset:30976
  ds_read_b64_tr_b16 v[124:125], v39 offset:30720
  ds_read_b64_tr_b16 v[126:127], v39 offset:30976
  s_waitcnt lgkmcnt(6)
  ds_write_b128 v48, v[52:55] offset:28672
  ds_write_b128 v48, v[116:119] offset:29696
  s_waitcnt vmcnt(24)
  ds_read_b64_tr_b16 v[128:129], v38 offset:0
  ds_read_b64_tr_b16 v[130:131], v38 offset:256
  ds_read_b64_tr_b16 v[52:53], v39 offset:0
  ds_read_b64_tr_b16 v[54:55], v39 offset:256
  s_waitcnt lgkmcnt(6)
  ds_write_b128 v48, v[124:127] offset:30720
  ds_write_b128 v48, v[120:123] offset:31744
  s_waitcnt vmcnt(22)
  ds_read_b64_tr_b16 v[132:133], v38 offset:2048
  ds_read_b64_tr_b16 v[134:135], v38 offset:2304
  ds_read_b64_tr_b16 v[124:125], v39 offset:2048
  ds_read_b64_tr_b16 v[126:127], v39 offset:2304
  s_waitcnt lgkmcnt(6)
  ds_write_b128 v48, v[52:55] offset:0
  ds_write_b128 v48, v[60:63] offset:1024
  s_waitcnt vmcnt(20)
  ds_read_b64_tr_b16 v[136:137], v38 offset:4096
  ds_read_b64_tr_b16 v[138:139], v38 offset:4352
  ds_read_b64_tr_b16 v[52:53], v39 offset:4096
  ds_read_b64_tr_b16 v[54:55], v39 offset:4352
  s_waitcnt lgkmcnt(6)
  ds_write_b128 v48, v[124:127] offset:2048
  ds_write_b128 v48, v[64:67] offset:3072
  s_waitcnt vmcnt(18)
  ds_read_b64_tr_b16 v[140:141], v38 offset:6144
  ds_read_b64_tr_b16 v[142:143], v38 offset:6400
  ds_read_b64_tr_b16 v[124:125], v39 offset:6144
  ds_read_b64_tr_b16 v[126:127], v39 offset:6400
  s_waitcnt lgkmcnt(6)
  ds_write_b128 v48, v[52:55] offset:4096
  ds_write_b128 v48, v[68:71] offset:5120
  s_waitcnt vmcnt(16)
  ds_read_b64_tr_b16 v[144:145], v38 offset:8192
  ds_read_b64_tr_b16 v[146:147], v38 offset:8448
  ds_read_b64_tr_b16 v[52:53], v39 offset:8192
  ds_read_b64_tr_b16 v[54:55], v39 offset:8448
  s_waitcnt lgkmcnt(6)
  ds_write_b128 v48, v[124:127] offset:6144
  ds_write_b128 v48, v[72:75] offset:7168
  s_waitcnt vmcnt(14)
  ds_read_b64_tr_b16 v[148:149], v38 offset:10240
  ds_read_b64_tr_b16 v[150:151], v38 offset:10496
  ds_read_b64_tr_b16 v[124:125], v39 offset:10240
  ds_read_b64_tr_b16 v[126:127], v39 offset:10496
  s_waitcnt lgkmcnt(6)
  ds_write_b128 v48, v[52:55] offset:8192
  ds_write_b128 v48, v[76:79] offset:9216
  s_waitcnt vmcnt(12)
  ds_read_b64_tr_b16 v[152:153], v38 offset:12288
  ds_read_b64_tr_b16 v[154:155], v38 offset:12544
  ds_read_b64_tr_b16 v[52:53], v39 offset:12288
  ds_read_b64_tr_b16 v[54:55], v39 offset:12544
  s_waitcnt lgkmcnt(6)
  ds_write_b128 v48, v[124:127] offset:10240
  ds_write_b128 v48, v[80:83] offset:11264
  s_waitcnt vmcnt(10)
  ds_read_b64_tr_b16 v[156:157], v38 offset:14336
  ds_read_b64_tr_b16 v[158:159], v38 offset:14592
  ds_read_b64_tr_b16 v[124:125], v39 offset:14336
  ds_read_b64_tr_b16 v[126:127], v39 offset:14592
  s_waitcnt lgkmcnt(6)
  ds_write_b128 v48, v[52:55] offset:12288
  ds_write_b128 v48, v[84:87] offset:13312
  s_waitcnt lgkmcnt(2)
  ds_write_b128 v48, v[124:127] offset:14336
  ds_write_b128 v48, v[88:91] offset:15360
  s_waitcnt lgkmcnt(0)
  s_branch L_ld_done
L_ld_3:
  s_load_dwordx2 s[4:5], s[0:1], 16
  s_load_dwordx2 s[68:69], s[0:1], 24
  s_load_dwordx2 s[72:73], s[0:1], 32
  s_load_dwordx2 s[76:77], s[0:1], 40
  s_lshl_b32 s22, s16, 15
  s_add_u32 s22, s22, 32768
  v_lshrrev_b32 v28, 4, v59
  v_and_b32 v29, 1, v28
  v_lshlrev_b32 v29, 1, v29
  v_and_b32 v30, 15, v59
  v_xor_b32 v30, v30, v29
  v_lshlrev_b32 v30, 4, v30
  v_lshl_add_u32 v28, v28, 10, v30
  v_xor_b32 v29, 64, v28
  v_xor_b32 v30, 128, v28
  v_xor_b32 v31, 192, v28
  s_lshl_b32 s26, s17, 17
  s_lshl_b32 s27, s16, 8
  s_add_u32 s26, s26, s27
  v_lshrrev_b32 v32, 2, v59
  v_and_b32 v33, 3, v59
  v_lshrrev_b32 v34, 5, v59
  v_lshlrev_b32 v34, 1, v34
  v_xor_b32 v33, v33, v34
  v_lshlrev_b32 v32, 13, v32
  v_lshl_add_u32 v32, v33, 4, v32
  s_lshl_b32 s23, s17, 8
  s_lshl_b32 s24, s16, 6
  s_add_u32 s23, s23, s24
  s_mov_b32 s24, 0
  s_waitcnt lgkmcnt(0)
  s_mov_b32 s6, 4194304
  s_mov_b32 s7, 0x20000
  s_mov_b32 s70, 4194304
  s_mov_b32 s71, 0x20000
  s_mov_b32 s74, 4194304
  s_mov_b32 s75, 0x20000
  s_mov_b32 s78, 4194304
  s_mov_b32 s79, 0x20000
  s_add_u32 s25, s26, 0
  s_add_u32 m0, s22, 0
  s_nop 0
  buffer_load_dwordx4 v28, s[76:79], s25 offen lds
  s_add_u32 s25, s26, 4096
  s_add_u32 m0, s22, 1024
  s_nop 0
  buffer_load_dwordx4 v29, s[76:79], s25 offen lds
  s_add_u32 s25, s26, 8192
  s_add_u32 m0, s22, 2048
  s_nop 0
  buffer_load_dwordx4 v28, s[76:79], s25 offen lds
  s_add_u32 s25, s26, 12288
  s_add_u32 m0, s22, 3072
  s_nop 0
  buffer_load_dwordx4 v29, s[76:79], s25 offen lds
  s_add_u32 s25, s26, 16384
  s_add_u32 m0, s22, 4096
  s_nop 0
  buffer_load_dwordx4 v30, s[76:79], s25 offen lds
  s_add_u32 s25, s26, 20480
  s_add_u32 m0, s22, 5120
  s_nop 0
  buffer_load_dwordx4 v31, s[76:79], s25 offen lds
  s_add_u32 s25, s26, 24576
  s_add_u32 m0, s22, 6144
  s_nop 0
  buffer_load_dwordx4 v30, s[76:79], s25 offen lds
  s_add_u32 s25, s26, 28672
  s_add_u32 m0, s22, 7168
  s_nop 0
  buffer_load_dwordx4 v31, s[76:79], s25 offen lds
  s_add_u32 s25, s26, 32768
  s_add_u32 m0, s22, 8192
  s_nop 0
  buffer_load_dwordx4 v28, s[76:79], s25 offen lds
  s_add_u32 s25, s26, 36864
  s_add_u32 m0, s22, 9216
  s_nop 0
  buffer_load_dwordx4 v29, s[76:79], s25 offen lds
  s_add_u32 s25, s26, 40960
  s_add_u32 m0, s22, 10240
  s_nop 0
  buffer_load_dwordx4 v28, s[76:79], s25 offen lds
  s_add_u32 s25, s26, 45056
  s_add_u32 m0, s22, 11264
  s_nop 0
  buffer_load_dwordx4 v29, s[76:79], s25 offen lds
  s_add_u32 s25, s26, 49152
  s_add_u32 m0, s22, 12288
  s_nop 0
  buffer_load_dwordx4 v30, s[76:79], s25 offen lds
  s_add_u32 s25, s26, 53248
  s_add_u32 m0, s22, 13312
  s_nop 0
  buffer_load_dwordx4 v31, s[76:79], s25 offen lds
  s_add_u32 s25, s26, 57344
  s_add_u32 m0, s22, 14336
  s_nop 0
  buffer_load_dwordx4 v30, s[76:79], s25 offen lds
  s_add_u32 s25, s26, 61440
  s_add_u32 m0, s22, 15360
  s_nop 0
  buffer_load_dwordx4 v31, s[76:79], s25 offen lds
  s_add_u32 s25, s26, 65536
  s_add_u32 m0, s22, 16384
  s_nop 0
  buffer_load_dwordx4 v28, s[76:79], s25 offen lds
  s_add_u32 s25, s26, 69632
  s_add_u32 m0, s22, 17408
  s_nop 0
  buffer_load_dwordx4 v29, s[76:79], s25 offen lds
  s_add_u32 s25, s26, 73728
  s_add_u32 m0, s22, 18432
  s_nop 0
  buffer_load_dwordx4 v28, s[76:79], s25 offen lds
  s_add_u32 s25, s26, 77824
  s_add_u32 m0, s22, 19456
  s_nop 0
  buffer_load_dwordx4 v29, s[76:79], s25 offen lds
  s_add_u32 s25, s26, 81920
  s_add_u32 m0, s22, 20480
  s_nop 0
  buffer_load_dwordx4 v30, s[76:79], s25 offen lds
  s_add_u32 s25, s26, 86016
  s_add_u32 m0, s22, 21504
  s_nop 0
  buffer_load_dwordx4 v31, s[76:79], s25 offen lds
  s_add_u32 s25, s26, 90112
  s_add_u32 m0, s22, 22528
  s_nop 0
  buffer_load_dwordx4 v30, s[76:79], s25 offen lds
  s_add_u32 s25, s26, 94208
  s_add_u32 m0, s22, 23552
  s_nop 0
  buffer_load_dwordx4 v31, s[76:79], s25 offen lds
  s_add_u32 s25, s26, 98304
  s_add_u32 m0, s22, 24576
  s_nop 0
  buffer_load_dwordx4 v28, s[76:79], s25 offen lds
  s_add_u32 s25, s26, 102400
  s_add_u32 m0, s22, 25600
  s_nop 0
  buffer_load_dwordx4 v29, s[76:79], s25 offen lds
  s_add_u32 s25, s26, 106496
  s_add_u32 m0, s22, 26624
  s_nop 0
  buffer_load_dwordx4 v28, s[76:79], s25 offen lds
  s_add_u32 s25, s26, 110592
  s_add_u32 m0, s22, 27648
  s_nop 0
  buffer_load_dwordx4 v29, s[76:79], s25 offen lds
  s_add_u32 s25, s26, 114688
  s_add_u32 m0, s22, 28672
  s_nop 0
  buffer_load_dwordx4 v30, s[76:79], s25 offen lds
  s_add_u32 s25, s26, 118784
  s_add_u32 m0, s22, 29696
  s_nop 0
  buffer_load_dwordx4 v31, s[76:79], s25 offen lds
  s_add_u32 s25, s26, 122880
  s_add_u32 m0, s22, 30720
  s_nop 0
  buffer_load_dwordx4 v30, s[76:79], s25 offen lds
  s_add_u32 s25, s26, 126976
  s_add_u32 m0, s22, 31744
  s_nop 0
  buffer_load_dwordx4 v31, s[76:79], s25 offen lds
  v_mov_b32 v20, -1
  v_mov_b32 v21, -1
  v_mov_b32 v22, -1
  v_mov_b32 v23, -1
  v_and_b32 v60, 15, v0
  v_lshrrev_b32 v61, 4, v0
  v_lshrrev_b32 v62, 1, v60
  v_mov_b32 v63, 0x3f80
  v_mov_b32 v64, 0x3f800000
  v_mov_b32 v67, 0x3f803f80
  v_mov_b32 v1, 0x4444
  v_mov_b32 v65, 0xeeee
  v_and_b32 v66, 1, v60
  v_cmp_eq_u32 vcc, 0, v66
  s_nop 1
  v_cndmask_b32 v1, v65, v1, vcc
  v_lshlrev_b32 v65, 1, v61
  v_mov_b32 v2, 0
  v_mov_b32 v3, 0
  v_cmp_eq_u32 vcc, v65, v62
  s_nop 1
  v_cndmask_b32 v2, v2, v67, vcc
  v_add_u32 v65, 1, v65
  v_cmp_eq_u32 vcc, v65, v62
  s_nop 1
  v_cndmask_b32 v3, v3, v67, vcc
  v_and_b32 v62, 7, v0
  v_mov_b32 v4, 0
  v_cmp_eq_u32 vcc, 0, v62
  s_nop 1
  v_cndmask_b32 v4, v4, v63, vcc
  v_cmp_eq_u32 vcc, 1, v62
  s_nop 1
  v_cndmask_b32 v4, v4, v64, vcc
  v_mov_b32 v5, 0
  v_cmp_eq_u32 vcc, 2, v62
  s_nop 1
  v_cndmask_b32 v5, v5, v63, vcc
  v_cmp_eq_u32 vcc, 3, v62
  s_nop 1
  v_cndmask_b32 v5, v5, v64, vcc
  v_mov_b32 v6, 0
  v_cmp_eq_u32 vcc, 4, v62
  s_nop 1
  v_cndmask_b32 v6, v6, v63, vcc
  v_cmp_eq_u32 vcc, 5, v62
  s_nop 1
  v_cndmask_b32 v6, v6, v64, vcc
  v_mov_b32 v7, 0
  v_cmp_eq_u32 vcc, 6, v62
  s_nop 1
  v_cndmask_b32 v7, v7, v63, vcc
  v_cmp_eq_u32 vcc, 7, v62
  s_nop 1
  v_cndmask_b32 v7, v7, v64, vcc
  v_bfe_u32 v65, v60, 2, 1
  v_lshlrev_b32 v66, 3, v65
  v_bfe_u32 v65, v60, 1, 1
  v_lshl_add_u32 v66, v65, 2, v66
  v_lshrrev_b32 v65, 3, v60
  v_lshl_add_u32 v66, v65, 1, v66
  v_and_b32 v65, 1, v60
  v_add_u32 v66, v66, v65
  v_lshlrev_b32 v66, 4, v66
  v_lshl_add_u32 v66, v61, 13, v66
  s_lshr_b32 s20, s17, 3
  s_and_b32 s20, s20, 1
  s_lshl_b32 s20, s20, 2
  s_xor_b32 s20, s20, s17
  s_lshl_b32 s20, s20, 8
  v_add_u32 v16, s20, v66
  s_lshr_b32 s20, s17, 2
  s_lshl_b32 s20, s20, 10
  s_and_b32 s21, s17, 3
  s_lshl_b32 s21, s21, 6
  s_add_u32 s20, s20, s21
  v_lshrrev_b32 v65, 1, v62
  v_lshlrev_b32 v66, 8, v65
  v_and_b32 v65, 1, v62
  v_lshl_add_u32 v66, v65, 5, v66
  v_lshrrev_b32 v65, 1, v61
  v_lshl_add_u32 v66, v65, 4, v66
  v_and_b32 v65, 1, v61
  v_lshl_add_u32 v66, v65, 3, v66
  v_add_u32 v17, s20, v66
  v_lshrrev_b32 v65, 1, v61
  v_lshlrev_b32 v66, 8, v65
  v_lshrrev_b32 v65, 1, v60
  v_lshl_add_u32 v66, v65, 5, v66
  v_and_b32 v65, 1, v61
  v_lshl_add_u32 v66, v65, 4, v66
  s_lshl_b32 s20, s16, 9
  v_add_u32 v15, s20, v66
  v_lshlrev_b32 v66, 3, v0
  s_add_u32 s21, s20, 12288
  v_add_u32 v14, s21, v66
  v_and_b32 v65, 1, v0
  v_lshl_add_u32 v19, v65, 10, v66
  v_lshlrev_b32 v0, 4, v0
  s_lshl_b32 s20, s16, 11
  v_add_u32 v8, s20, v0
  s_lshl_b32 s20, s16, 10
  v_add_u32 v13, s20, v0
  s_lshl_b32 s20, s16, 15
  s_add_u32 s20, s20, 32768
  v_add_u32 v12, s20, v0
  s_add_u32 s20, s16, 1
  s_and_b32 s20, s20, 3
  s_lshl_b32 s20, s20, 11
  v_add_u32 v9, s20, v0
  s_add_u32 s20, s16, 2
  s_and_b32 s20, s20, 3
  s_lshl_b32 s20, s20, 11
  v_add_u32 v10, s20, v0
  s_add_u32 s20, s16, 3
  s_and_b32 s20, s20, 3
  s_lshl_b32 s20, s20, 11
  v_add_u32 v11, s20, v0
  s_mov_b32 s38, 0x00ff00ff
  s_mov_b32 s39, 0x00ff00ff
  s_mov_b32 s50, 0x55555555
  s_mov_b32 s51, 0x55555555
  s_mov_b32 s48, 0x3e0293ee
  s_cmp_eq_u32 s16, 1
  s_cselect_b32 s66, 3, 2
  s_cselect_b32 s67, 4096, 0
  s_mov_b32 s58, 0x3e0293ee
  s_mov_b32 s59, 0x3e0293ee
  s_lshl_b32 s49, s17, 7
  s_add_u32 s49, s49, 8192
  s_cmp_eq_u32 s16, 0
  s_cselect_b64 s[52:53], s[38:39], 0
  s_cmp_eq_u32 s16, 3
  s_cselect_b64 s[54:55], 1, 0
  s_lshl_b32 s21, s17, 13
  s_lshl_b32 s22, s16, 11
  s_add_u32 s21, s21, s22
  s_add_u32 s25, s21, 1048576
  s_and_b32 s22, s16, 1
  s_lshl_b32 s22, s22, 10
  s_add_u32 s56, s25, s22
  s_xor_b32 s22, s22, 1024
  s_add_u32 s57, s25, s22
  s_mov_b32 s40, 1048576
  s_mov_b32 s41, 1081344
  s_mov_b32 s42, 1114112
  s_mov_b32 s43, 1146880
  s_mov_b32 s44, 1179648
  s_mov_b32 s45, 1212416
  s_mov_b32 s46, 1245184
  s_mov_b32 s47, 1277952
  buffer_store_dwordx4 v[20:23], v0, s[8:11], s25 offen
  buffer_store_dwordx4 v[20:23], v0, s[8:11], s25 offen offset:1024
  s_mov_b64 exec, s[38:39]
  s_mov_b32 s20, 1835008
  buffer_store_dwordx2 v[20:21], v17, s[8:11], s20 offen
  s_mov_b32 s20, 1843200
  buffer_store_dwordx2 v[20:21], v17, s[8:11], s20 offen
  s_mov_b32 s20, 1851392
  buffer_store_dwordx2 v[20:21], v17, s[8:11], s20 offen
  s_mov_b64 exec, -1
  s_lshl_b32 s22, s16, 15
  s_add_u32 s22, s22, 32768
  v_lshrrev_b32 v33, 4, v59
  v_bfe_u32 v34, v59, 2, 2
  v_and_b32 v35, 1, v33
  v_lshlrev_b32 v36, 4, v35
  v_lshrrev_b32 v37, 1, v33
  v_lshl_add_u32 v36, v37, 3, v36
  v_lshrrev_b32 v37, 1, v34
  v_lshl_add_u32 v36, v37, 2, v36
  v_and_b32 v37, 1, v34
  v_add_u32 v36, v36, v37
  v_lshlrev_b32 v36, 8, v36
  v_lshl_add_u32 v37, v35, 2, v34
  v_lshl_add_u32 v36, v37, 5, v36
  v_and_b32 v37, 3, v59
  v_lshl_add_u32 v36, v37, 3, v36
  v_add_u32 v36, s22, v36
  v_xor_b32 v40, 0, v36
  v_xor_b32 v41, 32, v36
  v_xor_b32 v42, 64, v36
  v_xor_b32 v43, 96, v36
  v_xor_b32 v44, 128, v36
  v_xor_b32 v45, 160, v36
  v_xor_b32 v46, 192, v36
  v_xor_b32 v47, 224, v36
  v_bfe_u32 v34, v59, 2, 2
  v_lshl_add_u32 v34, v33, 3, v34
  v_lshlrev_b32 v34, 6, v34
  v_and_b32 v35, 1, v59
  v_lshl_add_u32 v34, v35, 3, v34
  v_bfe_u32 v35, v59, 1, 1
  v_and_b32 v33, 1, v33
  v_lshlrev_b32 v33, 1, v33
  v_xor_b32 v35, v35, v33
  v_lshl_add_u32 v38, v35, 4, v34
  v_xor_b32 v35, 2, v35
  v_lshl_add_u32 v39, v35, 4, v34
  v_add_u32 v38, s22, v38
  v_add_u32 v39, s22, v39
  v_lshlrev_b32 v48, 4, v59
  v_add_u32 v48, s22, v48
  s_waitcnt vmcnt(29)
  ds_read_b64_tr_b16 v[192:193], v40 offset:0
  ds_read_b64_tr_b16 v[194:195], v40 offset:512
  ds_read_b64_tr_b16 v[208:209], v41 offset:0
  ds_read_b64_tr_b16 v[210:211], v41 offset:512
  ds_read_b64_tr_b16 v[224:225], v42 offset:0
  ds_read_b64_tr_b16 v[226:227], v42 offset:512
  ds_read_b64_tr_b16 v[240:241], v43 offset:0
  ds_read_b64_tr_b16 v[242:243], v43 offset:512
  s_waitcnt lgkmcnt(4)
  ds_read_b64_tr_b16 v[60:61], v44 offset:0
  ds_read_b64_tr_b16 v[62:63], v44 offset:512
  ds_read_b64_tr_b16 v[76:77], v45 offset:0
  ds_read_b64_tr_b16 v[78:79], v45 offset:512
  ds_read_b64_tr_b16 v[92:93], v46 offset:0
  ds_read_b64_tr_b16 v[94:95], v46 offset:512
  ds_read_b64_tr_b16 v[108:109], v47 offset:0
  ds_read_b64_tr_b16 v[110:111], v47 offset:512
  s_waitcnt lgkmcnt(0)
  s_waitcnt vmcnt(21)
  ds_read_b64_tr_b16 v[196:197], v40 offset:8192
  ds_read_b64_tr_b16 v[198:199], v40 offset:8704
  ds_read_b64_tr_b16 v[212:213], v41 offset:8192
  ds_read_b64_tr_b16 v[214:215], v41 offset:8704
  ds_read_b64_tr_b16 v[228:229], v42 offset:8192
  ds_read_b64_tr_b16 v[230:231], v42 offset:8704
  ds_read_b64_tr_b16 v[244:245], v43 offset:8192
  ds_read_b64_tr_b16 v[246:247], v43 offset:8704
  s_waitcnt lgkmcnt(4)
  ds_read_b64_tr_b16 v[64:65], v44 offset:8192
  ds_read_b64_tr_b16 v[66:67], v44 offset:8704
  ds_read_b64_tr_b16 v[80:81], v45 offset:8192
  ds_read_b64_tr_b16 v[82:83], v45 offset:8704
  ds_read_b64_tr_b16 v[96:97], v46 offset:8192
  ds_read_b64_tr_b16 v[98:99], v46 offset:8704
  ds_read_b64_tr_b16 v[112:113], v47 offset:8192
  ds_read_b64_tr_b16 v[114:115], v47 offset:8704
  s_waitcnt lgkmcnt(0)
  s_add_u32 s25, s23, 0
  s_add_u32 m0, s22, 8192
  s_nop 0
  buffer_load_dwordx4 v32, s[4:7], s25 offen lds
  s_add_u32 s25, s23, 131072
  s_add_u32 m0, s22, 9216
  s_nop 0
  buffer_load_dwordx4 v32, s[4:7], s25 offen lds
  s_add_u32 s25, s23, 262144
  s_add_u32 m0, s22, 10240
  s_nop 0
  buffer_load_dwordx4 v32, s[4:7], s25 offen lds
  s_add_u32 s25, s23, 393216
  s_add_u32 m0, s22, 11264
  s_nop 0
  buffer_load_dwordx4 v32, s[4:7], s25 offen lds
  s_add_u32 s25, s23, 524288
  s_add_u32 m0, s22, 12288
  s_nop 0
  buffer_load_dwordx4 v32, s[4:7], s25 offen lds
  s_add_u32 s25, s23, 655360
  s_add_u32 m0, s22, 13312
  s_nop 0
  buffer_load_dwordx4 v32, s[4:7], s25 offen lds
  s_add_u32 s25, s23, 786432
  s_add_u32 m0, s22, 14336
  s_nop 0
  buffer_load_dwordx4 v32, s[4:7], s25 offen lds
  s_add_u32 s25, s23, 917504
  s_add_u32 m0, s22, 15360
  s_nop 0
  buffer_load_dwordx4 v32, s[4:7], s25 offen lds
  s_waitcnt vmcnt(21)
  ds_read_b64_tr_b16 v[200:201], v40 offset:16384
  ds_read_b64_tr_b16 v[202:203], v40 offset:16896
  ds_read_b64_tr_b16 v[216:217], v41 offset:16384
  ds_read_b64_tr_b16 v[218:219], v41 offset:16896
  ds_read_b64_tr_b16 v[232:233], v42 offset:16384
  ds_read_b64_tr_b16 v[234:235], v42 offset:16896
  ds_read_b64_tr_b16 v[248:249], v43 offset:16384
  ds_read_b64_tr_b16 v[250:251], v43 offset:16896
  s_waitcnt lgkmcnt(4)
  ds_read_b64_tr_b16 v[68:69], v44 offset:16384
  ds_read_b64_tr_b16 v[70:71], v44 offset:16896
  ds_read_b64_tr_b16 v[84:85], v45 offset:16384
  ds_read_b64_tr_b16 v[86:87], v45 offset:16896
  ds_read_b64_tr_b16 v[100:101], v46 offset:16384
  ds_read_b64_tr_b16 v[102:103], v46 offset:16896
  ds_read_b64_tr_b16 v[116:117], v47 offset:16384
  ds_read_b64_tr_b16 v[118:119], v47 offset:16896
  s_waitcnt lgkmcnt(0)
  s_add_u32 s25, s23, 1048576
  s_add_u32 m0, s22, 16384
  s_nop 0
  buffer_load_dwordx4 v32, s[4:7], s25 offen lds
  s_add_u32 s25, s23, 1179648
  s_add_u32 m0, s22, 17408
  s_nop 0
  buffer_load_dwordx4 v32, s[4:7], s25 offen lds
  s_add_u32 s25, s23, 1310720
  s_add_u32 m0, s22, 18432
  s_nop 0
  buffer_load_dwordx4 v32, s[4:7], s25 offen lds
  s_add_u32 s25, s23, 1441792
  s_add_u32 m0, s22, 19456
  s_nop 0
  buffer_load_dwordx4 v32, s[4:7], s25 offen lds
  s_add_u32 s25, s23, 1572864
  s_add_u32 m0, s22, 20480
  s_nop 0
  buffer_load_dwordx4 v32, s[4:7], s25 offen lds
  s_add_u32 s25, s23, 1703936
  s_add_u32 m0, s22, 21504
  s_nop 0
  buffer_load_dwordx4 v32, s[4:7], s25 offen lds
  s_add_u32 s25, s23, 1835008
  s_add_u32 m0, s22, 22528
  s_nop 0
  buffer_load_dwordx4 v32, s[4:7], s25 offen lds
  s_add_u32 s25, s23, 1966080
  s_add_u32 m0, s22, 23552
  s_nop 0
  buffer_load_dwordx4 v32, s[4:7], s25 offen lds
  s_waitcnt vmcnt(21)
  ds_read_b64_tr_b16 v[204:205], v40 offset:24576
  ds_read_b64_tr_b16 v[206:207], v40 offset:25088
  ds_read_b64_tr_b16 v[220:221], v41 offset:24576
  ds_read_b64_tr_b16 v[222:223], v41 offset:25088
  ds_read_b64_tr_b16 v[236:237], v42 offset:24576
  ds_read_b64_tr_b16 v[238:239], v42 offset:25088
  ds_read_b64_tr_b16 v[252:253], v43 offset:24576
  ds_read_b64_tr_b16 v[254:255], v43 offset:25088
  s_waitcnt lgkmcnt(4)
  ds_read_b64_tr_b16 v[72:73], v44 offset:24576
  ds_read_b64_tr_b16 v[74:75], v44 offset:25088
  ds_read_b64_tr_b16 v[88:89], v45 offset:24576
  ds_read_b64_tr_b16 v[90:91], v45 offset:25088
  ds_read_b64_tr_b16 v[104:105], v46 offset:24576
  ds_read_b64_tr_b16 v[106:107], v46 offset:25088
  ds_read_b64_tr_b16 v[120:121], v47 offset:24576
  ds_read_b64_tr_b16 v[122:123], v47 offset:25088
  s_waitcnt lgkmcnt(0)
  s_add_u32 s25, s23, 2097152
  s_add_u32 m0, s22, 24576
  s_nop 0
  buffer_load_dwordx4 v32, s[4:7], s25 offen lds
  s_add_u32 s25, s23, 2228224
  s_add_u32 m0, s22, 25600
  s_nop 0
  buffer_load_dwordx4 v32, s[4:7], s25 offen lds
  s_add_u32 s25, s23, 2359296
  s_add_u32 m0, s22, 26624
  s_nop 0
  buffer_load_dwordx4 v32, s[4:7], s25 offen lds
  s_add_u32 s25, s23, 2490368
  s_add_u32 m0, s22, 27648
  s_nop 0
  buffer_load_dwordx4 v32, s[4:7], s25 offen lds
  s_add_u32 s25, s23, 2621440
  s_add_u32 m0, s22, 28672
  s_nop 0
  buffer_load_dwordx4 v32, s[4:7], s25 offen lds
  s_add_u32 s25, s23, 2752512
  s_add_u32 m0, s22, 29696
  s_nop 0
  buffer_load_dwordx4 v32, s[4:7], s25 offen lds
  s_add_u32 s25, s23, 2883584
  s_add_u32 m0, s22, 30720
  s_nop 0
  buffer_load_dwordx4 v32, s[4:7], s25 offen lds
  s_add_u32 s25, s23, 3014656
  s_add_u32 m0, s22, 31744
  s_nop 0
  buffer_load_dwordx4 v32, s[4:7], s25 offen lds
  s_add_u32 s25, s23, 3145728
  s_add_u32 m0, s22, 0
  s_nop 0
  buffer_load_dwordx4 v32, s[4:7], s25 offen lds
  s_add_u32 s25, s23, 3276800
  s_add_u32 m0, s22, 1024
  s_nop 0
  buffer_load_dwordx4 v32, s[4:7], s25 offen lds
  s_add_u32 s25, s23, 3407872
  s_add_u32 m0, s22, 2048
  s_nop 0
  buffer_load_dwordx4 v32, s[4:7], s25 offen lds
  s_add_u32 s25, s23, 3538944
  s_add_u32 m0, s22, 3072
  s_nop 0
  buffer_load_dwordx4 v32, s[4:7], s25 offen lds
  s_add_u32 s25, s23, 3670016
  s_add_u32 m0, s22, 4096
  s_nop 0
  buffer_load_dwordx4 v32, s[4:7], s25 offen lds
  s_add_u32 s25, s23, 3801088
  s_add_u32 m0, s22, 5120
  s_nop 0
  buffer_load_dwordx4 v32, s[4:7], s25 offen lds
  s_add_u32 s25, s23, 3932160
  s_add_u32 m0, s22, 6144
  s_nop 0
  buffer_load_dwordx4 v32, s[4:7], s25 offen lds
  s_add_u32 s25, s23, 4063232
  s_add_u32 m0, s22, 7168
  s_nop 0
  buffer_load_dwordx4 v32, s[4:7], s25 offen lds
  s_waitcnt vmcnt(30)
  s_barrier
  v_mov_b32 v56, 132
  v_mov_b32 v57, 1
  s_cmp_eq_u32 s16, 0
  s_cselect_b64 exec, 1, 0
  buffer_atomic_add v57, v56, s[12:15], 0 offen
  s_mov_b64 exec, -1
  ds_read_b64_tr_b16 a[16:17], v38 offset:8192
  ds_read_b64_tr_b16 a[18:19], v38 offset:8448
  ds_read_b64_tr_b16 a[80:81], v39 offset:8192
  ds_read_b64_tr_b16 a[82:83], v39 offset:8448
  s_waitcnt lgkmcnt(0)
  s_add_u32 s25, s23, 0
  s_add_u32 m0, s22, 8192
  s_nop 0
  buffer_load_dwordx4 v32, s[68:71], s25 offen lds
  s_add_u32 s25, s23, 131072
  s_add_u32 m0, s22, 9216
  s_nop 0
  buffer_load_dwordx4 v32, s[68:71], s25 offen lds
  s_waitcnt vmcnt(30)
  ds_read_b64_tr_b16 a[20:21], v38 offset:10240
  ds_read_b64_tr_b16 a[22:23], v38 offset:10496
  ds_read_b64_tr_b16 a[84:85], v39 offset:10240
  ds_read_b64_tr_b16 a[86:87], v39 offset:10496
  s_waitcnt lgkmcnt(0)
  s_add_u32 s25, s23, 262144
  s_add_u32 m0, s22, 10240
  s_nop 0
  buffer_load_dwordx4 v32, s[68:71], s25 offen lds
  s_add_u32 s25, s23, 393216
  s_add_u32 m0, s22, 11264
  s_nop 0
  buffer_load_dwordx4 v32, s[68:71], s25 offen lds
  s_waitcnt vmcnt(30)
  ds_read_b64_tr_b16 a[24:25], v38 offset:12288
  ds_read_b64_tr_b16 a[26:27], v38 offset:12544
  ds_read_b64_tr_b16 a[88:89], v39 offset:12288
  ds_read_b64_tr_b16 a[90:91], v39 offset:12544
  s_waitcnt lgkmcnt(0)
  s_add_u32 s25, s23, 524288
  s_add_u32 m0, s22, 12288
  s_nop 0
  buffer_load_dwordx4 v32, s[68:71], s25 offen lds
  s_add_u32 s25, s23, 655360
  s_add_u32 m0, s22, 13312
  s_nop 0
  buffer_load_dwordx4 v32, s[68:71], s25 offen lds
  s_waitcnt vmcnt(30)
  ds_read_b64_tr_b16 a[28:29], v38 offset:14336
  ds_read_b64_tr_b16 a[30:31], v38 offset:14592
  ds_read_b64_tr_b16 a[92:93], v39 offset:14336
  ds_read_b64_tr_b16 a[94:95], v39 offset:14592
  s_waitcnt lgkmcnt(0)
  s_add_u32 s25, s23, 786432
  s_add_u32 m0, s22, 14336
  s_nop 0
  buffer_load_dwordx4 v32, s[68:71], s25 offen lds
  s_add_u32 s25, s23, 917504
  s_add_u32 m0, s22, 15360
  s_nop 0
  buffer_load_dwordx4 v32, s[68:71], s25 offen lds
  s_waitcnt vmcnt(30)
  ds_read_b64_tr_b16 a[32:33], v38 offset:16384
  ds_read_b64_tr_b16 a[34:35], v38 offset:16640
  ds_read_b64_tr_b16 a[96:97], v39 offset:16384
  ds_read_b64_tr_b16 a[98:99], v39 offset:16640
  s_waitcnt lgkmcnt(0)
  s_add_u32 s25, s23, 1048576
  s_add_u32 m0, s22, 16384
  s_nop 0
  buffer_load_dwordx4 v32, s[68:71], s25 offen lds
  s_add_u32 s25, s23, 1179648
  s_add_u32 m0, s22, 17408
  s_nop 0
  buffer_load_dwordx4 v32, s[68:71], s25 offen lds
  s_waitcnt vmcnt(30)
  ds_read_b64_tr_b16 a[36:37], v38 offset:18432
  ds_read_b64_tr_b16 a[38:39], v38 offset:18688
  ds_read_b64_tr_b16 a[100:101], v39 offset:18432
  ds_read_b64_tr_b16 a[102:103], v39 offset:18688
  s_waitcnt lgkmcnt(0)
  s_add_u32 s25, s23, 1310720
  s_add_u32 m0, s22, 18432
  s_nop 0
  buffer_load_dwordx4 v32, s[68:71], s25 offen lds
  s_add_u32 s25, s23, 1441792
  s_add_u32 m0, s22, 19456
  s_nop 0
  buffer_load_dwordx4 v32, s[68:71], s25 offen lds
  s_waitcnt vmcnt(30)
  ds_read_b64_tr_b16 a[40:41], v38 offset:20480
  ds_read_b64_tr_b16 a[42:43], v38 offset:20736
  ds_read_b64_tr_b16 a[104:105], v39 offset:20480
  ds_read_b64_tr_b16 a[106:107], v39 offset:20736
  s_waitcnt lgkmcnt(0)
  s_add_u32 s25, s23, 1572864
  s_add_u32 m0, s22, 20480
  s_nop 0
  buffer_load_dwordx4 v32, s[68:71], s25 offen lds
  s_add_u32 s25, s23, 1703936
  s_add_u32 m0, s22, 21504
  s_nop 0
  buffer_load_dwordx4 v32, s[68:71], s25 offen lds
  s_waitcnt vmcnt(30)
  ds_read_b64_tr_b16 a[44:45], v38 offset:22528
  ds_read_b64_tr_b16 a[46:47], v38 offset:22784
  ds_read_b64_tr_b16 a[108:109], v39 offset:22528
  ds_read_b64_tr_b16 a[110:111], v39 offset:22784
  s_waitcnt lgkmcnt(0)
  s_add_u32 s25, s23, 1835008
  s_add_u32 m0, s22, 22528
  s_nop 0
  buffer_load_dwordx4 v32, s[68:71], s25 offen lds
  s_add_u32 s25, s23, 1966080
  s_add_u32 m0, s22, 23552
  s_nop 0
  buffer_load_dwordx4 v32, s[68:71], s25 offen lds
  s_waitcnt vmcnt(30)
  ds_read_b64_tr_b16 a[48:49], v38 offset:24576
  ds_read_b64_tr_b16 a[50:51], v38 offset:24832
  ds_read_b64_tr_b16 a[112:113], v39 offset:24576
  ds_read_b64_tr_b16 a[114:115], v39 offset:24832
  s_waitcnt lgkmcnt(0)
  s_add_u32 s25, s23, 2097152
  s_add_u32 m0, s22, 24576
  s_nop 0
  buffer_load_dwordx4 v32, s[68:71], s25 offen lds
  s_add_u32 s25, s23, 2228224
  s_add_u32 m0, s22, 25600
  s_nop 0
  buffer_load_dwordx4 v32, s[68:71], s25 offen lds
  s_waitcnt vmcnt(30)
  ds_read_b64_tr_b16 a[52:53], v38 offset:26624
  ds_read_b64_tr_b16 a[54:55], v38 offset:26880
  ds_read_b64_tr_b16 a[116:117], v39 offset:26624
  ds_read_b64_tr_b16 a[118:119], v39 offset:26880
  s_waitcnt lgkmcnt(0)
  s_add_u32 s25, s23, 2359296
  s_add_u32 m0, s22, 26624
  s_nop 0
  buffer_load_dwordx4 v32, s[68:71], s25 offen lds
  s_add_u32 s25, s23, 2490368
  s_add_u32 m0, s22, 27648
  s_nop 0
  buffer_load_dwordx4 v32, s[68:71], s25 offen lds
  s_waitcnt vmcnt(30)
  ds_read_b64_tr_b16 a[56:57], v38 offset:28672
  ds_read_b64_tr_b16 a[58:59], v38 offset:28928
  ds_read_b64_tr_b16 a[120:121], v39 offset:28672
  ds_read_b64_tr_b16 a[122:123], v39 offset:28928
  s_waitcnt lgkmcnt(0)
  s_add_u32 s25, s23, 2621440
  s_add_u32 m0, s22, 28672
  s_nop 0
  buffer_load_dwordx4 v32, s[68:71], s25 offen lds
  s_add_u32 s25, s23, 2752512
  s_add_u32 m0, s22, 29696
  s_nop 0
  buffer_load_dwordx4 v32, s[68:71], s25 offen lds
  s_waitcnt vmcnt(30)
  ds_read_b64_tr_b16 a[60:61], v38 offset:30720
  ds_read_b64_tr_b16 a[62:63], v38 offset:30976
  ds_read_b64_tr_b16 a[124:125], v39 offset:30720
  ds_read_b64_tr_b16 a[126:127], v39 offset:30976
  s_waitcnt lgkmcnt(0)
  s_add_u32 s25, s23, 2883584
  s_add_u32 m0, s22, 30720
  s_nop 0
  buffer_load_dwordx4 v32, s[68:71], s25 offen lds
  s_add_u32 s25, s23, 3014656
  s_add_u32 m0, s22, 31744
  s_nop 0
  buffer_load_dwordx4 v32, s[68:71], s25 offen lds
  s_waitcnt vmcnt(30)
  ds_read_b64_tr_b16 a[0:1], v38 offset:0
  ds_read_b64_tr_b16 a[2:3], v38 offset:256
  ds_read_b64_tr_b16 a[64:65], v39 offset:0
  ds_read_b64_tr_b16 a[66:67], v39 offset:256
  s_waitcnt lgkmcnt(0)
  s_add_u32 s25, s23, 3145728
  s_add_u32 m0, s22, 0
  s_nop 0
  buffer_load_dwordx4 v32, s[68:71], s25 offen lds
  s_add_u32 s25, s23, 3276800
  s_add_u32 m0, s22, 1024
  s_nop 0
  buffer_load_dwordx4 v32, s[68:71], s25 offen lds
  s_waitcnt vmcnt(30)
  ds_read_b64_tr_b16 a[4:5], v38 offset:2048
  ds_read_b64_tr_b16 a[6:7], v38 offset:2304
  ds_read_b64_tr_b16 a[68:69], v39 offset:2048
  ds_read_b64_tr_b16 a[70:71], v39 offset:2304
  s_waitcnt lgkmcnt(0)
  s_add_u32 s25, s23, 3407872
  s_add_u32 m0, s22, 2048
  s_nop 0
  buffer_load_dwordx4 v32, s[68:71], s25 offen lds
  s_add_u32 s25, s23, 3538944
  s_add_u32 m0, s22, 3072
  s_nop 0
  buffer_load_dwordx4 v32, s[68:71], s25 offen lds
  s_waitcnt vmcnt(30)
  ds_read_b64_tr_b16 a[8:9], v38 offset:4096
  ds_read_b64_tr_b16 a[10:11], v38 offset:4352
  ds_read_b64_tr_b16 a[72:73], v39 offset:4096
  ds_read_b64_tr_b16 a[74:75], v39 offset:4352
  s_waitcnt lgkmcnt(0)
  s_add_u32 s25, s23, 3670016
  s_add_u32 m0, s22, 4096
  s_nop 0
  buffer_load_dwordx4 v32, s[68:71], s25 offen lds
  s_add_u32 s25, s23, 3801088
  s_add_u32 m0, s22, 5120
  s_nop 0
  buffer_load_dwordx4 v32, s[68:71], s25 offen lds
  s_waitcnt vmcnt(30)
  ds_read_b64_tr_b16 a[12:13], v38 offset:6144
  ds_read_b64_tr_b16 a[14:15], v38 offset:6400
  ds_read_b64_tr_b16 a[76:77], v39 offset:6144
  ds_read_b64_tr_b16 a[78:79], v39 offset:6400
  s_waitcnt lgkmcnt(0)
  s_add_u32 s25, s23, 3932160
  s_add_u32 m0, s22, 6144
  s_nop 0
  buffer_load_dwordx4 v32, s[68:71], s25 offen lds
  s_add_u32 s25, s23, 4063232
  s_add_u32 m0, s22, 7168
  s_nop 0
  buffer_load_dwordx4 v32, s[68:71], s25 offen lds
  v_mov_b32 v51, 64
  buffer_load_dword v51, v51, s[12:15], 0 offen sc1
  s_waitcnt vmcnt(31)
  ds_read_b64_tr_b16 a[144:145], v38 offset:8192
  ds_read_b64_tr_b16 a[146:147], v38 offset:8448
  ds_read_b64_tr_b16 a[208:209], v39 offset:8192
  ds_read_b64_tr_b16 a[210:211], v39 offset:8448
  s_waitcnt lgkmcnt(0)
  s_add_u32 s25, s23, 0
  s_add_u32 m0, s22, 8192
  s_nop 0
  buffer_load_dwordx4 v32, s[72:75], s25 offen lds
  s_add_u32 s25, s23, 131072
  s_add_u32 m0, s22, 9216
  s_nop 0
  buffer_load_dwordx4 v32, s[72:75], s25 offen lds
  s_waitcnt vmcnt(31)
  ds_read_b64_tr_b16 a[148:149], v38 offset:10240
  ds_read_b64_tr_b16 a[150:151], v38 offset:10496
  ds_read_b64_tr_b16 a[212:213], v39 offset:10240
  ds_read_b64_tr_b16 a[214:215], v39 offset:10496
  s_waitcnt lgkmcnt(0)
  s_add_u32 s25, s23, 262144
  s_add_u32 m0, s22, 10240
  s_nop 0
  buffer_load_dwordx4 v32, s[72:75], s25 offen lds
  s_add_u32 s25, s23, 393216
  s_add_u32 m0, s22, 11264
  s_nop 0
  buffer_load_dwordx4 v32, s[72:75], s25 offen lds
  s_waitcnt vmcnt(31)
  ds_read_b64_tr_b16 a[152:153], v38 offset:12288
  ds_read_b64_tr_b16 a[154:155], v38 offset:12544
  ds_read_b64_tr_b16 a[216:217], v39 offset:12288
  ds_read_b64_tr_b16 a[218:219], v39 offset:12544
  s_waitcnt lgkmcnt(0)
  s_add_u32 s25, s23, 524288
  s_add_u32 m0, s22, 12288
  s_nop 0
  buffer_load_dwordx4 v32, s[72:75], s25 offen lds
  s_add_u32 s25, s23, 655360
  s_add_u32 m0, s22, 13312
  s_nop 0
  buffer_load_dwordx4 v32, s[72:75], s25 offen lds
  s_waitcnt vmcnt(31)
  ds_read_b64_tr_b16 a[156:157], v38 offset:14336
  ds_read_b64_tr_b16 a[158:159], v38 offset:14592
  ds_read_b64_tr_b16 a[220:221], v39 offset:14336
  ds_read_b64_tr_b16 a[222:223], v39 offset:14592
  s_waitcnt lgkmcnt(0)
  s_add_u32 s25, s23, 786432
  s_add_u32 m0, s22, 14336
  s_nop 0
  buffer_load_dwordx4 v32, s[72:75], s25 offen lds
  s_add_u32 s25, s23, 917504
  s_add_u32 m0, s22, 15360
  s_nop 0
  buffer_load_dwordx4 v32, s[72:75], s25 offen lds
  s_waitcnt vmcnt(31)
  ds_read_b64_tr_b16 a[160:161], v38 offset:16384
  ds_read_b64_tr_b16 a[162:163], v38 offset:16640
  ds_read_b64_tr_b16 a[224:225], v39 offset:16384
  ds_read_b64_tr_b16 a[226:227], v39 offset:16640
  s_waitcnt lgkmcnt(0)
  s_add_u32 s25, s23, 1048576
  s_add_u32 m0, s22, 16384
  s_nop 0
  buffer_load_dwordx4 v32, s[72:75], s25 offen lds
  s_add_u32 s25, s23, 1179648
  s_add_u32 m0, s22, 17408
  s_nop 0
  buffer_load_dwordx4 v32, s[72:75], s25 offen lds
  s_waitcnt vmcnt(31)
  ds_read_b64_tr_b16 a[164:165], v38 offset:18432
  ds_read_b64_tr_b16 a[166:167], v38 offset:18688
  ds_read_b64_tr_b16 a[228:229], v39 offset:18432
  ds_read_b64_tr_b16 a[230:231], v39 offset:18688
  s_waitcnt lgkmcnt(0)
  s_add_u32 s25, s23, 1310720
  s_add_u32 m0, s22, 18432
  s_nop 0
  buffer_load_dwordx4 v32, s[72:75], s25 offen lds
  s_add_u32 s25, s23, 1441792
  s_add_u32 m0, s22, 19456
  s_nop 0
  buffer_load_dwordx4 v32, s[72:75], s25 offen lds
  s_waitcnt vmcnt(31)
  ds_read_b64_tr_b16 a[168:169], v38 offset:20480
  ds_read_b64_tr_b16 a[170:171], v38 offset:20736
  ds_read_b64_tr_b16 a[232:233], v39 offset:20480
  ds_read_b64_tr_b16 a[234:235], v39 offset:20736
  s_waitcnt lgkmcnt(0)
  s_add_u32 s25, s23, 1572864
  s_add_u32 m0, s22, 20480
  s_nop 0
  buffer_load_dwordx4 v32, s[72:75], s25 offen lds
  s_add_u32 s25, s23, 1703936
  s_add_u32 m0, s22, 21504
  s_nop 0
  buffer_load_dwordx4 v32, s[72:75], s25 offen lds
  s_waitcnt vmcnt(31)
  ds_read_b64_tr_b16 a[172:173], v38 offset:22528
  ds_read_b64_tr_b16 a[174:175], v38 offset:22784
  ds_read_b64_tr_b16 a[236:237], v39 offset:22528
  ds_read_b64_tr_b16 a[238:239], v39 offset:22784
  s_waitcnt lgkmcnt(0)
  s_add_u32 s25, s23, 1835008
  s_add_u32 m0, s22, 22528
  s_nop 0
  buffer_load_dwordx4 v32, s[72:75], s25 offen lds
  s_add_u32 s25, s23, 1966080
  s_add_u32 m0, s22, 23552
  s_nop 0
  buffer_load_dwordx4 v32, s[72:75], s25 offen lds
  s_waitcnt vmcnt(31)
  ds_read_b64_tr_b16 a[176:177], v38 offset:24576
  ds_read_b64_tr_b16 a[178:179], v38 offset:24832
  ds_read_b64_tr_b16 a[240:241], v39 offset:24576
  ds_read_b64_tr_b16 a[242:243], v39 offset:24832
  s_waitcnt lgkmcnt(0)
  s_add_u32 s25, s23, 2097152
  s_add_u32 m0, s22, 24576
  s_nop 0
  buffer_load_dwordx4 v32, s[72:75], s25 offen lds
  s_add_u32 s25, s23, 2228224
  s_add_u32 m0, s22, 25600
  s_nop 0
  buffer_load_dwordx4 v32, s[72:75], s25 offen lds
  s_waitcnt vmcnt(31)
  ds_read_b64_tr_b16 a[180:181], v38 offset:26624
  ds_read_b64_tr_b16 a[182:183], v38 offset:26880
  ds_read_b64_tr_b16 a[244:245], v39 offset:26624
  ds_read_b64_tr_b16 a[246:247], v39 offset:26880
  s_waitcnt lgkmcnt(0)
  s_add_u32 s25, s23, 2359296
  s_add_u32 m0, s22, 26624
  s_nop 0
  buffer_load_dwordx4 v32, s[72:75], s25 offen lds
  s_add_u32 s25, s23, 2490368
  s_add_u32 m0, s22, 27648
  s_nop 0
  buffer_load_dwordx4 v32, s[72:75], s25 offen lds
  s_waitcnt vmcnt(31)
  ds_read_b64_tr_b16 a[184:185], v38 offset:28672
  ds_read_b64_tr_b16 a[186:187], v38 offset:28928
  ds_read_b64_tr_b16 a[248:249], v39 offset:28672
  ds_read_b64_tr_b16 a[250:251], v39 offset:28928
  s_waitcnt lgkmcnt(0)
  s_add_u32 s25, s23, 2621440
  s_add_u32 m0, s22, 28672
  s_nop 0
  buffer_load_dwordx4 v32, s[72:75], s25 offen lds
  s_add_u32 s25, s23, 2752512
  s_add_u32 m0, s22, 29696
  s_nop 0
  buffer_load_dwordx4 v32, s[72:75], s25 offen lds
  s_waitcnt vmcnt(31)
  ds_read_b64_tr_b16 a[188:189], v38 offset:30720
  ds_read_b64_tr_b16 a[190:191], v38 offset:30976
  ds_read_b64_tr_b16 a[252:253], v39 offset:30720
  ds_read_b64_tr_b16 a[254:255], v39 offset:30976
  s_waitcnt lgkmcnt(0)
  s_add_u32 s25, s23, 2883584
  s_add_u32 m0, s22, 30720
  s_nop 0
  buffer_load_dwordx4 v32, s[72:75], s25 offen lds
  s_add_u32 s25, s23, 3014656
  s_add_u32 m0, s22, 31744
  s_nop 0
  buffer_load_dwordx4 v32, s[72:75], s25 offen lds
  s_waitcnt vmcnt(31)
  ds_read_b64_tr_b16 a[128:129], v38 offset:0
  ds_read_b64_tr_b16 a[130:131], v38 offset:256
  ds_read_b64_tr_b16 a[192:193], v39 offset:0
  ds_read_b64_tr_b16 a[194:195], v39 offset:256
  s_waitcnt lgkmcnt(0)
  s_add_u32 s25, s23, 3145728
  s_add_u32 m0, s22, 0
  s_nop 0
  buffer_load_dwordx4 v32, s[72:75], s25 offen lds
  s_add_u32 s25, s23, 3276800
  s_add_u32 m0, s22, 1024
  s_nop 0
  buffer_load_dwordx4 v32, s[72:75], s25 offen lds
  s_waitcnt vmcnt(31)
  ds_read_b64_tr_b16 a[132:133], v38 offset:2048
  ds_read_b64_tr_b16 a[134:135], v38 offset:2304
  ds_read_b64_tr_b16 a[196:197], v39 offset:2048
  ds_read_b64_tr_b16 a[198:199], v39 offset:2304
  s_waitcnt lgkmcnt(0)
  s_add_u32 s25, s23, 3407872
  s_add_u32 m0, s22, 2048
  s_nop 0
  buffer_load_dwordx4 v32, s[72:75], s25 offen lds
  s_add_u32 s25, s23, 3538944
  s_add_u32 m0, s22, 3072
  s_nop 0
  buffer_load_dwordx4 v32, s[72:75], s25 offen lds
  s_waitcnt vmcnt(31)
  ds_read_b64_tr_b16 a[136:137], v38 offset:4096
  ds_read_b64_tr_b16 a[138:139], v38 offset:4352
  ds_read_b64_tr_b16 a[200:201], v39 offset:4096
  ds_read_b64_tr_b16 a[202:203], v39 offset:4352
  s_waitcnt lgkmcnt(0)
  s_add_u32 s25, s23, 3670016
  s_add_u32 m0, s22, 4096
  s_nop 0
  buffer_load_dwordx4 v32, s[72:75], s25 offen lds
  s_add_u32 s25, s23, 3801088
  s_add_u32 m0, s22, 5120
  s_nop 0
  buffer_load_dwordx4 v32, s[72:75], s25 offen lds
  s_waitcnt vmcnt(31)
  ds_read_b64_tr_b16 a[140:141], v38 offset:6144
  ds_read_b64_tr_b16 a[142:143], v38 offset:6400
  ds_read_b64_tr_b16 a[204:205], v39 offset:6144
  ds_read_b64_tr_b16 a[206:207], v39 offset:6400
  s_waitcnt lgkmcnt(0)
  s_add_u32 s25, s23, 3932160
  s_add_u32 m0, s22, 6144
  s_nop 0
  buffer_load_dwordx4 v32, s[72:75], s25 offen lds
  s_add_u32 s25, s23, 4063232
  s_add_u32 m0, s22, 7168
  s_nop 0
  buffer_load_dwordx4 v32, s[72:75], s25 offen lds
  s_waitcnt vmcnt(32)
  s_load_dwordx2 s[4:5], s[0:1], 8
  s_waitcnt lgkmcnt(0)
  s_mov_b32 s6, 8192
  s_mov_b32 s7, 0x20000
  v_bfe_u32 v58, v59, 1, 3
  v_lshlrev_b32 v58, 10, v58
  v_lshrrev_b32 v56, 4, v59
  v_lshl_add_u32 v58, v56, 5, v58
  v_and_b32 v56, 1, v59
  v_lshl_add_u32 v58, v56, 2, v58
  s_lshl_b32 s20, s16, 8
  buffer_load_dword v20, v58, s[4:7], s20 offen offset:0
  buffer_load_dword v21, v58, s[4:7], s20 offen offset:8
  buffer_load_dword v22, v58, s[4:7], s20 offen offset:16
  buffer_load_dword v23, v58, s[4:7], s20 offen offset:24
  buffer_load_dword v24, v58, s[4:7], s20 offen offset:128
  buffer_load_dword v25, v58, s[4:7], s20 offen offset:136
  buffer_load_dword v26, v58, s[4:7], s20 offen offset:144
  buffer_load_dword v27, v58, s[4:7], s20 offen offset:152
  v_mov_b32 v57, 132
  buffer_load_dword v57, v57, s[12:15], 0 offen sc1
  s_lshl_b32 s20, s17, 8
  v_lshlrev_b32 v50, 2, v59
  buffer_load_dword v50, v50, s[8:11], s20 offen offset:0 sc1
  s_waitcnt vmcnt(40)
  ds_read_b64_tr_b16 v[144:145], v38 offset:8192
  ds_read_b64_tr_b16 v[146:147], v38 offset:8448
  ds_read_b64_tr_b16 v[52:53], v39 offset:8192
  ds_read_b64_tr_b16 v[54:55], v39 offset:8448
  s_waitcnt vmcnt(38)
  ds_read_b64_tr_b16 v[148:149], v38 offset:10240
  ds_read_b64_tr_b16 v[150:151], v38 offset:10496
  ds_read_b64_tr_b16 v[124:125], v39 offset:10240
  ds_read_b64_tr_b16 v[126:127], v39 offset:10496
  s_waitcnt lgkmcnt(4)
  ds_write_b128 v48, v[52:55] offset:8192
  ds_write_b128 v48, v[76:79] offset:9216
  s_waitcnt vmcnt(36)
  ds_read_b64_tr_b16 v[152:153], v38 offset:12288
  ds_read_b64_tr_b16 v[154:155], v38 offset:12544
  ds_read_b64_tr_b16 v[52:53], v39 offset:12288
  ds_read_b64_tr_b16 v[54:55], v39 offset:12544
  s_waitcnt lgkmcnt(6)
  ds_write_b128 v48, v[124:127] offset:10240
  ds_write_b128 v48, v[80:83] offset:11264
  s_waitcnt vmcnt(34)
  ds_read_b64_tr_b16 v[156:157], v38 offset:14336
  ds_read_b64_tr_b16 v[158:159], v38 offset:14592
  ds_read_b64_tr_b16 v[124:125], v39 offset:14336
  ds_read_b64_tr_b16 v[126:127], v39 offset:14592
  s_waitcnt lgkmcnt(6)
  ds_write_b128 v48, v[52:55] offset:12288
  ds_write_b128 v48, v[84:87] offset:13312
  s_waitcnt vmcnt(32)
  ds_read_b64_tr_b16 v[160:161], v38 offset:16384
  ds_read_b64_tr_b16 v[162:163], v38 offset:16640
  ds_read_b64_tr_b16 v[52:53], v39 offset:16384
  ds_read_b64_tr_b16 v[54:55], v39 offset:16640
  s_waitcnt lgkmcnt(6)
  ds_write_b128 v48, v[124:127] offset:14336
  ds_write_b128 v48, v[88:91] offset:15360
  s_waitcnt vmcnt(30)
  ds_read_b64_tr_b16 v[164:165], v38 offset:18432
  ds_read_b64_tr_b16 v[166:167], v38 offset:18688
  ds_read_b64_tr_b16 v[124:125], v39 offset:18432
  ds_read_b64_tr_b16 v[126:127], v39 offset:18688
  s_waitcnt lgkmcnt(6)
  ds_write_b128 v48, v[52:55] offset:16384
  ds_write_b128 v48, v[92:95] offset:17408
  s_waitcnt vmcnt(28)
  ds_read_b64_tr_b16 v[168:169], v38 offset:20480
  ds_read_b64_tr_b16 v[170:171], v38 offset:20736
  ds_read_b64_tr_b16 v[52:53], v39 offset:20480
  ds_read_b64_tr_b16 v[54:55], v39 offset:20736
  s_waitcnt lgkmcnt(6)
  ds_write_b128 v48, v[124:127] offset:18432
  ds_write_b128 v48, v[96:99] offset:19456
  s_waitcnt vmcnt(26)
  ds_read_b64_tr_b16 v[172:173], v38 offset:22528
  ds_read_b64_tr_b16 v[174:175], v38 offset:22784
  ds_read_b64_tr_b16 v[124:125], v39 offset:22528
  ds_read_b64_tr_b16 v[126:127], v39 offset:22784
  s_waitcnt lgkmcnt(6)
  ds_write_b128 v48, v[52:55] offset:20480
  ds_write_b128 v48, v[100:103] offset:21504
  s_waitcnt vmcnt(24)
  ds_read_b64_tr_b16 v[176:177], v38 offset:24576
  ds_read_b64_tr_b16 v[178:179], v38 offset:24832
  ds_read_b64_tr_b16 v[52:53], v39 offset:24576
  ds_read_b64_tr_b16 v[54:55], v39 offset:24832
  s_waitcnt lgkmcnt(6)
  ds_write_b128 v48, v[124:127] offset:22528
  ds_write_b128 v48, v[104:107] offset:23552
  s_waitcnt vmcnt(22)
  ds_read_b64_tr_b16 v[180:181], v38 offset:26624
  ds_read_b64_tr_b16 v[182:183], v38 offset:26880
  ds_read_b64_tr_b16 v[124:125], v39 offset:26624
  ds_read_b64_tr_b16 v[126:127], v39 offset:26880
  s_waitcnt lgkmcnt(6)
  ds_write_b128 v48, v[52:55] offset:24576
  ds_write_b128 v48, v[108:111] offset:25600
  s_waitcnt vmcnt(20)
  ds_read_b64_tr_b16 v[184:185], v38 offset:28672
  ds_read_b64_tr_b16 v[186:187], v38 offset:28928
  ds_read_b64_tr_b16 v[52:53], v39 offset:28672
  ds_read_b64_tr_b16 v[54:55], v39 offset:28928
  s_waitcnt lgkmcnt(6)
  ds_write_b128 v48, v[124:127] offset:26624
  ds_write_b128 v48, v[112:115] offset:27648
  s_waitcnt vmcnt(18)
  ds_read_b64_tr_b16 v[188:189], v38 offset:30720
  ds_read_b64_tr_b16 v[190:191], v38 offset:30976
  ds_read_b64_tr_b16 v[124:125], v39 offset:30720
  ds_read_b64_tr_b16 v[126:127], v39 offset:30976
  s_waitcnt lgkmcnt(6)
  ds_write_b128 v48, v[52:55] offset:28672
  ds_write_b128 v48, v[116:119] offset:29696
  s_waitcnt vmcnt(16)
  ds_read_b64_tr_b16 v[128:129], v38 offset:0
  ds_read_b64_tr_b16 v[130:131], v38 offset:256
  ds_read_b64_tr_b16 v[52:53], v39 offset:0
  ds_read_b64_tr_b16 v[54:55], v39 offset:256
  s_waitcnt lgkmcnt(6)
  ds_write_b128 v48, v[124:127] offset:30720
  ds_write_b128 v48, v[120:123] offset:31744
  s_waitcnt vmcnt(14)
  ds_read_b64_tr_b16 v[132:133], v38 offset:2048
  ds_read_b64_tr_b16 v[134:135], v38 offset:2304
  ds_read_b64_tr_b16 v[124:125], v39 offset:2048
  ds_read_b64_tr_b16 v[126:127], v39 offset:2304
  s_waitcnt lgkmcnt(6)
  ds_write_b128 v48, v[52:55] offset:0
  ds_write_b128 v48, v[60:63] offset:1024
  s_waitcnt vmcnt(12)
  ds_read_b64_tr_b16 v[136:137], v38 offset:4096
  ds_read_b64_tr_b16 v[138:139], v38 offset:4352
  ds_read_b64_tr_b16 v[52:53], v39 offset:4096
  ds_read_b64_tr_b16 v[54:55], v39 offset:4352
  s_waitcnt lgkmcnt(6)
  ds_write_b128 v48, v[124:127] offset:2048
  ds_write_b128 v48, v[64:67] offset:3072
  s_waitcnt vmcnt(10)
  ds_read_b64_tr_b16 v[140:141], v38 offset:6144
  ds_read_b64_tr_b16 v[142:143], v38 offset:6400
  ds_read_b64_tr_b16 v[124:125], v39 offset:6144
  ds_read_b64_tr_b16 v[126:127], v39 offset:6400
  s_waitcnt lgkmcnt(6)
  ds_write_b128 v48, v[52:55] offset:4096
  ds_write_b128 v48, v[68:71] offset:5120
  s_waitcnt lgkmcnt(2)
  ds_write_b128 v48, v[124:127] offset:6144
  ds_write_b128 v48, v[72:75] offset:7168
  s_waitcnt lgkmcnt(0)
L_ld_done:
  s_lshl_b32 s21, s17, 13
  s_lshl_b32 s22, s16, 11
  s_add_u32 s21, s21, s22
  s_add_u32 s25, s21, 1048576
  s_mov_b32 s18, 0
  s_mov_b32 s29, 0
  s_mov_b32 s26, 1835008
  s_mov_b32 s27, 1843200
  s_mov_b32 s28, 1851392
  s_lshl_b32 s21, s17, 14
  s_lshl_b32 s22, s16, 12
  s_add_u32 s21, s21, s22
  s_add_u32 s30, s21, 16777216
  s_lshl_b32 s21, s17, 13
  s_lshl_b32 s22, s16, 11
  s_add_u32 s21, s21, s22
  s_add_u32 s32, s21, 4194304
  s_add_u32 s33, s21, 67108864
  s_mov_b32 s65, 0
  s_waitcnt vmcnt(0)
  v_cmp_eq_u32 vcc, 0, v51
  v_cmp_gt_u32 s[22:23], 32, v57
  s_or_b64 vcc, vcc, s[22:23]
  v_cmp_ne_u32 s[36:37], 0, v50
  s_cbranch_vccz L_rdy_ok
  s_mov_b64 s[36:37], 0
L_rdy:
  v_mov_b32 v56, 64
  v_mov_b32 v57, 132
  buffer_load_dword v56, v56, s[12:15], 0 offen sc1
  buffer_load_dword v57, v57, s[12:15], 0 offen sc1
  s_waitcnt vmcnt(0)
  v_cmp_eq_u32 vcc, 0, v56
  v_cmp_gt_u32 s[22:23], 32, v57
  s_or_b64 vcc, vcc, s[22:23]
  s_add_u32 s19, s19, 1
  s_cmp_lt_u32 s19, 2097152
  s_cselect_b64 s[20:21], -1, 0
  s_and_b64 vcc, vcc, s[20:21]
  s_cbranch_vccnz L_rdy
L_rdy_ok:
  s_bitcmp1_b64 s[36:37], 0
  s_cbranch_scc0 L_f1poll_p0
L_f1ok_p0:
  v_mov_b64 v[28:29], v[20:21]
  v_mov_b64 v[30:31], v[22:23]
  v_mov_b64 v[32:33], v[24:25]
  v_mov_b64 v[34:35], v[26:27]
  v_mov_b64 v[60:61], 0
  v_mov_b64 v[62:63], 0
  v_mov_b64 v[64:65], 0
  v_mov_b64 v[66:67], 0
  v_mov_b64 v[68:69], 0
  v_mov_b64 v[70:71], 0
  v_mov_b64 v[72:73], 0
  v_mov_b64 v[74:75], 0
  v_mov_b64 v[76:77], 0
  v_mov_b64 v[78:79], 0
  v_mov_b64 v[80:81], 0
  v_mov_b64 v[82:83], 0
  ds_read_b128 v[104:107], v12 offset:0
  ds_read_b128 v[108:111], v12 offset:2048
  ds_read_b128 v[112:115], v12 offset:4096
  ds_read_b128 v[116:119], v12 offset:6144
  s_branch L_have_mem
.p2align 6
L_top:
L_top_w:
  s_add_u32 s19, s19, 1
  s_cmp_lt_u32 s19, 2097152
  s_cselect_b64 s[20:21], -1, 0
  s_waitcnt vmcnt(15)
  v_mfma_f32_16x16x32_bf16 v[72:75], v[28:31], v[4:7], 0
  s_waitcnt vmcnt(14)
  v_mfma_f32_16x16x32_bf16 v[72:75], v[32:35], v[4:7], v[72:75]
  v_bitop3_b32 v18, v28, v32, s29 bitop3:0x7e
  s_waitcnt vmcnt(13)
  v_mfma_f32_16x16x32_bf16 v[72:75], v[36:39], v[4:7], v[72:75]
  v_bitop3_b32 v18, v18, v36, s29 bitop3:0xf6
  s_waitcnt vmcnt(12)
  v_mfma_f32_16x16x32_bf16 v[72:75], v[40:43], v[4:7], v[72:75]
  v_bitop3_b32 v18, v18, v40, s29 bitop3:0xf6
  s_waitcnt vmcnt(11)
  v_mfma_f32_16x16x32_bf16 v[72:75], v[44:47], v[4:7], v[72:75]
  v_bitop3_b32 v18, v18, v44, s29 bitop3:0xf6
  s_waitcnt vmcnt(10)
  v_mfma_f32_16x16x32_bf16 v[72:75], v[48:51], v[4:7], v[72:75]
  v_bitop3_b32 v18, v18, v48, s29 bitop3:0xf6
  s_waitcnt vmcnt(9)
  v_mfma_f32_16x16x32_bf16 v[72:75], v[52:55], v[4:7], v[72:75]
  v_bitop3_b32 v18, v18, v52, s29 bitop3:0xf6
  s_waitcnt vmcnt(8)
  v_mfma_f32_16x16x32_bf16 v[72:75], v[56:59], v[4:7], v[72:75]
  v_bitop3_b32 v18, v18, v56, s29 bitop3:0xf6
  v_and_b32 v18, 1, v18
  v_cmp_ne_u32 vcc, 0, v18
  s_and_b64 vcc, vcc, s[20:21]
  s_cbranch_vccnz L_retry1
L_red_ok:
  s_nop 2
  v_cvt_pk_bf16_f32 v76, v72, v73
  s_nop 1
  v_cvt_pk_bf16_f32 v77, v74, v75
  s_mov_b64 exec, s[38:39]
  buffer_store_dwordx2 v[76:77], v17, s[8:11], s26 offen
  s_mov_b64 exec, -1
L_nored:
  s_lshl_b32 s20, s16, 11
  s_add_u32 s24, s26, s20
  s_barrier
  s_mov_b32 s20, s26
  s_mov_b32 s26, s27
  s_mov_b32 s27, s28
  s_mov_b32 s28, s20
  s_add_u32 s18, s18, 1
  s_xor_b32 s29, s29, 1
  v_mov_b64 v[60:61], 0
  v_mov_b64 v[62:63], 0
  v_mov_b64 v[64:65], 0
  v_mov_b64 v[66:67], 0
  v_mov_b64 v[68:69], 0
  v_mov_b64 v[70:71], 0
  v_mov_b64 v[72:73], 0
  v_mov_b64 v[74:75], 0
  v_mov_b64 v[76:77], 0
  buffer_load_dwordx4 v[28:31], v0, s[8:11], s24 offen sc1
  buffer_load_dwordx4 v[32:35], v0, s[8:11], s24 offen offset:1024 sc1
  v_mov_b64 v[78:79], 0
  v_mov_b64 v[80:81], 0
  v_mov_b64 v[82:83], 0
  ds_read_b128 v[104:107], v12 offset:0
  ds_read_b128 v[108:111], v12 offset:2048
  ds_read_b128 v[112:115], v12 offset:4096
  ds_read_b128 v[116:119], v12 offset:6144
  s_waitcnt lgkmcnt(0)
  buffer_load_dwordx4 v[84:87], v0, s[8:11], s24 offen sc1
  buffer_load_dwordx4 v[88:91], v0, s[8:11], s24 offen offset:1024 sc1
  s_add_u32 s19, s19, 1
  s_cmp_lt_u32 s19, 2097152
  s_cselect_b64 s[20:21], -1, 0
  s_waitcnt vmcnt(2)
  v_max3_u32 v18, v28, v29, v30
  v_max3_u32 v18, v18, v31, v32
  v_max3_u32 v18, v18, v33, v34
  v_max_u32 v18, v18, v35
  v_cmp_eq_u32 vcc, -1, v18
  s_and_b64 vcc, vcc, s[20:21]
  s_cbranch_vccnz L_m_r0
L_have_mem:
  s_cmp_eq_u32 s18, 63
  s_cbranch_scc1 L_epilogue
  v_smfmac_f32_16x16x64_bf16 v[68:71], v[28:31], a[128:135], v1
  ds_write_b128 v8, v[28:31] offset:0
  v_smfmac_f32_16x16x64_bf16 v[72:75], v[28:31], a[192:199], v1
  ds_write_b128 v8, v[32:35] offset:1024
  v_smfmac_f32_16x16x64_bf16 v[68:71], v[32:35], a[136:143], v1
  buffer_load_dwordx4 v[84:87], v0, s[8:11], s30 offen sc1
  v_smfmac_f32_16x16x64_bf16 v[72:75], v[32:35], a[200:207], v1
  buffer_load_dwordx4 v[88:91], v0, s[8:11], s30 offen offset:1024 sc1
  v_smfmac_f32_16x16x64_bf16 v[76:79], v[28:31], v[128:135], v1
  s_waitcnt lgkmcnt(0)
  s_barrier
  ds_read_b128 v[36:39], v9 offset:0
  ds_read_b128 v[40:43], v9 offset:1024
  ds_read_b128 v[44:47], v10 offset:0
  ds_read_b128 v[48:51], v10 offset:1024
  ds_read_b128 v[52:55], v11 offset:0
  ds_read_b128 v[56:59], v11 offset:1024
  v_smfmac_f32_16x16x64_bf16 v[76:79], v[32:35], v[136:143], v1
  s_waitcnt lgkmcnt(8)
  v_smfmac_f32_16x16x64_bf16 v[80:83], v[28:31], v[104:111], v1
  buffer_load_dwordx4 v[92:95], v0, s[8:11], s30 offen offset:2048 sc1
  v_smfmac_f32_16x16x64_bf16 v[80:83], v[32:35], v[112:119], v1
  buffer_load_dwordx4 v[96:99], v0, s[8:11], s30 offen offset:3072 sc1
  v_smfmac_f32_16x16x64_bf16 v[60:63], v[28:31], a[0:7], v1
  s_add_u32 s34, s18, 1
  s_min_u32 s34, s34, 62
  v_smfmac_f32_16x16x64_bf16 v[64:67], v[28:31], a[64:71], v1
  s_sub_u32 s35, s34, s18
  s_lshl_b32 s35, s35, 19
  v_smfmac_f32_16x16x64_bf16 v[60:63], v[32:35], a[8:15], v1
  s_add_u32 s31, s30, s35
  s_add_u32 s30, s30, 524288
  v_smfmac_f32_16x16x64_bf16 v[64:67], v[32:35], a[72:79], v1
  s_cmp_eq_u32 s65, 0
  s_cbranch_scc0 L_f1merge
L_f1merged:
  s_bitcmp1_b64 s[36:37], s34
  s_cbranch_scc0 L_f1poll_st
L_f1ok_st:
  s_waitcnt lgkmcnt(5)
  v_smfmac_f32_16x16x64_bf16 v[60:63], v[36:39], a[16:23], v1
  v_lshlrev_b32 v18, 2, v0
  v_smfmac_f32_16x16x64_bf16 v[64:67], v[36:39], a[80:87], v1
  buffer_load_dword v100, v18, s[8:11], s31 offen sc1
  s_waitcnt lgkmcnt(4)
  v_smfmac_f32_16x16x64_bf16 v[60:63], v[40:43], a[24:31], v1
  v_mov_b32 v101, s18
  v_smfmac_f32_16x16x64_bf16 v[64:67], v[40:43], a[88:95], v1
  buffer_store_dword v101, off, s[8:11], s49 sc1
  s_waitcnt lgkmcnt(3)
  v_smfmac_f32_16x16x64_bf16 v[60:63], v[44:47], a[32:39], v1
  ds_read_b128 v[104:107], v12 offset:8192
  v_smfmac_f32_16x16x64_bf16 v[64:67], v[44:47], a[96:103], v1
  ds_read_b128 v[108:111], v12 offset:10240
  s_waitcnt lgkmcnt(4)
  v_smfmac_f32_16x16x64_bf16 v[60:63], v[48:51], a[40:47], v1
  ds_read_b128 v[112:115], v12 offset:12288
  v_smfmac_f32_16x16x64_bf16 v[64:67], v[48:51], a[104:111], v1
  ds_read_b128 v[116:119], v12 offset:14336
  s_waitcnt lgkmcnt(5)
  v_smfmac_f32_16x16x64_bf16 v[60:63], v[52:55], a[48:55], v1
  ds_read_b128 v[120:123], v12 offset:16384
  v_smfmac_f32_16x16x64_bf16 v[64:67], v[52:55], a[112:119], v1
  ds_read_b128 v[124:127], v12 offset:18432
  s_waitcnt lgkmcnt(6)
  v_smfmac_f32_16x16x64_bf16 v[60:63], v[56:59], a[56:63], v1
  v_smfmac_f32_16x16x64_bf16 v[64:67], v[56:59], a[120:127], v1
  v_smfmac_f32_16x16x64_bf16 v[68:71], v[36:39], a[144:151], v1
  v_smfmac_f32_16x16x64_bf16 v[72:75], v[36:39], a[208:215], v1
  v_smfmac_f32_16x16x64_bf16 v[68:71], v[40:43], a[152:159], v1
  v_cvt_pk_bf16_f32 v20, v60, v61
  v_smfmac_f32_16x16x64_bf16 v[72:75], v[40:43], a[216:223], v1
  v_cvt_pk_bf16_f32 v21, v62, v63
  v_smfmac_f32_16x16x64_bf16 v[68:71], v[44:47], a[160:167], v1
  v_cvt_pk_bf16_f32 v22, v64, v65
  v_smfmac_f32_16x16x64_bf16 v[72:75], v[44:47], a[224:231], v1
  v_cvt_pk_bf16_f32 v23, v66, v67
  v_smfmac_f32_16x16x64_bf16 v[68:71], v[48:51], a[168:175], v1
  v_smfmac_f32_16x16x64_bf16 v[72:75], v[48:51], a[232:239], v1
  v_smfmac_f32_16x16x64_bf16 v[68:71], v[52:55], a[176:183], v1
  v_smfmac_f32_16x16x64_bf16 v[72:75], v[52:55], a[240:247], v1
  v_smfmac_f32_16x16x64_bf16 v[68:71], v[56:59], a[184:191], v1
  v_smfmac_f32_16x16x64_bf16 v[72:75], v[56:59], a[248:255], v1
  v_mfma_f32_16x16x16_bf16 v[60:63], v[20:21], v[2:3], 0
  v_mfma_f32_16x16x16_bf16 v[64:67], v[22:23], v[2:3], 0
  v_cvt_pk_bf16_f32 v24, v68, v69
  v_cvt_pk_bf16_f32 v25, v70, v71
  v_cvt_pk_bf16_f32 v26, v72, v73
  v_cvt_pk_bf16_f32 v27, v74, v75
  v_smfmac_f32_16x16x64_bf16 v[76:79], v[36:39], v[144:151], v1
  v_mfma_f32_16x16x16_bf16 v[68:71], v[24:25], v[2:3], 0
  v_mfma_f32_16x16x16_bf16 v[72:75], v[26:27], v[2:3], 0
  v_cvt_pk_bf16_f32 v24, v60, v61
  v_cvt_pk_bf16_f32 v25, v62, v63
  v_cvt_pk_bf16_f32 v26, v64, v65
  v_cvt_pk_bf16_f32 v27, v66, v67
  s_waitcnt vmcnt(2)
  s_nop 0
  v_mfma_f32_16x16x32_bf16 v[60:63], v[84:87], v[24:27], 0
  v_mfma_f32_16x16x32_bf16 v[64:67], v[88:91], v[24:27], 0
  v_cvt_pk_bf16_f32 v20, v68, v69
  v_cvt_pk_bf16_f32 v21, v70, v71
  v_cvt_pk_bf16_f32 v22, v72, v73
  v_cvt_pk_bf16_f32 v23, v74, v75
  v_smfmac_f32_16x16x64_bf16 v[76:79], v[40:43], v[152:159], v1
  v_mfma_f32_16x16x32_bf16 v[68:71], v[20:23], v[24:27], 0
  v_cndmask_b32 v60, v64, v60, s[50:51]
  v_cndmask_b32 v61, v65, v61, s[50:51]
  v_cndmask_b32 v62, v66, v62, s[50:51]
  v_cndmask_b32 v63, v67, v63, s[50:51]
  ds_write_b128 v13, v[60:63] offset:8192
  s_waitcnt lgkmcnt(5)
  v_smfmac_f32_16x16x64_bf16 v[80:83], v[36:39], v[104:111], v1
  s_nop 0
  ds_write2_b32 v14, v68, v70 offset0:0 offset1:1
  s_add_u32 s35, s18, 3
  s_min_u32 s35, s35, 62
  s_bitcmp1_b64 s[36:37], s35
  s_cbranch_scc0 L_f1async
L_f1asyncd:
  v_smfmac_f32_16x16x64_bf16 v[80:83], v[40:43], v[112:119], v1
  buffer_store_dwordx4 v[20:23], v0, s[8:11], s33 offen sc1
  v_smfmac_f32_16x16x64_bf16 v[80:83], v[44:47], v[120:127], v1
  ds_read_b128 v[104:107], v12 offset:20480
  ds_read_b128 v[108:111], v12 offset:22528
  v_smfmac_f32_16x16x64_bf16 v[76:79], v[44:47], v[160:167], v1
  ds_read_b128 v[112:115], v12 offset:24576
  ds_read_b128 v[116:119], v12 offset:26624
  v_smfmac_f32_16x16x64_bf16 v[76:79], v[48:51], v[168:175], v1
  ds_read_b128 v[120:123], v12 offset:28672
  ds_read_b128 v[124:127], v12 offset:30720
  s_waitcnt lgkmcnt(6)
  s_barrier
  ds_read_b128 v[60:63], v0 offset:8192
  ds_read_b128 v[64:67], v0 offset:9216
  ds_read_b128 v[68:71], v0 offset:10240
  ds_read_b128 v[72:75], v0 offset:11264
  ds_read_b64 v[84:85], v19 offset:12288
  ds_read_b64 v[86:87], v19 offset:12800
  v_smfmac_f32_16x16x64_bf16 v[76:79], v[52:55], v[176:183], v1
  v_smfmac_f32_16x16x64_bf16 v[76:79], v[56:59], v[184:191], v1
  s_waitcnt lgkmcnt(6)
  v_smfmac_f32_16x16x64_bf16 v[80:83], v[48:51], v[104:111], v1
  v_smfmac_f32_16x16x64_bf16 v[80:83], v[52:55], v[112:119], v1
  v_smfmac_f32_16x16x64_bf16 v[80:83], v[56:59], v[120:127], v1
  s_waitcnt lgkmcnt(4)
  v_pk_add_f32 v[60:61], v[60:61], v[64:65]
  v_pk_add_f32 v[62:63], v[62:63], v[66:67]
  s_waitcnt lgkmcnt(2)
  v_pk_add_f32 v[68:69], v[68:69], v[72:73]
  v_pk_add_f32 v[70:71], v[70:71], v[74:75]
  s_waitcnt lgkmcnt(0)
  v_pk_add_f32 v[84:85], v[84:85], v[86:87]
  v_pk_add_f32 v[60:61], v[60:61], v[68:69]
  v_pk_add_f32 v[62:63], v[62:63], v[70:71]
  v_add_f32_dpp v84, v84, v84 quad_perm:[1,0,3,2] row_mask:0xf bank_mask:0xf
  v_add_f32_dpp v85, v85, v85 quad_perm:[1,0,3,2] row_mask:0xf bank_mask:0xf
  v_mov_b32_dpp v64, v60 quad_perm:[1,0,3,2] row_mask:0xf bank_mask:0xf
  v_mov_b32_dpp v65, v61 quad_perm:[1,0,3,2] row_mask:0xf bank_mask:0xf
  v_mov_b32_dpp v66, v62 quad_perm:[1,0,3,2] row_mask:0xf bank_mask:0xf
  v_mov_b32_dpp v67, v63 quad_perm:[1,0,3,2] row_mask:0xf bank_mask:0xf
  v_max3_f32 v68, v60, v61, v62
  v_max3_f32 v70, v63, v84, v85
  v_max3_f32 v69, v64, v65, v66
  v_max3_f32 v68, v68, v70, v67
  v_max_f32 v70, v68, v69
  v_max_f32 v68, v68, v69
  v_cvt_pk_bf16_f32 v24, v76, v77
  v_cvt_pk_bf16_f32 v25, v78, v79
  v_permlane16_swap_b32 v68, v70
  v_max_f32 v69, v68, v70
  v_max_f32 v68, v68, v70
  v_cvt_pk_bf16_f32 v26, v80, v81
  v_cvt_pk_bf16_f32 v27, v82, v83
  v_permlane32_swap_b32 v68, v69
  v_max_f32 v68, v68, v69
  v_mul_f32 v68, s48, v68
  buffer_store_dwordx4 v[24:27], v0, s[8:11], s33 offen offset:1024 sc1
  v_pk_fma_f32 v[60:61], v[60:61], s[58:59], v[68:69] op_sel_hi:[1,1,0] neg_lo:[0,0,1] neg_hi:[0,0,1]
  v_pk_fma_f32 v[62:63], v[62:63], s[58:59], v[68:69] op_sel_hi:[1,1,0] neg_lo:[0,0,1] neg_hi:[0,0,1]
  v_pk_fma_f32 v[64:65], v[64:65], s[58:59], v[68:69] op_sel_hi:[1,1,0] neg_lo:[0,0,1] neg_hi:[0,0,1]
  v_pk_fma_f32 v[66:67], v[66:67], s[58:59], v[68:69] op_sel_hi:[1,1,0] neg_lo:[0,0,1] neg_hi:[0,0,1]
  v_pk_fma_f32 v[84:85], v[84:85], s[58:59], v[68:69] op_sel_hi:[1,1,0] neg_lo:[0,0,1] neg_hi:[0,0,1]
  v_exp_f32 v60, v60
  v_exp_f32 v61, v61
  v_exp_f32 v62, v62
  v_exp_f32 v63, v63
  v_exp_f32 v64, v64
  v_exp_f32 v65, v65
  v_exp_f32 v66, v66
  v_exp_f32 v67, v67
  v_exp_f32 v84, v84
  v_cvt_pk_bf16_f32 v72, v60, v61
  v_exp_f32 v85, v85
  v_cvt_pk_bf16_f32 v73, v62, v63
  v_cvt_pk_bf16_f32 v74, v64, v65
  v_cvt_pk_bf16_f32 v75, v66, v67
  v_cvt_pk_bf16_f32 v86, v84, v84
  v_cvt_pk_bf16_f32 v87, v85, v85
  v_mfma_f32_16x16x32_bf16 v[76:79], v[92:95], v[72:75], 0
  v_add_f32 v60, v60, v61
  v_add_f32 v62, v62, v63
  v_mfma_f32_16x16x32_bf16 v[80:83], v[96:99], v[72:75], 0
  v_add_f32 v64, v64, v65
  v_add_f32 v66, v66, v67
  v_mfma_f32_16x16x16_bf16 v[76:79], v[24:25], v[86:87], v[76:79]
  v_add_f32 v84, v84, v85
  v_add_f32 v60, v60, v62
  v_mfma_f32_16x16x16_bf16 v[80:83], v[26:27], v[86:87], v[80:83]
  v_add_f32 v64, v64, v66
  v_add_f32 v60, v60, v84
  v_add_f32 v61, v60, v64
  v_add_f32 v60, v60, v64
  v_mov_b64 v[28:29], 0
  v_mov_b64 v[30:31], 0
  v_permlane16_swap_b32 v60, v61
  v_add_f32 v62, v60, v61
  v_add_f32 v60, v60, v61
  v_mov_b64 v[32:33], 0
  v_mov_b64 v[34:35], 0
  v_permlane32_swap_b32 v60, v62
  v_add_f32 v60, v60, v62
  v_rcp_f32 v60, v60
  v_mov_b64 v[36:37], 0
  v_pk_mul_f32 v[76:77], v[76:77], v[60:61] op_sel_hi:[1,0]
  v_pk_mul_f32 v[78:79], v[78:79], v[60:61] op_sel_hi:[1,0]
  v_pk_mul_f32 v[80:81], v[80:81], v[60:61] op_sel_hi:[1,0]
  v_pk_mul_f32 v[82:83], v[82:83], v[60:61] op_sel_hi:[1,0]
  v_cvt_pk_bf16_f32 v72, v76, v77
  v_cvt_pk_bf16_f32 v73, v78, v79
  v_cvt_pk_bf16_f32 v74, v80, v81
  v_cvt_pk_bf16_f32 v75, v82, v83
  s_mov_b64 exec, s[50:51]
  ds_write_b128 v15, v[72:75] offset:16384
  s_mov_b64 exec, -1
  v_mov_b64 v[38:39], 0
  v_mov_b64 v[40:41], 0
  v_mov_b64 v[42:43], 0
  v_mov_b64 v[44:45], 0
  v_mov_b64 v[46:47], 0
  v_mov_b64 v[48:49], 0
  v_mov_b64 v[50:51], 0
  v_mov_b64 v[52:53], 0
  v_mov_b64 v[54:55], 0
  v_mov_b64 v[56:57], 0
  v_mov_b64 v[58:59], 0
  s_add_u32 s35, s33, 1024
  s_waitcnt lgkmcnt(0)
  s_barrier
  ds_read_b128 v[60:63], v0 offset:16384
  ds_read_b128 v[64:67], v0 offset:17408
  ds_read_b128 v[104:107], v12 offset:1024
  ds_read_b128 v[108:111], v12 offset:3072
  s_add_u32 s33, s33, 262144
  s_waitcnt lgkmcnt(3)
  v_smfmac_f32_16x16x64_bf16 v[28:31], v[60:63], v[192:199], v1
  ds_read_b128 v[112:115], v12 offset:9216
  v_smfmac_f32_16x16x64_bf16 v[32:35], v[60:63], v[208:215], v1
  ds_read_b128 v[116:119], v12 offset:11264
  s_waitcnt lgkmcnt(4)
  v_smfmac_f32_16x16x64_bf16 v[28:31], v[64:67], v[200:207], v1
  ds_read_b128 v[120:123], v12 offset:5120
  v_smfmac_f32_16x16x64_bf16 v[32:35], v[64:67], v[216:223], v1
  ds_read_b128 v[124:127], v12 offset:7168
  v_smfmac_f32_16x16x64_bf16 v[36:39], v[60:63], v[224:231], v1
  ds_read_b128 v[84:87], v12 offset:13312
  v_smfmac_f32_16x16x64_bf16 v[40:43], v[60:63], v[240:247], v1
  ds_read_b128 v[88:91], v12 offset:15360
  v_add_f32 v28, v28, v29
  v_smfmac_f32_16x16x64_bf16 v[36:39], v[64:67], v[232:239], v1
  ds_read_b128 v[92:95], v12 offset:17408
  v_add_f32 v30, v30, v31
  v_smfmac_f32_16x16x64_bf16 v[40:43], v[64:67], v[248:255], v1
  ds_read_b128 v[96:99], v12 offset:19456
  v_cvt_pk_bf16_f32 v68, v28, v30
  s_waitcnt lgkmcnt(8)
  v_smfmac_f32_16x16x64_bf16 v[44:47], v[60:63], v[104:111], v1
  ds_read_b128 v[104:107], v12 offset:25600
  v_add_f32 v32, v32, v33
  s_waitcnt lgkmcnt(7)
  v_smfmac_f32_16x16x64_bf16 v[48:51], v[60:63], v[112:119], v1
  ds_read_b128 v[108:111], v12 offset:27648
  v_add_f32 v34, v34, v35
  s_waitcnt lgkmcnt(6)
  v_smfmac_f32_16x16x64_bf16 v[44:47], v[64:67], v[120:127], v1
  ds_read_b128 v[112:115], v12 offset:21504
  v_cvt_pk_bf16_f32 v69, v32, v34
  s_waitcnt lgkmcnt(5)
  v_smfmac_f32_16x16x64_bf16 v[48:51], v[64:67], v[84:91], v1
  ds_read_b128 v[116:119], v12 offset:23552
  v_add_f32 v36, v36, v37
  s_waitcnt lgkmcnt(4)
  v_smfmac_f32_16x16x64_bf16 v[52:55], v[60:63], v[92:99], v1
  ds_read_b128 v[120:123], v12 offset:29696
  v_add_f32 v38, v38, v39
  s_waitcnt lgkmcnt(3)
  v_smfmac_f32_16x16x64_bf16 v[56:59], v[60:63], v[104:111], v1
  ds_read_b128 v[124:127], v12 offset:31744
  v_cvt_pk_bf16_f32 v70, v36, v38
  s_waitcnt lgkmcnt(2)
  v_smfmac_f32_16x16x64_bf16 v[52:55], v[64:67], v[112:119], v1
  v_add_f32 v40, v40, v41
  v_add_f32 v42, v42, v43
  s_waitcnt lgkmcnt(0)
  v_smfmac_f32_16x16x64_bf16 v[56:59], v[64:67], v[120:127], v1
  v_cvt_pk_bf16_f32 v71, v40, v42
  v_add_f32 v44, v44, v45
  v_bfi_b32 v68, 1, s29, v68
  buffer_store_dwordx4 v[68:71], v0, s[8:11], s56 offen
  v_add_f32 v46, v46, v47
  v_cvt_pk_bf16_f32 v72, v44, v46
  v_add_f32 v48, v48, v49
  v_add_f32 v50, v50, v51
  v_cvt_pk_bf16_f32 v73, v48, v50
  v_add_f32 v52, v52, v53
  v_add_f32 v54, v54, v55
  v_cvt_pk_bf16_f32 v74, v52, v54
  v_add_f32 v56, v56, v57
  v_add_f32 v58, v58, v59
  v_cvt_pk_bf16_f32 v75, v56, v58
  v_bfi_b32 v72, 1, s29, v72
  buffer_store_dwordx4 v[72:75], v0, s[8:11], s57 offen
  s_cmp_eq_u32 s16, 0
  s_cbranch_scc0 L_house
  s_sleep 6
  buffer_load_dwordx4 v[28:31], v16, s[8:11], s40 offen sc1
  buffer_load_dwordx4 v[32:35], v16, s[8:11], s41 offen sc1
  buffer_load_dwordx4 v[36:39], v16, s[8:11], s42 offen sc1
  buffer_load_dwordx4 v[40:43], v16, s[8:11], s43 offen sc1
  buffer_load_dwordx4 v[44:47], v16, s[8:11], s44 offen sc1
  buffer_load_dwordx4 v[48:51], v16, s[8:11], s45 offen sc1
  buffer_load_dwordx4 v[52:55], v16, s[8:11], s46 offen sc1
  buffer_load_dwordx4 v[56:59], v16, s[8:11], s47 offen sc1
  buffer_load_dwordx4 v[84:87], v16, s[8:11], s40 offen sc1
  buffer_load_dwordx4 v[88:91], v16, s[8:11], s41 offen sc1
  buffer_load_dwordx4 v[92:95], v16, s[8:11], s42 offen sc1
  buffer_load_dwordx4 v[96:99], v16, s[8:11], s43 offen sc1
  buffer_load_dwordx4 v[120:123], v16, s[8:11], s44 offen sc1
  buffer_load_dwordx4 v[124:127], v16, s[8:11], s45 offen sc1
  buffer_load_dwordx4 v[20:23], v16, s[8:11], s46 offen sc1
  buffer_load_dwordx4 v[24:27], v16, s[8:11], s47 offen sc1
  s_branch L_top
L_retry1:
  buffer_load_dwordx4 v[28:31], v16, s[8:11], s40 offen sc1
  buffer_load_dwordx4 v[32:35], v16, s[8:11], s41 offen sc1
  buffer_load_dwordx4 v[36:39], v16, s[8:11], s42 offen sc1
  buffer_load_dwordx4 v[40:43], v16, s[8:11], s43 offen sc1
  buffer_load_dwordx4 v[44:47], v16, s[8:11], s44 offen sc1
  buffer_load_dwordx4 v[48:51], v16, s[8:11], s45 offen sc1
  buffer_load_dwordx4 v[52:55], v16, s[8:11], s46 offen sc1
  buffer_load_dwordx4 v[56:59], v16, s[8:11], s47 offen sc1
  s_add_u32 s19, s19, 1
  s_cmp_lt_u32 s19, 2097152
  s_cselect_b64 s[20:21], -1, 0
  s_waitcnt vmcnt(15)
  v_mfma_f32_16x16x32_bf16 v[72:75], v[84:87], v[4:7], 0
  s_waitcnt vmcnt(14)
  v_mfma_f32_16x16x32_bf16 v[72:75], v[88:91], v[4:7], v[72:75]
  v_bitop3_b32 v18, v84, v88, s29 bitop3:0x7e
  s_waitcnt vmcnt(13)
  v_mfma_f32_16x16x32_bf16 v[72:75], v[92:95], v[4:7], v[72:75]
  v_bitop3_b32 v18, v18, v92, s29 bitop3:0xf6
  s_waitcnt vmcnt(12)
  v_mfma_f32_16x16x32_bf16 v[72:75], v[96:99], v[4:7], v[72:75]
  v_bitop3_b32 v18, v18, v96, s29 bitop3:0xf6
  s_waitcnt vmcnt(11)
  v_mfma_f32_16x16x32_bf16 v[72:75], v[120:123], v[4:7], v[72:75]
  v_bitop3_b32 v18, v18, v120, s29 bitop3:0xf6
  s_waitcnt vmcnt(10)
  v_mfma_f32_16x16x32_bf16 v[72:75], v[124:127], v[4:7], v[72:75]
  v_bitop3_b32 v18, v18, v124, s29 bitop3:0xf6
  s_waitcnt vmcnt(9)
  v_mfma_f32_16x16x32_bf16 v[72:75], v[20:23], v[4:7], v[72:75]
  v_bitop3_b32 v18, v18, v20, s29 bitop3:0xf6
  s_waitcnt vmcnt(8)
  v_mfma_f32_16x16x32_bf16 v[72:75], v[24:27], v[4:7], v[72:75]
  v_bitop3_b32 v18, v18, v24, s29 bitop3:0xf6
  v_and_b32 v18, 1, v18
  v_cmp_ne_u32 vcc, 0, v18
  s_and_b64 vcc, vcc, s[20:21]
  s_cbranch_vccz L_red_ok
  buffer_load_dwordx4 v[84:87], v16, s[8:11], s40 offen sc1
  buffer_load_dwordx4 v[88:91], v16, s[8:11], s41 offen sc1
  buffer_load_dwordx4 v[92:95], v16, s[8:11], s42 offen sc1
  buffer_load_dwordx4 v[96:99], v16, s[8:11], s43 offen sc1
  buffer_load_dwordx4 v[120:123], v16, s[8:11], s44 offen sc1
  buffer_load_dwordx4 v[124:127], v16, s[8:11], s45 offen sc1
  buffer_load_dwordx4 v[20:23], v16, s[8:11], s46 offen sc1
  buffer_load_dwordx4 v[24:27], v16, s[8:11], s47 offen sc1
  s_branch L_top_w
L_m_r0:
  buffer_load_dwordx4 v[92:95], v0, s[8:11], s24 offen sc1
  buffer_load_dwordx4 v[96:99], v0, s[8:11], s24 offen offset:1024 sc1
  s_add_u32 s19, s19, 1
  s_cmp_lt_u32 s19, 2097152
  s_cselect_b64 s[20:21], -1, 0
  s_waitcnt vmcnt(2)
  v_max3_u32 v18, v84, v85, v86
  v_max3_u32 v18, v18, v87, v88
  v_max3_u32 v18, v18, v89, v90
  v_max_u32 v18, v18, v91
  v_cmp_eq_u32 vcc, -1, v18
  s_and_b64 vcc, vcc, s[20:21]
  s_cbranch_vccnz L_m_r1
  v_mov_b64 v[28:29], v[84:85]
  v_mov_b64 v[30:31], v[86:87]
  v_mov_b64 v[32:33], v[88:89]
  v_mov_b64 v[34:35], v[90:91]
  s_branch L_have_mem
L_m_r1:
  buffer_load_dwordx4 v[84:87], v0, s[8:11], s24 offen sc1
  buffer_load_dwordx4 v[88:91], v0, s[8:11], s24 offen offset:1024 sc1
  s_add_u32 s19, s19, 1
  s_cmp_lt_u32 s19, 2097152
  s_cselect_b64 s[20:21], -1, 0
  s_waitcnt vmcnt(2)
  v_max3_u32 v18, v92, v93, v94
  v_max3_u32 v18, v18, v95, v96
  v_max3_u32 v18, v18, v97, v98
  v_max_u32 v18, v18, v99
  v_cmp_eq_u32 vcc, -1, v18
  s_and_b64 vcc, vcc, s[20:21]
  s_cbranch_vccnz L_m_r0
  v_mov_b64 v[28:29], v[92:93]
  v_mov_b64 v[30:31], v[94:95]
  v_mov_b64 v[32:33], v[96:97]
  v_mov_b64 v[34:35], v[98:99]
  s_branch L_have_mem
L_house:
  s_cmp_eq_u32 s16, 2
  s_cbranch_scc0 L_nored
  v_mov_b32 v102, -1
  v_mov_b32 v103, -1
  s_mov_b64 exec, s[38:39]
  buffer_store_dwordx2 v[102:103], v17, s[8:11], s27 offen
  s_mov_b64 exec, -1
  s_branch L_nored
L_epilogue:
  s_waitcnt vmcnt(0)
  ds_write_b128 v8, v[28:31] offset:0
  ds_write_b128 v8, v[32:35] offset:1024
  s_waitcnt lgkmcnt(0)
  s_barrier
  ds_read_b128 v[36:39], v9 offset:0
  ds_read_b128 v[40:43], v9 offset:1024
  ds_read_b128 v[44:47], v10 offset:0
  ds_read_b128 v[48:51], v10 offset:1024
  ds_read_b128 v[52:55], v11 offset:0
  ds_read_b128 v[56:59], v11 offset:1024
  v_mov_b32 v18, 63
  s_mov_b64 exec, s[54:55]
  buffer_store_dword v18, v0, s[8:11], s49 offen sc1
  s_mov_b64 exec, -1
  s_waitcnt lgkmcnt(0)
  ds_read_b128 v[120:123], v12 offset:8192
  ds_read_b128 v[124:127], v12 offset:10240
  ds_read_b128 v[84:87], v12 offset:12288
  ds_read_b128 v[88:91], v12 offset:14336
  ds_read_b128 v[92:95], v12 offset:16384
  ds_read_b128 v[96:99], v12 offset:18432
  ds_read_b128 v[60:63], v12 offset:20480
  ds_read_b128 v[64:67], v12 offset:22528
  v_smfmac_f32_16x16x64_bf16 v[68:71], v[28:31], a[128:135], v1
  v_smfmac_f32_16x16x64_bf16 v[72:75], v[28:31], a[192:199], v1
  v_smfmac_f32_16x16x64_bf16 v[68:71], v[32:35], a[136:143], v1
  v_smfmac_f32_16x16x64_bf16 v[72:75], v[32:35], a[200:207], v1
  v_smfmac_f32_16x16x64_bf16 v[68:71], v[36:39], a[144:151], v1
  v_smfmac_f32_16x16x64_bf16 v[72:75], v[36:39], a[208:215], v1
  v_smfmac_f32_16x16x64_bf16 v[68:71], v[40:43], a[152:159], v1
  v_smfmac_f32_16x16x64_bf16 v[72:75], v[40:43], a[216:223], v1
  v_smfmac_f32_16x16x64_bf16 v[68:71], v[44:47], a[160:167], v1
  v_smfmac_f32_16x16x64_bf16 v[72:75], v[44:47], a[224:231], v1
  v_smfmac_f32_16x16x64_bf16 v[68:71], v[48:51], a[168:175], v1
  v_smfmac_f32_16x16x64_bf16 v[72:75], v[48:51], a[232:239], v1
  v_smfmac_f32_16x16x64_bf16 v[68:71], v[52:55], a[176:183], v1
  v_smfmac_f32_16x16x64_bf16 v[72:75], v[52:55], a[240:247], v1
  v_smfmac_f32_16x16x64_bf16 v[68:71], v[56:59], a[184:191], v1
  v_smfmac_f32_16x16x64_bf16 v[72:75], v[56:59], a[248:255], v1
  v_smfmac_f32_16x16x64_bf16 v[80:83], v[28:31], v[104:111], v1
  v_smfmac_f32_16x16x64_bf16 v[80:83], v[32:35], v[112:119], v1
  ds_read_b128 v[104:107], v12 offset:24576
  ds_read_b128 v[108:111], v12 offset:26624
  ds_read_b128 v[112:115], v12 offset:28672
  ds_read_b128 v[116:119], v12 offset:30720
  v_smfmac_f32_16x16x64_bf16 v[76:79], v[28:31], v[128:135], v1
  v_smfmac_f32_16x16x64_bf16 v[76:79], v[32:35], v[136:143], v1
  v_smfmac_f32_16x16x64_bf16 v[76:79], v[36:39], v[144:151], v1
  v_smfmac_f32_16x16x64_bf16 v[76:79], v[40:43], v[152:159], v1
  v_smfmac_f32_16x16x64_bf16 v[76:79], v[44:47], v[160:167], v1
  v_smfmac_f32_16x16x64_bf16 v[76:79], v[48:51], v[168:175], v1
  v_smfmac_f32_16x16x64_bf16 v[76:79], v[52:55], v[176:183], v1
  v_smfmac_f32_16x16x64_bf16 v[76:79], v[56:59], v[184:191], v1
  s_waitcnt lgkmcnt(0)
  v_smfmac_f32_16x16x64_bf16 v[80:83], v[36:39], v[120:127], v1
  v_smfmac_f32_16x16x64_bf16 v[80:83], v[40:43], v[84:91], v1
  v_smfmac_f32_16x16x64_bf16 v[80:83], v[44:47], v[92:99], v1
  v_smfmac_f32_16x16x64_bf16 v[80:83], v[48:51], v[60:67], v1
  v_smfmac_f32_16x16x64_bf16 v[80:83], v[52:55], v[104:111], v1
  v_smfmac_f32_16x16x64_bf16 v[80:83], v[56:59], v[112:119], v1
  v_cvt_pk_bf16_f32 v108, v68, v69
  v_cvt_pk_bf16_f32 v109, v70, v71
  v_cvt_pk_bf16_f32 v110, v72, v73
  v_cvt_pk_bf16_f32 v111, v74, v75
  v_mfma_f32_16x16x16_bf16 v[60:63], v[108:109], v[2:3], 0
  v_mfma_f32_16x16x16_bf16 v[64:67], v[110:111], v[2:3], 0
  s_nop 3
  v_cvt_pk_bf16_f32 v84, v60, v61
  s_nop 2
  v_cvt_pk_bf16_f32 v85, v62, v63
  s_nop 5
  v_cvt_pk_bf16_f32 v86, v64, v65
  s_nop 4
  v_cvt_pk_bf16_f32 v87, v66, v67
  v_cvt_pk_bf16_f32 v88, v76, v77
  v_cvt_pk_bf16_f32 v89, v78, v79
  v_cvt_pk_bf16_f32 v90, v80, v81
  v_cvt_pk_bf16_f32 v91, v82, v83
  buffer_store_dwordx4 v[84:87], v0, s[8:11], s33 offen sc1
  buffer_store_dwordx4 v[88:91], v0, s[8:11], s33 offen offset:1024 sc1
  s_waitcnt vmcnt(0)
  s_barrier
  v_mov_b32 v18, 64
  s_mov_b64 exec, s[54:55]
  buffer_store_dword v18, v0, s[8:11], s49 offen sc1
  s_mov_b64 exec, -1
  s_waitcnt vmcnt(0)
  s_waitcnt vmcnt(0)
  s_endpgm
L_f1merge:
  v_cmp_ne_u32 s[20:21], 0, v101
  s_mov_b32 s65, 0
  s_nop 4
  s_or_b64 s[36:37], s[36:37], s[20:21]
  s_branch L_f1merged
L_f1async:
  s_lshl_b32 s20, s17, 8
  v_lshrrev_b32 v101, 2, v0
  buffer_load_dword v101, v101, s[8:11], s20 offen offset:0 sc1
  s_mov_b32 s65, 1
  s_branch L_f1asyncd
L_f1poll_p0:
  s_lshl_b32 s20, s17, 8
  v_lshrrev_b32 v18, 2, v0
  buffer_load_dword v18, v18, s[8:11], s20 offen offset:0 sc1
  s_waitcnt vmcnt(0)
  v_cmp_ne_u32 s[36:37], 0, v18
  s_nop 4
  s_bitcmp1_b64 s[36:37], 0
  s_cbranch_scc1 L_f1ok_p0
  s_add_u32 s19, s19, 1
  s_cmp_lt_u32 s19, 2097152
  s_cbranch_scc1 L_f1poll_p0
  s_branch L_f1ok_p0
L_f1poll_st:
  s_lshl_b32 s20, s17, 8
  v_lshrrev_b32 v18, 2, v0
  buffer_load_dword v18, v18, s[8:11], s20 offen offset:0 sc1
  s_waitcnt vmcnt(0)
  v_cmp_ne_u32 s[36:37], 0, v18
  s_nop 4
  s_bitcmp1_b64 s[36:37], s34
  s_cbranch_scc1 L_f1ok_st
  s_add_u32 s19, s19, 1
  s_cmp_lt_u32 s19, 2097152
  s_cbranch_scc1 L_f1poll_st
  s_branch L_f1ok_st
L_exit:
  s_endpgm

.section .rodata,"a"
.p2align 6
.amdhsa_kernel gated_mix__memory_aug_recurrent_mem_tr__grouped_kv_mqa__prompt_kernel
  .amdhsa_next_free_vgpr 512
  .amdhsa_next_free_sgpr 102
  .amdhsa_accum_offset 256
  .amdhsa_group_segment_fixed_size 0
  .amdhsa_kernarg_size 128
  .amdhsa_user_sgpr_count 2
  .amdhsa_user_sgpr_kernarg_segment_ptr 1
  .amdhsa_system_sgpr_workgroup_id_x 1
.end_amdhsa_kernel
```
